```python
import torch

def _softmax(x, axis=-1):
    return torch.softmax(x, dim=axis)
def _gelu(x):
    return torch.nn.functional.gelu(x, approximate="tanh")
def _silu(x):
    return torch.nn.functional.silu(x)
def _sigmoid(x):
    return torch.sigmoid(x)
def _layernorm(x, axis=-1, eps=1e-5):
    m = x.mean(dim=axis, keepdim=True)
    v = x.var(dim=axis, keepdim=True, unbiased=False)
    return (x - m) / torch.sqrt(v + eps)
def _scatter_add(tgt, idx, src, axis=0):
    return tgt.clone().index_add_(axis, idx, src)
def _segment_sum(src, seg, n):
    out = torch.zeros((n,) + src.shape[1:], dtype=src.dtype)
    return out.index_add_(0, seg, src)
def _pad(x, pw):
    flat = tuple(v for pair in reversed(pw) for v in pair)
    return torch.nn.functional.pad(x, flat)

kernel_name = 'parallel_sum__softmax_full_mha__glu_gated_glu__prompt'

def setup_inputs():

    _w = (lambda a: (lambda t: t.to(torch.bfloat16) if t.is_floating_point() else t)(torch.as_tensor(a)))
    def _A_setup():
        B, S, D = 1, 2048, 576
        return {
            "x": _w((lambda *s: torch.randn(*s, dtype=torch.bfloat16) * 0.05)(B, S, D)),
            "wqkv": _w((lambda *s: torch.randn(*s, dtype=torch.bfloat16) * 0.2)(D, 3 * D)),
            "wo": _w((lambda *s: torch.randn(*s, dtype=torch.bfloat16) * 0.1)(D, D)),
        }
    _A_in = _A_setup()

    def _B_setup():
        B, S, D, F = 1, 2048, 576, 4608
        return {
            "x": _w((lambda *s: torch.randn(*s, dtype=torch.bfloat16) * 0.05)(B, S, D)),
            "w_gate": _w((lambda *s: torch.randn(*s, dtype=torch.bfloat16) * 0.8)(D, F)),
            "w_up": _w((lambda *s: torch.randn(*s, dtype=torch.bfloat16) * 0.1)(D, F)),
            "w_down": _w((lambda *s: torch.randn(*s, dtype=torch.bfloat16) * 0.1)(F, D)),
        }
    _B_in = _B_setup()

    return {
        "A_x": _A_in["x"],
        "A_wqkv": _A_in["wqkv"],
        "A_wo": _A_in["wo"],
        "B_x": _B_in["x"],
        "B_w_gate": _B_in["w_gate"],
        "B_w_up": _B_in["w_up"],
        "B_w_down": _B_in["w_down"],
    }

def reference(A_x, A_wqkv, A_wo, B_x, B_w_gate, B_w_up, B_w_down):
    def _A_ref(x, wqkv, wo):
        B, S, D = x.shape
        H = 32; Dh = D // H
        qkv = (lambda x, *d: x.permute(*d))((x @ wqkv).reshape(B, S, 3, H, Dh), 2, 0, 3, 1, 4)
        q, k, v = qkv[0], qkv[1], qkv[2]
        scale = Dh ** -0.5
        scores = torch.einsum("bhqd,bhkd->bhqk", q, k) * scale
        p = _softmax(scores, axis=-1)
        o = torch.einsum("bhqk,bhkd->bhqd", p, v)
        return (lambda x, *d: x.permute(*d))(o, 0, 2, 1, 3).reshape(B, S, D) @ wo

    def _B_ref(x, w_gate, w_up, w_down):
        g = torch.einsum("bsd,df->bsf", x, w_gate)
        u = torch.einsum("bsd,df->bsf", x, w_up)
        h = _sigmoid(g) * u
        return torch.einsum("bsf,fd->bsd", h, w_down)

    x = A_x
    xn = _layernorm(x, axis=-1)
    return x + _A_ref(xn, A_wqkv, A_wo) + _B_ref(xn, B_w_gate, B_w_up, B_w_down)
```

```asm
; @launch grid=(256,1,1) block=(512,1,1) lds=162304
.amdgcn_target "amdgcn-amd-amdhsa--gfx950"
.text
.globl parallel_sum__softmax_full_mha__glu_gated_glu__prompt_kernel
.type parallel_sum__softmax_full_mha__glu_gated_glu__prompt_kernel,@function
.p2align 8
parallel_sum__softmax_full_mha__glu_gated_glu__prompt_kernel:
    s_load_dwordx4 s[4:7], s[0:1], 0
    s_load_dwordx4 s[8:11], s[0:1], 32
    s_load_dwordx4 s[48:51], s[0:1], 64
    s_cmp_ge_u32 s2, 256
    s_cbranch_scc1 K_EXIT
    s_getpc_b64 s[60:61]
K_PC:
    s_and_b32 s62, s2, 0xf8
    s_lshl_b32 s62, s62, 1
    s_sub_u32 s60, s60, K_PC-parallel_sum__softmax_full_mha__glu_gated_glu__prompt_kernel
    s_subb_u32 s61, s61, 0
    v_lshrrev_b32 v244, 5, v0
    v_add_lshl_u32 v244, v244, s62, 7
    v_min_u32 v244, CODE_END-parallel_sum__softmax_full_mha__glu_gated_glu__prompt_kernel-4, v244
    v_mov_b32 v245, s61
    v_add_co_u32 v244, vcc, s60, v244
    s_nop 1
    v_addc_co_u32 v245, vcc, 0, v245, vcc
    global_load_dword v246, v[244:245], off
    v_lshrrev_b32 v1, 6, v0
    v_and_b32 v0, 63, v0
    v_readfirstlane_b32 s24, v1
    s_mov_b32 s52, s2
    s_lshr_b32 s33, s2, 7
    s_xor_b32 s33, s33, s2
    s_and_b32 s33, s33, 1
    s_mul_i32 s33, s33, 0x81
    s_xor_b32 s2, s2, s33
    s_and_b32 s3, s2, 7
    s_lshr_b32 s14, s2, 3
    s_mov_b32 s15, s2
    s_lshr_b32 s33, s14, 2
    s_and_b32 s32, s14, 3
    s_and_b32 s34, s33, 3
    s_add_u32 s31, s32, s34
    s_lshl_b32 s31, s31, 1
    s_and_b32 s34, s3, 1
    s_add_u32 s31, s31, s34
    s_cmp_ge_u32 s31, 9
    s_cselect_b32 s34, 9, 0
    s_sub_u32 s31, s31, s34
    s_and_b32 s34, s3, 3
    s_lshl_b32 s34, s34, 2
    s_add_u32 s26, s34, s32
    s_cmp_ge_u32 s24, 4
    s_cbranch_scc1 K_LOAD
    s_lshr_b32 s34, s3, 2
    s_lshl_b32 s25, s34, 3
    s_add_u32 s25, s25, s33
    v_lshrrev_b32 v164, 3, v0
    v_and_b32 v165, 7, v0
    v_lshrrev_b32 v166, 4, v0
    v_mul_u32_u24 v167, 1152, v164
    v_xor_b32 v166, v165, v166
    v_lshl_add_u32 v144, v166, 4, v167
    v_xor_b32 v145, 64, v144
    s_lshl_b32 s36, s25, 2
    s_add_u32 s36, s36, s24
    s_mul_i32 s37, s36, 36864
    s_bitcmp1_b32 0xaa80, s26
    s_cselect_b32 s38, 73728, 0
    s_cselect_b32 s35, 0, 73728
    s_lshl_b32 s34, s24, 12
    s_add_u32 s38, s38, s34
    s_mul_i32 s57, s24, 12288
    s_add_u32 s57, s57, s35
    s_add_u32 s57, s57, 24576
    s_lshl_b32 s39, s31, 7
    s_mov_b32 s18, 2359296
    s_mov_b32 s19, 0x00020000
    s_waitcnt lgkmcnt(0)
    s_mov_b32 s16, s4
    s_mov_b32 s17, s5
    s_add_u32 s40, s37, s39
    s_nop 0
    s_add_u32 m0, s38, 8192
    s_add_u32 s39, s39, 128
    buffer_load_dwordx4 v144, s[16:19], s40 offen lds
    s_add_u32 m0, s38, 9216
    s_add_u32 s40, s40, 9216
    buffer_load_dwordx4 v145, s[16:19], s40 offen lds
    s_add_u32 m0, s38, 10240
    s_add_u32 s40, s40, 9216
    buffer_load_dwordx4 v144, s[16:19], s40 offen lds
    s_add_u32 m0, s38, 11264
    s_add_u32 s40, s40, 9216
    buffer_load_dwordx4 v145, s[16:19], s40 offen lds
    s_cmp_eq_u32 s39, 1152
    s_cselect_b32 s39, 0, s39
    s_add_u32 s40, s37, s39
    s_add_u32 m0, s38, 24576
    s_add_u32 s39, s39, 128
    buffer_load_dwordx4 v144, s[16:19], s40 offen lds
    s_add_u32 m0, s38, 25600
    s_add_u32 s40, s40, 9216
    buffer_load_dwordx4 v145, s[16:19], s40 offen lds
    s_add_u32 m0, s38, 26624
    s_add_u32 s40, s40, 9216
    buffer_load_dwordx4 v144, s[16:19], s40 offen lds
    s_add_u32 m0, s38, 27648
    s_add_u32 s40, s40, 9216
    buffer_load_dwordx4 v145, s[16:19], s40 offen lds
    s_cmp_eq_u32 s39, 1152
    s_cselect_b32 s39, 0, s39
    s_add_u32 s40, s37, s39
    s_add_u32 m0, s57, 0
    s_nop 0
    s_add_u32 s39, s39, 128
    buffer_load_dwordx4 v144, s[16:19], s40 offen lds
    s_add_u32 m0, s57, 1024
    s_add_u32 s40, s40, 9216
    buffer_load_dwordx4 v145, s[16:19], s40 offen lds
    s_add_u32 m0, s57, 2048
    s_add_u32 s40, s40, 9216
    buffer_load_dwordx4 v144, s[16:19], s40 offen lds
    s_add_u32 m0, s57, 3072
    s_add_u32 s40, s40, 9216
    buffer_load_dwordx4 v145, s[16:19], s40 offen lds
    s_cmp_eq_u32 s39, 1152
    s_cselect_b32 s39, 0, s39
    s_add_u32 s40, s37, s39
    s_add_u32 m0, s57, 4096
    s_add_u32 s39, s39, 128
    buffer_load_dwordx4 v144, s[16:19], s40 offen lds
    s_add_u32 m0, s57, 5120
    s_add_u32 s40, s40, 9216
    buffer_load_dwordx4 v145, s[16:19], s40 offen lds
    s_add_u32 m0, s57, 6144
    s_add_u32 s40, s40, 9216
    buffer_load_dwordx4 v144, s[16:19], s40 offen lds
    s_add_u32 m0, s57, 7168
    s_add_u32 s40, s40, 9216
    buffer_load_dwordx4 v145, s[16:19], s40 offen lds
    s_cmp_eq_u32 s39, 1152
    s_cselect_b32 s39, 0, s39
    v_mov_b32 v221, v0
    s_mov_b32 s12, s50
    s_mov_b32 s13, s51
    s_mov_b32 s20, s12
    s_mov_b32 s21, s13
    s_mov_b32 s22, 58720256
    s_mov_b32 s23, 0x00020000
    s_lshr_b32 s32, s26, 1
    s_and_b32 s33, s26, 1
    s_mul_i32 s29, s32, 9
    s_mul_i32 s34, s33, 5
    s_add_u32 s29, s29, s34
    s_sub_u32 s30, 5, s33
    s_min_u32 s34, s32, 3
    s_mul_i32 s28, s32, 3
    s_add_u32 s28, s28, s34
    s_add_u32 s28, s28, s33
    s_cmp_lt_u32 s32, 3
    s_cselect_b32 s34, 3, 2
    s_cmp_eq_u32 s33, 1
    s_cselect_b32 s27, s34, 1
    v_lshlrev_b32 v254, 4, v221
    v_and_b32 v164, 31, v221
    v_lshrrev_b32 v165, 4, v221
    v_and_b32 v169, 15, v221
    v_bfe_u32 v166, v221, 1, 3
    v_xor_b32 v166, v166, v165
    v_lshlrev_b32 v167, 7, v169
    v_add_u32 v167, s38, v167
    s_sub_u32 s58, s38, s57
    v_lshl_add_u32 v146, v166, 4, v167
    v_xor_b32 v147, 64, v146
    v_bfe_u32 v166, v221, 2, 2
    v_lshl_add_u32 v167, v165, 3, v166
    v_lshlrev_b32 v167, 7, v167
    v_and_b32 v168, 3, v221
    v_lshl_add_u32 v167, v168, 3, v167
    v_bfe_u32 v168, v221, 3, 2
    v_lshl_add_u32 v248, v168, 5, v167
    v_add_u32 v248, s35, v248
    v_xor_b32 v249, 32, v248
    v_xor_b32 v250, 64, v248
    v_xor_b32 v251, 96, v248
    v_mov_b32 v160, 0x3f803f80
    v_mov_b32 v152, 0
    v_mov_b32 v153, 0
    v_mov_b32 v154, 0
    v_mov_b32 v155, 0
    v_mov_b32 v156, 0
    v_mov_b32 v157, 0
    v_mov_b32 v158, 0
    v_mov_b32 v159, 0
    s_mul_i32 s41, s36, 294912
    s_lshl_b32 s33, s29, 12
    s_add_u32 s41, s41, s33
    s_add_u32 s41, s41, 8388608
    s_mul_i32 s42, s36, 110592
    s_lshl_b32 s33, s28, 12
    s_add_u32 s42, s42, s33
    s_mov_b32 s43, s28
    s_mov_b32 s44, s27
    s_mov_b32 s45, s30
    s_mov_b32 s59, 0x38800000
    s_waitcnt lgkmcnt(0)
    s_waitcnt vmcnt(12)
    ds_read_b128 v[0:3], v146 offset:8192
    ds_read_b128 v[4:7], v146 offset:10240
    ds_read_b128 v[8:11], v147 offset:8192
    ds_read_b128 v[12:15], v147 offset:10240
    s_add_u32 s40, s37, s39
    s_add_u32 m0, s57, 8192
    s_add_u32 s39, s39, 128
    buffer_load_dwordx4 v144, s[16:19], s40 offen lds
    s_add_u32 m0, s57, 9216
    s_add_u32 s40, s40, 9216
    buffer_load_dwordx4 v145, s[16:19], s40 offen lds
    s_add_u32 m0, s57, 10240
    s_add_u32 s40, s40, 9216
    buffer_load_dwordx4 v144, s[16:19], s40 offen lds
    s_add_u32 m0, s57, 11264
    s_add_u32 s40, s40, 9216
    buffer_load_dwordx4 v145, s[16:19], s40 offen lds
    s_cmp_eq_u32 s39, 1152
    s_cselect_b32 s39, 0, s39
    s_waitcnt vmcnt(12)
    ds_read_b128 v[16:19], v146 offset:24576
    ds_read_b128 v[20:23], v146 offset:26624
    ds_read_b128 v[24:27], v147 offset:24576
    ds_read_b128 v[28:31], v147 offset:26624
    v_subrev_u32 v146, s58, v146
    v_subrev_u32 v147, s58, v147
    s_waitcnt lgkmcnt(4)
    s_add_u32 s40, s37, s39
    s_add_u32 m0, s38, 40960
    s_add_u32 s39, s39, 128
    buffer_load_dwordx4 v144, s[16:19], s40 offen lds
    s_add_u32 m0, s38, 41984
    s_add_u32 s40, s40, 9216
    buffer_load_dwordx4 v145, s[16:19], s40 offen lds
    s_add_u32 m0, s38, 43008
    s_add_u32 s40, s40, 9216
    buffer_load_dwordx4 v144, s[16:19], s40 offen lds
    s_add_u32 m0, s38, 44032
    s_add_u32 s40, s40, 9216
    buffer_load_dwordx4 v145, s[16:19], s40 offen lds
    s_cmp_eq_u32 s39, 1152
    s_cselect_b32 s39, 0, s39
    v_dot2c_f32_bf16 v152, v160, v0
    v_dot2c_f32_bf16 v156, v0, v0
    v_dot2c_f32_bf16 v153, v160, v1
    v_dot2c_f32_bf16 v157, v1, v1
    v_dot2c_f32_bf16 v152, v160, v2
    v_dot2c_f32_bf16 v156, v2, v2
    v_dot2c_f32_bf16 v153, v160, v3
    v_dot2c_f32_bf16 v157, v3, v3
    v_dot2c_f32_bf16 v154, v160, v4
    v_dot2c_f32_bf16 v158, v4, v4
    v_dot2c_f32_bf16 v155, v160, v5
    v_dot2c_f32_bf16 v159, v5, v5
    v_dot2c_f32_bf16 v154, v160, v6
    v_dot2c_f32_bf16 v158, v6, v6
    v_dot2c_f32_bf16 v155, v160, v7
    v_dot2c_f32_bf16 v159, v7, v7
    v_dot2c_f32_bf16 v152, v160, v8
    v_dot2c_f32_bf16 v156, v8, v8
    v_dot2c_f32_bf16 v153, v160, v9
    v_dot2c_f32_bf16 v157, v9, v9
    v_dot2c_f32_bf16 v152, v160, v10
    v_dot2c_f32_bf16 v156, v10, v10
    v_dot2c_f32_bf16 v153, v160, v11
    v_dot2c_f32_bf16 v157, v11, v11
    v_dot2c_f32_bf16 v154, v160, v12
    v_dot2c_f32_bf16 v158, v12, v12
    v_dot2c_f32_bf16 v155, v160, v13
    v_dot2c_f32_bf16 v159, v13, v13
    v_dot2c_f32_bf16 v154, v160, v14
    v_dot2c_f32_bf16 v158, v14, v14
    v_dot2c_f32_bf16 v155, v160, v15
    v_dot2c_f32_bf16 v159, v15, v15
    s_waitcnt vmcnt(12)
    ds_read_b128 v[32:35], v146 offset:0
    ds_read_b128 v[36:39], v146 offset:2048
    ds_read_b128 v[40:43], v147 offset:0
    ds_read_b128 v[44:47], v147 offset:2048
    s_waitcnt lgkmcnt(4)
    s_add_u32 s40, s37, s39
    s_add_u32 m0, s38, 57344
    s_add_u32 s39, s39, 128
    buffer_load_dwordx4 v144, s[16:19], s40 offen lds
    s_add_u32 m0, s38, 58368
    s_add_u32 s40, s40, 9216
    buffer_load_dwordx4 v145, s[16:19], s40 offen lds
    s_add_u32 m0, s38, 59392
    s_add_u32 s40, s40, 9216
    buffer_load_dwordx4 v144, s[16:19], s40 offen lds
    s_add_u32 m0, s38, 60416
    s_add_u32 s40, s40, 9216
    buffer_load_dwordx4 v145, s[16:19], s40 offen lds
    s_cmp_eq_u32 s39, 1152
    s_cselect_b32 s39, 0, s39
    v_dot2c_f32_bf16 v152, v160, v16
    v_dot2c_f32_bf16 v156, v16, v16
    v_dot2c_f32_bf16 v153, v160, v17
    v_dot2c_f32_bf16 v157, v17, v17
    v_dot2c_f32_bf16 v152, v160, v18
    v_dot2c_f32_bf16 v156, v18, v18
    v_dot2c_f32_bf16 v153, v160, v19
    v_dot2c_f32_bf16 v157, v19, v19
    v_dot2c_f32_bf16 v154, v160, v20
    v_dot2c_f32_bf16 v158, v20, v20
    v_dot2c_f32_bf16 v155, v160, v21
    v_dot2c_f32_bf16 v159, v21, v21
    v_dot2c_f32_bf16 v154, v160, v22
    v_dot2c_f32_bf16 v158, v22, v22
    v_dot2c_f32_bf16 v155, v160, v23
    v_dot2c_f32_bf16 v159, v23, v23
    v_dot2c_f32_bf16 v152, v160, v24
    v_dot2c_f32_bf16 v156, v24, v24
    v_dot2c_f32_bf16 v153, v160, v25
    v_dot2c_f32_bf16 v157, v25, v25
    v_dot2c_f32_bf16 v152, v160, v26
    v_dot2c_f32_bf16 v156, v26, v26
    v_dot2c_f32_bf16 v153, v160, v27
    v_dot2c_f32_bf16 v157, v27, v27
    v_dot2c_f32_bf16 v154, v160, v28
    v_dot2c_f32_bf16 v158, v28, v28
    v_dot2c_f32_bf16 v155, v160, v29
    v_dot2c_f32_bf16 v159, v29, v29
    v_dot2c_f32_bf16 v154, v160, v30
    v_dot2c_f32_bf16 v158, v30, v30
    v_dot2c_f32_bf16 v155, v160, v31
    v_dot2c_f32_bf16 v159, v31, v31
    s_waitcnt vmcnt(12)
    ds_read_b128 v[48:51], v146 offset:4096
    ds_read_b128 v[52:55], v146 offset:6144
    ds_read_b128 v[56:59], v147 offset:4096
    ds_read_b128 v[60:63], v147 offset:6144
    s_waitcnt lgkmcnt(4)
    s_add_u32 s40, s37, s39
    s_add_u32 m0, s38, 24576
    s_add_u32 s39, s39, 128
    buffer_load_dwordx4 v144, s[16:19], s40 offen lds
    s_add_u32 m0, s38, 25600
    s_add_u32 s40, s40, 9216
    buffer_load_dwordx4 v145, s[16:19], s40 offen lds
    s_add_u32 m0, s38, 26624
    s_add_u32 s40, s40, 9216
    buffer_load_dwordx4 v144, s[16:19], s40 offen lds
    s_add_u32 m0, s38, 27648
    s_add_u32 s40, s40, 9216
    buffer_load_dwordx4 v145, s[16:19], s40 offen lds
    s_cmp_eq_u32 s39, 1152
    s_cselect_b32 s39, 0, s39
    v_dot2c_f32_bf16 v152, v160, v32
    v_dot2c_f32_bf16 v156, v32, v32
    v_dot2c_f32_bf16 v153, v160, v33
    v_dot2c_f32_bf16 v157, v33, v33
    v_dot2c_f32_bf16 v152, v160, v34
    v_dot2c_f32_bf16 v156, v34, v34
    v_dot2c_f32_bf16 v153, v160, v35
    v_dot2c_f32_bf16 v157, v35, v35
    v_dot2c_f32_bf16 v154, v160, v36
    v_dot2c_f32_bf16 v158, v36, v36
    v_dot2c_f32_bf16 v155, v160, v37
    v_dot2c_f32_bf16 v159, v37, v37
    v_dot2c_f32_bf16 v154, v160, v38
    v_dot2c_f32_bf16 v158, v38, v38
    v_dot2c_f32_bf16 v155, v160, v39
    v_dot2c_f32_bf16 v159, v39, v39
    v_dot2c_f32_bf16 v152, v160, v40
    v_dot2c_f32_bf16 v156, v40, v40
    v_dot2c_f32_bf16 v153, v160, v41
    v_dot2c_f32_bf16 v157, v41, v41
    v_dot2c_f32_bf16 v152, v160, v42
    v_dot2c_f32_bf16 v156, v42, v42
    v_dot2c_f32_bf16 v153, v160, v43
    v_dot2c_f32_bf16 v157, v43, v43
    v_dot2c_f32_bf16 v154, v160, v44
    v_dot2c_f32_bf16 v158, v44, v44
    v_dot2c_f32_bf16 v155, v160, v45
    v_dot2c_f32_bf16 v159, v45, v45
    v_dot2c_f32_bf16 v154, v160, v46
    v_dot2c_f32_bf16 v158, v46, v46
    v_dot2c_f32_bf16 v155, v160, v47
    v_dot2c_f32_bf16 v159, v47, v47
    s_waitcnt vmcnt(12)
    ds_read_b128 v[64:67], v146 offset:8192
    ds_read_b128 v[68:71], v146 offset:10240
    ds_read_b128 v[72:75], v147 offset:8192
    ds_read_b128 v[76:79], v147 offset:10240
    v_add_u32 v146, s58, v146
    v_add_u32 v147, s58, v147
    s_waitcnt lgkmcnt(4)
    v_dot2c_f32_bf16 v152, v160, v48
    v_dot2c_f32_bf16 v156, v48, v48
    v_dot2c_f32_bf16 v153, v160, v49
    v_dot2c_f32_bf16 v157, v49, v49
    v_dot2c_f32_bf16 v152, v160, v50
    v_dot2c_f32_bf16 v156, v50, v50
    v_dot2c_f32_bf16 v153, v160, v51
    v_dot2c_f32_bf16 v157, v51, v51
    v_dot2c_f32_bf16 v154, v160, v52
    v_dot2c_f32_bf16 v158, v52, v52
    v_dot2c_f32_bf16 v155, v160, v53
    v_dot2c_f32_bf16 v159, v53, v53
    v_dot2c_f32_bf16 v154, v160, v54
    v_dot2c_f32_bf16 v158, v54, v54
    v_dot2c_f32_bf16 v155, v160, v55
    v_dot2c_f32_bf16 v159, v55, v55
    v_dot2c_f32_bf16 v152, v160, v56
    v_dot2c_f32_bf16 v156, v56, v56
    v_dot2c_f32_bf16 v153, v160, v57
    v_dot2c_f32_bf16 v157, v57, v57
    v_dot2c_f32_bf16 v152, v160, v58
    v_dot2c_f32_bf16 v156, v58, v58
    v_dot2c_f32_bf16 v153, v160, v59
    v_dot2c_f32_bf16 v157, v59, v59
    v_dot2c_f32_bf16 v154, v160, v60
    v_dot2c_f32_bf16 v158, v60, v60
    v_dot2c_f32_bf16 v155, v160, v61
    v_dot2c_f32_bf16 v159, v61, v61
    v_dot2c_f32_bf16 v154, v160, v62
    v_dot2c_f32_bf16 v158, v62, v62
    v_dot2c_f32_bf16 v155, v160, v63
    v_dot2c_f32_bf16 v159, v63, v63
    s_waitcnt vmcnt(8)
    ds_read_b128 v[80:83], v146 offset:40960
    ds_read_b128 v[84:87], v146 offset:43008
    ds_read_b128 v[88:91], v147 offset:40960
    ds_read_b128 v[92:95], v147 offset:43008
    s_waitcnt lgkmcnt(4)
    v_dot2c_f32_bf16 v152, v160, v64
    v_dot2c_f32_bf16 v156, v64, v64
    v_dot2c_f32_bf16 v153, v160, v65
    v_dot2c_f32_bf16 v157, v65, v65
    v_dot2c_f32_bf16 v152, v160, v66
    v_dot2c_f32_bf16 v156, v66, v66
    v_dot2c_f32_bf16 v153, v160, v67
    v_dot2c_f32_bf16 v157, v67, v67
    v_dot2c_f32_bf16 v154, v160, v68
    v_dot2c_f32_bf16 v158, v68, v68
    v_dot2c_f32_bf16 v155, v160, v69
    v_dot2c_f32_bf16 v159, v69, v69
    v_dot2c_f32_bf16 v154, v160, v70
    v_dot2c_f32_bf16 v158, v70, v70
    v_dot2c_f32_bf16 v155, v160, v71
    v_dot2c_f32_bf16 v159, v71, v71
    v_dot2c_f32_bf16 v152, v160, v72
    v_dot2c_f32_bf16 v156, v72, v72
    v_dot2c_f32_bf16 v153, v160, v73
    v_dot2c_f32_bf16 v157, v73, v73
    v_dot2c_f32_bf16 v152, v160, v74
    v_dot2c_f32_bf16 v156, v74, v74
    v_dot2c_f32_bf16 v153, v160, v75
    v_dot2c_f32_bf16 v157, v75, v75
    v_dot2c_f32_bf16 v154, v160, v76
    v_dot2c_f32_bf16 v158, v76, v76
    v_dot2c_f32_bf16 v155, v160, v77
    v_dot2c_f32_bf16 v159, v77, v77
    v_dot2c_f32_bf16 v154, v160, v78
    v_dot2c_f32_bf16 v158, v78, v78
    v_dot2c_f32_bf16 v155, v160, v79
    v_dot2c_f32_bf16 v159, v79, v79
    s_waitcnt vmcnt(4)
    ds_read_b128 v[96:99], v146 offset:57344
    ds_read_b128 v[100:103], v146 offset:59392
    ds_read_b128 v[104:107], v147 offset:57344
    ds_read_b128 v[108:111], v147 offset:59392
    s_waitcnt lgkmcnt(4)
    s_add_u32 s40, s37, s39
    s_add_u32 m0, s38, 40960
    s_add_u32 s39, s39, 128
    buffer_load_dwordx4 v144, s[16:19], s40 offen lds
    s_add_u32 m0, s38, 41984
    s_add_u32 s40, s40, 9216
    buffer_load_dwordx4 v145, s[16:19], s40 offen lds
    s_add_u32 m0, s38, 43008
    s_add_u32 s40, s40, 9216
    buffer_load_dwordx4 v144, s[16:19], s40 offen lds
    s_add_u32 m0, s38, 44032
    s_add_u32 s40, s40, 9216
    buffer_load_dwordx4 v145, s[16:19], s40 offen lds
    s_cmp_eq_u32 s39, 1152
    s_cselect_b32 s39, 0, s39
    s_barrier
    v_dot2c_f32_bf16 v152, v160, v80
    v_dot2c_f32_bf16 v156, v80, v80
    v_dot2c_f32_bf16 v153, v160, v81
    v_dot2c_f32_bf16 v157, v81, v81
    v_dot2c_f32_bf16 v152, v160, v82
    v_dot2c_f32_bf16 v156, v82, v82
    v_dot2c_f32_bf16 v153, v160, v83
    v_dot2c_f32_bf16 v157, v83, v83
    v_dot2c_f32_bf16 v154, v160, v84
    v_dot2c_f32_bf16 v158, v84, v84
    v_dot2c_f32_bf16 v155, v160, v85
    v_dot2c_f32_bf16 v159, v85, v85
    v_dot2c_f32_bf16 v154, v160, v86
    v_dot2c_f32_bf16 v158, v86, v86
    v_dot2c_f32_bf16 v155, v160, v87
    v_dot2c_f32_bf16 v159, v87, v87
    v_dot2c_f32_bf16 v152, v160, v88
    v_dot2c_f32_bf16 v156, v88, v88
    v_dot2c_f32_bf16 v153, v160, v89
    v_dot2c_f32_bf16 v157, v89, v89
    v_dot2c_f32_bf16 v152, v160, v90
    v_dot2c_f32_bf16 v156, v90, v90
    v_dot2c_f32_bf16 v153, v160, v91
    v_dot2c_f32_bf16 v157, v91, v91
    v_dot2c_f32_bf16 v154, v160, v92
    v_dot2c_f32_bf16 v158, v92, v92
    v_dot2c_f32_bf16 v155, v160, v93
    v_dot2c_f32_bf16 v159, v93, v93
    v_dot2c_f32_bf16 v154, v160, v94
    v_dot2c_f32_bf16 v158, v94, v94
    v_dot2c_f32_bf16 v155, v160, v95
    v_dot2c_f32_bf16 v159, v95, v95
    s_waitcnt vmcnt(4)
    ds_read_b128 v[112:115], v146 offset:24576
    ds_read_b128 v[116:119], v146 offset:26624
    ds_read_b128 v[120:123], v147 offset:24576
    ds_read_b128 v[124:127], v147 offset:26624
    s_waitcnt lgkmcnt(4)
    v_dot2c_f32_bf16 v152, v160, v96
    v_dot2c_f32_bf16 v156, v96, v96
    v_dot2c_f32_bf16 v153, v160, v97
    v_dot2c_f32_bf16 v157, v97, v97
    v_dot2c_f32_bf16 v152, v160, v98
    v_dot2c_f32_bf16 v156, v98, v98
    v_dot2c_f32_bf16 v153, v160, v99
    v_dot2c_f32_bf16 v157, v99, v99
    v_dot2c_f32_bf16 v154, v160, v100
    v_dot2c_f32_bf16 v158, v100, v100
    v_dot2c_f32_bf16 v155, v160, v101
    v_dot2c_f32_bf16 v159, v101, v101
    v_dot2c_f32_bf16 v154, v160, v102
    v_dot2c_f32_bf16 v158, v102, v102
    v_dot2c_f32_bf16 v155, v160, v103
    v_dot2c_f32_bf16 v159, v103, v103
    v_dot2c_f32_bf16 v152, v160, v104
    v_dot2c_f32_bf16 v156, v104, v104
    v_dot2c_f32_bf16 v153, v160, v105
    v_dot2c_f32_bf16 v157, v105, v105
    v_dot2c_f32_bf16 v152, v160, v106
    v_dot2c_f32_bf16 v156, v106, v106
    v_dot2c_f32_bf16 v153, v160, v107
    v_dot2c_f32_bf16 v157, v107, v107
    v_dot2c_f32_bf16 v154, v160, v108
    v_dot2c_f32_bf16 v158, v108, v108
    v_dot2c_f32_bf16 v155, v160, v109
    v_dot2c_f32_bf16 v159, v109, v109
    v_dot2c_f32_bf16 v154, v160, v110
    v_dot2c_f32_bf16 v158, v110, v110
    v_dot2c_f32_bf16 v155, v160, v111
    v_dot2c_f32_bf16 v159, v111, v111
    s_waitcnt vmcnt(0)
    ds_read_b128 v[128:131], v146 offset:40960
    ds_read_b128 v[132:135], v146 offset:43008
    ds_read_b128 v[136:139], v147 offset:40960
    ds_read_b128 v[140:143], v147 offset:43008
    s_waitcnt lgkmcnt(4)
    v_dot2c_f32_bf16 v152, v160, v112
    v_dot2c_f32_bf16 v156, v112, v112
    v_dot2c_f32_bf16 v153, v160, v113
    v_dot2c_f32_bf16 v157, v113, v113
    v_dot2c_f32_bf16 v152, v160, v114
    v_dot2c_f32_bf16 v156, v114, v114
    v_dot2c_f32_bf16 v153, v160, v115
    v_dot2c_f32_bf16 v157, v115, v115
    v_dot2c_f32_bf16 v154, v160, v116
    v_dot2c_f32_bf16 v158, v116, v116
    v_dot2c_f32_bf16 v155, v160, v117
    v_dot2c_f32_bf16 v159, v117, v117
    v_dot2c_f32_bf16 v154, v160, v118
    v_dot2c_f32_bf16 v158, v118, v118
    v_dot2c_f32_bf16 v155, v160, v119
    v_dot2c_f32_bf16 v159, v119, v119
    v_dot2c_f32_bf16 v152, v160, v120
    v_dot2c_f32_bf16 v156, v120, v120
    v_dot2c_f32_bf16 v153, v160, v121
    v_dot2c_f32_bf16 v157, v121, v121
    v_dot2c_f32_bf16 v152, v160, v122
    v_dot2c_f32_bf16 v156, v122, v122
    v_dot2c_f32_bf16 v153, v160, v123
    v_dot2c_f32_bf16 v157, v123, v123
    v_dot2c_f32_bf16 v154, v160, v124
    v_dot2c_f32_bf16 v158, v124, v124
    v_dot2c_f32_bf16 v155, v160, v125
    v_dot2c_f32_bf16 v159, v125, v125
    v_dot2c_f32_bf16 v154, v160, v126
    v_dot2c_f32_bf16 v158, v126, v126
    v_dot2c_f32_bf16 v155, v160, v127
    v_dot2c_f32_bf16 v159, v127, v127
    s_waitcnt lgkmcnt(0)
    v_dot2c_f32_bf16 v152, v160, v128
    v_dot2c_f32_bf16 v156, v128, v128
    v_dot2c_f32_bf16 v153, v160, v129
    v_dot2c_f32_bf16 v157, v129, v129
    v_dot2c_f32_bf16 v152, v160, v130
    v_dot2c_f32_bf16 v156, v130, v130
    v_dot2c_f32_bf16 v153, v160, v131
    v_dot2c_f32_bf16 v157, v131, v131
    v_dot2c_f32_bf16 v154, v160, v132
    v_dot2c_f32_bf16 v158, v132, v132
    v_dot2c_f32_bf16 v155, v160, v133
    v_dot2c_f32_bf16 v159, v133, v133
    v_dot2c_f32_bf16 v154, v160, v134
    v_dot2c_f32_bf16 v158, v134, v134
    v_dot2c_f32_bf16 v155, v160, v135
    v_dot2c_f32_bf16 v159, v135, v135
    v_dot2c_f32_bf16 v152, v160, v136
    v_dot2c_f32_bf16 v156, v136, v136
    v_dot2c_f32_bf16 v153, v160, v137
    v_dot2c_f32_bf16 v157, v137, v137
    v_dot2c_f32_bf16 v152, v160, v138
    v_dot2c_f32_bf16 v156, v138, v138
    v_dot2c_f32_bf16 v153, v160, v139
    v_dot2c_f32_bf16 v157, v139, v139
    v_dot2c_f32_bf16 v154, v160, v140
    v_dot2c_f32_bf16 v158, v140, v140
    v_dot2c_f32_bf16 v155, v160, v141
    v_dot2c_f32_bf16 v159, v141, v141
    v_dot2c_f32_bf16 v154, v160, v142
    v_dot2c_f32_bf16 v158, v142, v142
    v_dot2c_f32_bf16 v155, v160, v143
    v_dot2c_f32_bf16 v159, v143, v143
    s_nop 2
    v_add_f32 v152, v152, v153
    v_add_f32 v154, v154, v155
    v_add_f32 v156, v156, v157
    v_add_f32 v158, v158, v159
    v_mov_b32 v161, 0x00003f80
    v_mov_b32 v162, 0x3f800000
    v_permlane16_swap_b32 v152, v154
    v_permlane16_swap_b32 v156, v158
    s_nop 1
    v_add_f32 v152, v152, v154
    v_add_f32 v156, v156, v158
    v_mov_b32 v153, v152
    v_mov_b32 v157, v156
    s_nop 1
    v_permlane32_swap_b32 v152, v153
    v_permlane32_swap_b32 v156, v157
    s_nop 1
    v_add_f32 v152, v152, v153
    v_add_f32 v156, v156, v157
    v_mul_f32 v208, 0xbae38e39, v152
    v_mul_f32 v156, 0x3ae38e39, v156
    v_mov_b32 v209, v208
    v_fma_f32 v156, -v208, v208, v156
    v_max_f32 v156, 0, v156
    v_permlane16_swap_b32 v208, v209
    v_add_f32 v156, 0x3727c5ac, v156
    v_rsq_f32 v163, v156
    v_lshlrev_b32 v150, 2, v164
    s_lshl_b32 s33, s36, 7
    s_add_u32 s33, s33, 54525952
    s_cmp_eq_u32 s26, 0
    s_cselect_b32 s34, 0, 0x7ffffff0
    v_or_b32 v150, s34, v150
    v_mul_f32 v252, 0xbfb8aa3b, v163
    v_mul_f32 v253, 0xbfb8aa3b, v163
    v_mul_f32 v163, s59, v163
    buffer_store_dword v163, v150, s[20:23], s33 offen sc1
    s_mov_b32 m0, 158208
    v_permlane16_swap_b32 v252, v253
    v_dot2_f32_bf16 v168, v0, v161, v208
    v_dot2_f32_bf16 v169, v0, v162, v208
    v_dot2_f32_bf16 v170, v1, v161, v208
    v_dot2_f32_bf16 v171, v1, v162, v208
    v_dot2_f32_bf16 v172, v2, v161, v208
    v_dot2_f32_bf16 v173, v2, v162, v208
    v_cvt_pk_bf16_f32 v0, v168, v169
    v_dot2_f32_bf16 v174, v3, v161, v208
    v_dot2_f32_bf16 v175, v3, v162, v208
    v_cvt_pk_bf16_f32 v1, v170, v171
    v_dot2_f32_bf16 v168, v4, v161, v209
    v_dot2_f32_bf16 v169, v4, v162, v209
    v_cvt_pk_bf16_f32 v2, v172, v173
    v_dot2_f32_bf16 v170, v5, v161, v209
    v_dot2_f32_bf16 v171, v5, v162, v209
    v_cvt_pk_bf16_f32 v3, v174, v175
    v_dot2_f32_bf16 v172, v6, v161, v209
    v_dot2_f32_bf16 v173, v6, v162, v209
    v_cvt_pk_bf16_f32 v4, v168, v169
    v_dot2_f32_bf16 v174, v7, v161, v209
    v_dot2_f32_bf16 v175, v7, v162, v209
    v_cvt_pk_bf16_f32 v5, v170, v171
    v_dot2_f32_bf16 v168, v8, v161, v208
    v_dot2_f32_bf16 v169, v8, v162, v208
    v_cvt_pk_bf16_f32 v6, v172, v173
    v_dot2_f32_bf16 v170, v9, v161, v208
    v_dot2_f32_bf16 v171, v9, v162, v208
    v_cvt_pk_bf16_f32 v7, v174, v175
    v_dot2_f32_bf16 v172, v10, v161, v208
    v_dot2_f32_bf16 v173, v10, v162, v208
    v_cvt_pk_bf16_f32 v8, v168, v169
    v_dot2_f32_bf16 v174, v11, v161, v208
    v_dot2_f32_bf16 v175, v11, v162, v208
    v_cvt_pk_bf16_f32 v9, v170, v171
    v_dot2_f32_bf16 v168, v12, v161, v209
    v_dot2_f32_bf16 v169, v12, v162, v209
    v_cvt_pk_bf16_f32 v10, v172, v173
    v_dot2_f32_bf16 v170, v13, v161, v209
    v_dot2_f32_bf16 v171, v13, v162, v209
    v_cvt_pk_bf16_f32 v11, v174, v175
    v_dot2_f32_bf16 v172, v14, v161, v209
    v_dot2_f32_bf16 v173, v14, v162, v209
    v_cvt_pk_bf16_f32 v12, v168, v169
    v_dot2_f32_bf16 v174, v15, v161, v209
    v_dot2_f32_bf16 v175, v15, v162, v209
    v_cvt_pk_bf16_f32 v13, v170, v171
    v_dot2_f32_bf16 v168, v16, v161, v208
    v_dot2_f32_bf16 v169, v16, v162, v208
    v_cvt_pk_bf16_f32 v14, v172, v173
    v_dot2_f32_bf16 v170, v17, v161, v208
    v_dot2_f32_bf16 v171, v17, v162, v208
    v_cvt_pk_bf16_f32 v15, v174, v175
    v_dot2_f32_bf16 v172, v18, v161, v208
    v_dot2_f32_bf16 v173, v18, v162, v208
    v_cvt_pk_bf16_f32 v16, v168, v169
    v_dot2_f32_bf16 v174, v19, v161, v208
    v_dot2_f32_bf16 v175, v19, v162, v208
    v_cvt_pk_bf16_f32 v17, v170, v171
    v_dot2_f32_bf16 v168, v20, v161, v209
    v_dot2_f32_bf16 v169, v20, v162, v209
    v_cvt_pk_bf16_f32 v18, v172, v173
    v_dot2_f32_bf16 v170, v21, v161, v209
    v_dot2_f32_bf16 v171, v21, v162, v209
    v_cvt_pk_bf16_f32 v19, v174, v175
    v_dot2_f32_bf16 v172, v22, v161, v209
    v_dot2_f32_bf16 v173, v22, v162, v209
    v_cvt_pk_bf16_f32 v20, v168, v169
    v_dot2_f32_bf16 v174, v23, v161, v209
    v_dot2_f32_bf16 v175, v23, v162, v209
    v_cvt_pk_bf16_f32 v21, v170, v171
    v_dot2_f32_bf16 v168, v24, v161, v208
    v_dot2_f32_bf16 v169, v24, v162, v208
    v_cvt_pk_bf16_f32 v22, v172, v173
    v_dot2_f32_bf16 v170, v25, v161, v208
    v_dot2_f32_bf16 v171, v25, v162, v208
    v_cvt_pk_bf16_f32 v23, v174, v175
    v_dot2_f32_bf16 v172, v26, v161, v208
    v_dot2_f32_bf16 v173, v26, v162, v208
    v_cvt_pk_bf16_f32 v24, v168, v169
    v_dot2_f32_bf16 v174, v27, v161, v208
    v_dot2_f32_bf16 v175, v27, v162, v208
    v_cvt_pk_bf16_f32 v25, v170, v171
    v_dot2_f32_bf16 v168, v28, v161, v209
    v_dot2_f32_bf16 v169, v28, v162, v209
    v_cvt_pk_bf16_f32 v26, v172, v173
    v_dot2_f32_bf16 v170, v29, v161, v209
    v_dot2_f32_bf16 v171, v29, v162, v209
    v_cvt_pk_bf16_f32 v27, v174, v175
    v_dot2_f32_bf16 v172, v30, v161, v209
    v_dot2_f32_bf16 v173, v30, v162, v209
    v_cvt_pk_bf16_f32 v28, v168, v169
    v_dot2_f32_bf16 v174, v31, v161, v209
    v_dot2_f32_bf16 v175, v31, v162, v209
    v_cvt_pk_bf16_f32 v29, v170, v171
    v_dot2_f32_bf16 v168, v32, v161, v208
    v_dot2_f32_bf16 v169, v32, v162, v208
    v_cvt_pk_bf16_f32 v30, v172, v173
    v_dot2_f32_bf16 v170, v33, v161, v208
    v_dot2_f32_bf16 v171, v33, v162, v208
    v_cvt_pk_bf16_f32 v31, v174, v175
    v_dot2_f32_bf16 v172, v34, v161, v208
    v_dot2_f32_bf16 v173, v34, v162, v208
    v_cvt_pk_bf16_f32 v32, v168, v169
    v_dot2_f32_bf16 v174, v35, v161, v208
    v_dot2_f32_bf16 v175, v35, v162, v208
    v_cvt_pk_bf16_f32 v33, v170, v171
    v_dot2_f32_bf16 v168, v36, v161, v209
    v_dot2_f32_bf16 v169, v36, v162, v209
    v_cvt_pk_bf16_f32 v34, v172, v173
    v_dot2_f32_bf16 v170, v37, v161, v209
    v_dot2_f32_bf16 v171, v37, v162, v209
    v_cvt_pk_bf16_f32 v35, v174, v175
    v_dot2_f32_bf16 v172, v38, v161, v209
    v_dot2_f32_bf16 v173, v38, v162, v209
    v_cvt_pk_bf16_f32 v36, v168, v169
    v_dot2_f32_bf16 v174, v39, v161, v209
    v_dot2_f32_bf16 v175, v39, v162, v209
    v_cvt_pk_bf16_f32 v37, v170, v171
    v_dot2_f32_bf16 v168, v40, v161, v208
    v_dot2_f32_bf16 v169, v40, v162, v208
    v_cvt_pk_bf16_f32 v38, v172, v173
    v_dot2_f32_bf16 v170, v41, v161, v208
    v_dot2_f32_bf16 v171, v41, v162, v208
    v_cvt_pk_bf16_f32 v39, v174, v175
    v_dot2_f32_bf16 v172, v42, v161, v208
    v_dot2_f32_bf16 v173, v42, v162, v208
    v_cvt_pk_bf16_f32 v40, v168, v169
    v_dot2_f32_bf16 v174, v43, v161, v208
    v_dot2_f32_bf16 v175, v43, v162, v208
    v_cvt_pk_bf16_f32 v41, v170, v171
    v_dot2_f32_bf16 v168, v44, v161, v209
    v_dot2_f32_bf16 v169, v44, v162, v209
    v_cvt_pk_bf16_f32 v42, v172, v173
    v_dot2_f32_bf16 v170, v45, v161, v209
    v_dot2_f32_bf16 v171, v45, v162, v209
    v_cvt_pk_bf16_f32 v43, v174, v175
    v_dot2_f32_bf16 v172, v46, v161, v209
    v_dot2_f32_bf16 v173, v46, v162, v209
    v_cvt_pk_bf16_f32 v44, v168, v169
    v_dot2_f32_bf16 v174, v47, v161, v209
    v_dot2_f32_bf16 v175, v47, v162, v209
    v_cvt_pk_bf16_f32 v45, v170, v171
    v_dot2_f32_bf16 v168, v48, v161, v208
    v_dot2_f32_bf16 v169, v48, v162, v208
    v_cvt_pk_bf16_f32 v46, v172, v173
    v_dot2_f32_bf16 v170, v49, v161, v208
    v_dot2_f32_bf16 v171, v49, v162, v208
    v_cvt_pk_bf16_f32 v47, v174, v175
    v_dot2_f32_bf16 v172, v50, v161, v208
    v_dot2_f32_bf16 v173, v50, v162, v208
    v_cvt_pk_bf16_f32 v48, v168, v169
    v_dot2_f32_bf16 v174, v51, v161, v208
    v_dot2_f32_bf16 v175, v51, v162, v208
    v_cvt_pk_bf16_f32 v49, v170, v171
    v_dot2_f32_bf16 v168, v52, v161, v209
    v_dot2_f32_bf16 v169, v52, v162, v209
    v_cvt_pk_bf16_f32 v50, v172, v173
    v_dot2_f32_bf16 v170, v53, v161, v209
    v_dot2_f32_bf16 v171, v53, v162, v209
    v_cvt_pk_bf16_f32 v51, v174, v175
    v_dot2_f32_bf16 v172, v54, v161, v209
    v_dot2_f32_bf16 v173, v54, v162, v209
    v_cvt_pk_bf16_f32 v52, v168, v169
    v_dot2_f32_bf16 v174, v55, v161, v209
    v_dot2_f32_bf16 v175, v55, v162, v209
    v_cvt_pk_bf16_f32 v53, v170, v171
    v_dot2_f32_bf16 v168, v56, v161, v208
    v_dot2_f32_bf16 v169, v56, v162, v208
    v_cvt_pk_bf16_f32 v54, v172, v173
    v_dot2_f32_bf16 v170, v57, v161, v208
    v_dot2_f32_bf16 v171, v57, v162, v208
    v_cvt_pk_bf16_f32 v55, v174, v175
    v_dot2_f32_bf16 v172, v58, v161, v208
    v_dot2_f32_bf16 v173, v58, v162, v208
    v_cvt_pk_bf16_f32 v56, v168, v169
    v_dot2_f32_bf16 v174, v59, v161, v208
    v_dot2_f32_bf16 v175, v59, v162, v208
    v_cvt_pk_bf16_f32 v57, v170, v171
    v_dot2_f32_bf16 v168, v60, v161, v209
    v_dot2_f32_bf16 v169, v60, v162, v209
    v_cvt_pk_bf16_f32 v58, v172, v173
    v_dot2_f32_bf16 v170, v61, v161, v209
    v_dot2_f32_bf16 v171, v61, v162, v209
    v_cvt_pk_bf16_f32 v59, v174, v175
    v_dot2_f32_bf16 v172, v62, v161, v209
    v_dot2_f32_bf16 v173, v62, v162, v209
    v_cvt_pk_bf16_f32 v60, v168, v169
    v_dot2_f32_bf16 v174, v63, v161, v209
    v_dot2_f32_bf16 v175, v63, v162, v209
    v_cvt_pk_bf16_f32 v61, v170, v171
    v_dot2_f32_bf16 v168, v64, v161, v208
    v_dot2_f32_bf16 v169, v64, v162, v208
    v_cvt_pk_bf16_f32 v62, v172, v173
    v_dot2_f32_bf16 v170, v65, v161, v208
    v_dot2_f32_bf16 v171, v65, v162, v208
    v_cvt_pk_bf16_f32 v63, v174, v175
    v_dot2_f32_bf16 v172, v66, v161, v208
    v_dot2_f32_bf16 v173, v66, v162, v208
    v_cvt_pk_bf16_f32 v64, v168, v169
    v_dot2_f32_bf16 v174, v67, v161, v208
    v_dot2_f32_bf16 v175, v67, v162, v208
    v_cvt_pk_bf16_f32 v65, v170, v171
    v_dot2_f32_bf16 v168, v68, v161, v209
    v_dot2_f32_bf16 v169, v68, v162, v209
    v_cvt_pk_bf16_f32 v66, v172, v173
    v_dot2_f32_bf16 v170, v69, v161, v209
    v_dot2_f32_bf16 v171, v69, v162, v209
    v_cvt_pk_bf16_f32 v67, v174, v175
    v_dot2_f32_bf16 v172, v70, v161, v209
    v_dot2_f32_bf16 v173, v70, v162, v209
    v_cvt_pk_bf16_f32 v68, v168, v169
    v_dot2_f32_bf16 v174, v71, v161, v209
    v_dot2_f32_bf16 v175, v71, v162, v209
    v_cvt_pk_bf16_f32 v69, v170, v171
    v_dot2_f32_bf16 v168, v72, v161, v208
    v_dot2_f32_bf16 v169, v72, v162, v208
    v_cvt_pk_bf16_f32 v70, v172, v173
    v_dot2_f32_bf16 v170, v73, v161, v208
    v_dot2_f32_bf16 v171, v73, v162, v208
    v_cvt_pk_bf16_f32 v71, v174, v175
    v_dot2_f32_bf16 v172, v74, v161, v208
    v_dot2_f32_bf16 v173, v74, v162, v208
    v_cvt_pk_bf16_f32 v72, v168, v169
    v_dot2_f32_bf16 v174, v75, v161, v208
    v_dot2_f32_bf16 v175, v75, v162, v208
    v_cvt_pk_bf16_f32 v73, v170, v171
    v_dot2_f32_bf16 v168, v76, v161, v209
    v_dot2_f32_bf16 v169, v76, v162, v209
    v_cvt_pk_bf16_f32 v74, v172, v173
    v_dot2_f32_bf16 v170, v77, v161, v209
    v_dot2_f32_bf16 v171, v77, v162, v209
    v_cvt_pk_bf16_f32 v75, v174, v175
    v_dot2_f32_bf16 v172, v78, v161, v209
    v_dot2_f32_bf16 v173, v78, v162, v209
    v_cvt_pk_bf16_f32 v76, v168, v169
    v_dot2_f32_bf16 v174, v79, v161, v209
    v_dot2_f32_bf16 v175, v79, v162, v209
    v_cvt_pk_bf16_f32 v77, v170, v171
    s_nop 1
    v_cvt_pk_bf16_f32 v78, v172, v173
    s_nop 1
    v_cvt_pk_bf16_f32 v79, v174, v175
    s_barrier
    s_nop 0
    ds_read_b64_tr_b16 v[224:225], v248 offset:0
    ds_read_b64_tr_b16 v[226:227], v248 offset:512
    ds_read_b64_tr_b16 v[228:229], v249 offset:0
    ds_read_b64_tr_b16 v[230:231], v249 offset:512
    ds_read_b64_tr_b16 v[232:233], v250 offset:0
    ds_read_b64_tr_b16 v[234:235], v250 offset:512
    ds_read_b64_tr_b16 v[236:237], v251 offset:0
    ds_read_b64_tr_b16 v[238:239], v251 offset:512
    s_waitcnt lgkmcnt(6)
    s_bitcmp1_b32 s27, 0
    s_cbranch_scc0 K1_F0
    v_mfma_f32_16x16x32_bf16 v[176:179], v[224:227], v[0:3], 0
    ds_read_b64_tr_b16 v[240:241], v248 offset:4096
    v_lshlrev_b32 v210, 16, v80
    v_mfma_f32_16x16x32_bf16 v[180:183], v[224:227], v[4:7], 0
    s_waitcnt lgkmcnt(5)
    ds_read_b64_tr_b16 v[242:243], v248 offset:4608
    v_and_b32 v211, 0xffff0000, v80
    v_add_f32 v210, v210, v208
    v_add_f32 v211, v211, v208
    v_cvt_pk_bf16_f32 v80, v210, v211
    v_mfma_f32_16x16x32_bf16 v[184:187], v[228:231], v[0:3], 0
    ds_read_b64_tr_b16 v[244:245], v249 offset:4096
    v_lshlrev_b32 v212, 16, v81
    v_mfma_f32_16x16x32_bf16 v[188:191], v[228:231], v[4:7], 0
    s_waitcnt lgkmcnt(5)
    ds_read_b64_tr_b16 v[246:247], v249 offset:4608
    v_and_b32 v213, 0xffff0000, v81
    v_add_f32 v212, v212, v208
    v_add_f32 v213, v213, v208
    v_cvt_pk_bf16_f32 v81, v212, v213
    v_mfma_f32_16x16x32_bf16 v[192:195], v[232:235], v[0:3], 0
    ds_read_b64_tr_b16 v[224:225], v250 offset:4096
    v_lshlrev_b32 v214, 16, v82
    v_mfma_f32_16x16x32_bf16 v[196:199], v[232:235], v[4:7], 0
    s_waitcnt lgkmcnt(5)
    ds_read_b64_tr_b16 v[226:227], v250 offset:4608
    v_and_b32 v215, 0xffff0000, v82
    v_add_f32 v214, v214, v208
    v_add_f32 v215, v215, v208
    v_mfma_f32_16x16x32_bf16 v[200:203], v[236:239], v[0:3], 0
    ds_read_b64_tr_b16 v[228:229], v251 offset:4096
    v_cvt_pk_bf16_f32 v82, v214, v215
    v_mfma_f32_16x16x32_bf16 v[204:207], v[236:239], v[4:7], 0
    s_waitcnt lgkmcnt(5)
    ds_read_b64_tr_b16 v[230:231], v251 offset:4608
    v_lshlrev_b32 v216, 16, v83
    v_and_b32 v217, 0xffff0000, v83
    v_add_f32 v216, v216, v208
    v_add_f32 v217, v217, v208
    v_mfma_f32_16x16x32_bf16 v[176:179], v[240:243], v[8:11], v[176:179]
    ds_read_b64_tr_b16 v[232:233], v248 offset:8192
    v_cvt_pk_bf16_f32 v83, v216, v217
    v_mfma_f32_16x16x32_bf16 v[180:183], v[240:243], v[12:15], v[180:183]
    s_waitcnt lgkmcnt(5)
    ds_read_b64_tr_b16 v[234:235], v248 offset:8704
    v_lshlrev_b32 v210, 16, v84
    v_and_b32 v211, 0xffff0000, v84
    v_add_f32 v210, v210, v209
    v_add_f32 v211, v211, v209
    v_mfma_f32_16x16x32_bf16 v[184:187], v[244:247], v[8:11], v[184:187]
    ds_read_b64_tr_b16 v[236:237], v249 offset:8192
    v_cvt_pk_bf16_f32 v84, v210, v211
    v_mfma_f32_16x16x32_bf16 v[188:191], v[244:247], v[12:15], v[188:191]
    s_waitcnt lgkmcnt(5)
    ds_read_b64_tr_b16 v[238:239], v249 offset:8704
    v_lshlrev_b32 v212, 16, v85
    v_and_b32 v213, 0xffff0000, v85
    v_add_f32 v212, v212, v209
    v_add_f32 v213, v213, v209
    v_mfma_f32_16x16x32_bf16 v[192:195], v[224:227], v[8:11], v[192:195]
    ds_read_b64_tr_b16 v[240:241], v250 offset:8192
    v_cvt_pk_bf16_f32 v85, v212, v213
    v_mfma_f32_16x16x32_bf16 v[196:199], v[224:227], v[12:15], v[196:199]
    s_waitcnt lgkmcnt(5)
    ds_read_b64_tr_b16 v[242:243], v250 offset:8704
    v_lshlrev_b32 v214, 16, v86
    v_and_b32 v215, 0xffff0000, v86
    v_add_f32 v214, v214, v209
    v_mfma_f32_16x16x32_bf16 v[200:203], v[228:231], v[8:11], v[200:203]
    ds_read_b64_tr_b16 v[244:245], v251 offset:8192
    v_add_f32 v215, v215, v209
    v_mfma_f32_16x16x32_bf16 v[204:207], v[228:231], v[12:15], v[204:207]
    s_waitcnt lgkmcnt(5)
    ds_read_b64_tr_b16 v[246:247], v251 offset:8704
    v_cvt_pk_bf16_f32 v86, v214, v215
    v_lshlrev_b32 v216, 16, v87
    v_and_b32 v217, 0xffff0000, v87
    v_add_f32 v216, v216, v209
    v_mfma_f32_16x16x32_bf16 v[176:179], v[232:235], v[16:19], v[176:179]
    ds_read_b64_tr_b16 v[224:225], v248 offset:12288
    v_add_f32 v217, v217, v209
    v_mfma_f32_16x16x32_bf16 v[180:183], v[232:235], v[20:23], v[180:183]
    s_waitcnt lgkmcnt(5)
    ds_read_b64_tr_b16 v[226:227], v248 offset:12800
    v_cvt_pk_bf16_f32 v87, v216, v217
    v_lshlrev_b32 v210, 16, v88
    v_and_b32 v211, 0xffff0000, v88
    v_add_f32 v210, v210, v208
    v_mfma_f32_16x16x32_bf16 v[184:187], v[236:239], v[16:19], v[184:187]
    ds_read_b64_tr_b16 v[228:229], v249 offset:12288
    v_add_f32 v211, v211, v208
    v_mfma_f32_16x16x32_bf16 v[188:191], v[236:239], v[20:23], v[188:191]
    s_waitcnt lgkmcnt(5)
    ds_read_b64_tr_b16 v[230:231], v249 offset:12800
    v_cvt_pk_bf16_f32 v88, v210, v211
    v_lshlrev_b32 v212, 16, v89
    v_and_b32 v213, 0xffff0000, v89
    v_add_f32 v212, v212, v208
    v_mfma_f32_16x16x32_bf16 v[192:195], v[240:243], v[16:19], v[192:195]
    ds_read_b64_tr_b16 v[232:233], v250 offset:12288
    v_add_f32 v213, v213, v208
    v_mfma_f32_16x16x32_bf16 v[196:199], v[240:243], v[20:23], v[196:199]
    s_waitcnt lgkmcnt(5)
    ds_read_b64_tr_b16 v[234:235], v250 offset:12800
    v_cvt_pk_bf16_f32 v89, v212, v213
    v_lshlrev_b32 v214, 16, v90
    v_and_b32 v215, 0xffff0000, v90
    v_add_f32 v214, v214, v208
    v_mfma_f32_16x16x32_bf16 v[200:203], v[244:247], v[16:19], v[200:203]
    ds_read_b64_tr_b16 v[236:237], v251 offset:12288
    v_add_f32 v215, v215, v208
    v_mfma_f32_16x16x32_bf16 v[204:207], v[244:247], v[20:23], v[204:207]
    s_waitcnt lgkmcnt(5)
    ds_read_b64_tr_b16 v[238:239], v251 offset:12800
    v_cvt_pk_bf16_f32 v90, v214, v215
    v_lshlrev_b32 v216, 16, v91
    v_and_b32 v217, 0xffff0000, v91
    v_mfma_f32_16x16x32_bf16 v[176:179], v[224:227], v[24:27], v[176:179]
    ds_read_b64_tr_b16 v[240:241], v248 offset:16384
    v_add_f32 v216, v216, v208
    v_mfma_f32_16x16x32_bf16 v[180:183], v[224:227], v[28:31], v[180:183]
    s_waitcnt lgkmcnt(5)
    ds_read_b64_tr_b16 v[242:243], v248 offset:16896
    v_add_f32 v217, v217, v208
    v_cvt_pk_bf16_f32 v91, v216, v217
    v_lshlrev_b32 v210, 16, v92
    v_and_b32 v211, 0xffff0000, v92
    v_mfma_f32_16x16x32_bf16 v[184:187], v[228:231], v[24:27], v[184:187]
    ds_read_b64_tr_b16 v[244:245], v249 offset:16384
    v_add_f32 v210, v210, v209
    v_mfma_f32_16x16x32_bf16 v[188:191], v[228:231], v[28:31], v[188:191]
    s_waitcnt lgkmcnt(5)
    ds_read_b64_tr_b16 v[246:247], v249 offset:16896
    v_add_f32 v211, v211, v209
    v_cvt_pk_bf16_f32 v92, v210, v211
    v_lshlrev_b32 v212, 16, v93
    v_and_b32 v213, 0xffff0000, v93
    v_mfma_f32_16x16x32_bf16 v[192:195], v[232:235], v[24:27], v[192:195]
    ds_read_b64_tr_b16 v[224:225], v250 offset:16384
    v_add_f32 v212, v212, v209
    v_mfma_f32_16x16x32_bf16 v[196:199], v[232:235], v[28:31], v[196:199]
    s_waitcnt lgkmcnt(5)
    ds_read_b64_tr_b16 v[226:227], v250 offset:16896
    v_add_f32 v213, v213, v209
    v_cvt_pk_bf16_f32 v93, v212, v213
    v_lshlrev_b32 v214, 16, v94
    v_and_b32 v215, 0xffff0000, v94
    v_mfma_f32_16x16x32_bf16 v[200:203], v[236:239], v[24:27], v[200:203]
    ds_read_b64_tr_b16 v[228:229], v251 offset:16384
    v_add_f32 v214, v214, v209
    v_mfma_f32_16x16x32_bf16 v[204:207], v[236:239], v[28:31], v[204:207]
    s_waitcnt lgkmcnt(5)
    ds_read_b64_tr_b16 v[230:231], v251 offset:16896
    v_add_f32 v215, v215, v209
    v_cvt_pk_bf16_f32 v94, v214, v215
    v_lshlrev_b32 v216, 16, v95
    v_mfma_f32_16x16x32_bf16 v[176:179], v[240:243], v[32:35], v[176:179]
    ds_read_b64_tr_b16 v[232:233], v248 offset:20480
    v_and_b32 v217, 0xffff0000, v95
    v_mfma_f32_16x16x32_bf16 v[180:183], v[240:243], v[36:39], v[180:183]
    s_waitcnt lgkmcnt(5)
    ds_read_b64_tr_b16 v[234:235], v248 offset:20992
    v_add_f32 v216, v216, v209
    v_add_f32 v217, v217, v209
    v_cvt_pk_bf16_f32 v95, v216, v217
    v_lshlrev_b32 v210, 16, v96
    v_mfma_f32_16x16x32_bf16 v[184:187], v[244:247], v[32:35], v[184:187]
    ds_read_b64_tr_b16 v[236:237], v249 offset:20480
    v_and_b32 v211, 0xffff0000, v96
    v_mfma_f32_16x16x32_bf16 v[188:191], v[244:247], v[36:39], v[188:191]
    s_waitcnt lgkmcnt(5)
    ds_read_b64_tr_b16 v[238:239], v249 offset:20992
    v_add_f32 v210, v210, v208
    v_add_f32 v211, v211, v208
    v_cvt_pk_bf16_f32 v96, v210, v211
    v_lshlrev_b32 v212, 16, v97
    v_mfma_f32_16x16x32_bf16 v[192:195], v[224:227], v[32:35], v[192:195]
    ds_read_b64_tr_b16 v[240:241], v250 offset:20480
    v_and_b32 v213, 0xffff0000, v97
    v_mfma_f32_16x16x32_bf16 v[196:199], v[224:227], v[36:39], v[196:199]
    s_waitcnt lgkmcnt(5)
    ds_read_b64_tr_b16 v[242:243], v250 offset:20992
    v_add_f32 v212, v212, v208
    v_add_f32 v213, v213, v208
    v_cvt_pk_bf16_f32 v97, v212, v213
    v_lshlrev_b32 v214, 16, v98
    v_mfma_f32_16x16x32_bf16 v[200:203], v[228:231], v[32:35], v[200:203]
    ds_read_b64_tr_b16 v[244:245], v251 offset:20480
    v_and_b32 v215, 0xffff0000, v98
    v_mfma_f32_16x16x32_bf16 v[204:207], v[228:231], v[36:39], v[204:207]
    s_waitcnt lgkmcnt(5)
    ds_read_b64_tr_b16 v[246:247], v251 offset:20992
    v_add_f32 v214, v214, v208
    v_add_f32 v215, v215, v208
    v_cvt_pk_bf16_f32 v98, v214, v215
    v_lshlrev_b32 v216, 16, v99
    v_mfma_f32_16x16x32_bf16 v[176:179], v[232:235], v[40:43], v[176:179]
    s_barrier
    ds_read_b64_tr_b16 v[224:225], v248 offset:24576
    v_and_b32 v217, 0xffff0000, v99
    v_mfma_f32_16x16x32_bf16 v[180:183], v[232:235], v[44:47], v[180:183]
    s_waitcnt lgkmcnt(5)
    ds_read_b64_tr_b16 v[226:227], v248 offset:25088
    v_add_f32 v216, v216, v208
    v_add_f32 v217, v217, v208
    v_cvt_pk_bf16_f32 v99, v216, v217
    v_mfma_f32_16x16x32_bf16 v[184:187], v[236:239], v[40:43], v[184:187]
    ds_read_b64_tr_b16 v[228:229], v249 offset:24576
    v_lshlrev_b32 v210, 16, v100
    v_mfma_f32_16x16x32_bf16 v[188:191], v[236:239], v[44:47], v[188:191]
    s_waitcnt lgkmcnt(5)
    ds_read_b64_tr_b16 v[230:231], v249 offset:25088
    v_and_b32 v211, 0xffff0000, v100
    v_add_f32 v210, v210, v209
    v_add_f32 v211, v211, v209
    v_cvt_pk_bf16_f32 v100, v210, v211
    v_mfma_f32_16x16x32_bf16 v[192:195], v[240:243], v[40:43], v[192:195]
    ds_read_b64_tr_b16 v[232:233], v250 offset:24576
    v_lshlrev_b32 v212, 16, v101
    v_mfma_f32_16x16x32_bf16 v[196:199], v[240:243], v[44:47], v[196:199]
    s_waitcnt lgkmcnt(5)
    ds_read_b64_tr_b16 v[234:235], v250 offset:25088
    v_and_b32 v213, 0xffff0000, v101
    v_add_f32 v212, v212, v209
    v_add_f32 v213, v213, v209
    v_cvt_pk_bf16_f32 v101, v212, v213
    v_mfma_f32_16x16x32_bf16 v[200:203], v[244:247], v[40:43], v[200:203]
    ds_read_b64_tr_b16 v[236:237], v251 offset:24576
    v_lshlrev_b32 v214, 16, v102
    v_mfma_f32_16x16x32_bf16 v[204:207], v[244:247], v[44:47], v[204:207]
    s_waitcnt lgkmcnt(5)
    ds_read_b64_tr_b16 v[238:239], v251 offset:25088
    v_and_b32 v215, 0xffff0000, v102
    v_add_f32 v214, v214, v209
    v_add_f32 v215, v215, v209
    v_cvt_pk_bf16_f32 v102, v214, v215
    v_mfma_f32_16x16x32_bf16 v[176:179], v[224:227], v[48:51], v[176:179]
    ds_read_b64_tr_b16 v[240:241], v248 offset:28672
    v_lshlrev_b32 v216, 16, v103
    v_mfma_f32_16x16x32_bf16 v[180:183], v[224:227], v[52:55], v[180:183]
    s_waitcnt lgkmcnt(5)
    ds_read_b64_tr_b16 v[242:243], v248 offset:29184
    v_and_b32 v217, 0xffff0000, v103
    v_add_f32 v216, v216, v209
    v_add_f32 v217, v217, v209
    v_cvt_pk_bf16_f32 v103, v216, v217
    v_mfma_f32_16x16x32_bf16 v[184:187], v[228:231], v[48:51], v[184:187]
    ds_read_b64_tr_b16 v[244:245], v249 offset:28672
    v_lshlrev_b32 v210, 16, v104
    v_mfma_f32_16x16x32_bf16 v[188:191], v[228:231], v[52:55], v[188:191]
    s_waitcnt lgkmcnt(5)
    ds_read_b64_tr_b16 v[246:247], v249 offset:29184
    v_and_b32 v211, 0xffff0000, v104
    v_add_f32 v210, v210, v208
    v_add_f32 v211, v211, v208
    v_cvt_pk_bf16_f32 v104, v210, v211
    v_mfma_f32_16x16x32_bf16 v[192:195], v[232:235], v[48:51], v[192:195]
    ds_read_b64_tr_b16 v[224:225], v250 offset:28672
    v_lshlrev_b32 v212, 16, v105
    v_mfma_f32_16x16x32_bf16 v[196:199], v[232:235], v[52:55], v[196:199]
    s_waitcnt lgkmcnt(5)
    ds_read_b64_tr_b16 v[226:227], v250 offset:29184
    v_and_b32 v213, 0xffff0000, v105
    v_add_f32 v212, v212, v208
    v_add_f32 v213, v213, v208
    v_cvt_pk_bf16_f32 v105, v212, v213
    v_mfma_f32_16x16x32_bf16 v[200:203], v[236:239], v[48:51], v[200:203]
    ds_read_b64_tr_b16 v[228:229], v251 offset:28672
    v_lshlrev_b32 v214, 16, v106
    v_mfma_f32_16x16x32_bf16 v[204:207], v[236:239], v[52:55], v[204:207]
    s_waitcnt lgkmcnt(5)
    ds_read_b64_tr_b16 v[230:231], v251 offset:29184
    v_and_b32 v215, 0xffff0000, v106
    v_add_f32 v214, v214, v208
    v_add_f32 v215, v215, v208
    v_cvt_pk_bf16_f32 v106, v214, v215
    v_mfma_f32_16x16x32_bf16 v[176:179], v[240:243], v[56:59], v[176:179]
    ds_read_b64_tr_b16 v[232:233], v248 offset:32768
    v_lshlrev_b32 v216, 16, v107
    v_mfma_f32_16x16x32_bf16 v[180:183], v[240:243], v[60:63], v[180:183]
    s_waitcnt lgkmcnt(5)
    ds_read_b64_tr_b16 v[234:235], v248 offset:33280
    v_and_b32 v217, 0xffff0000, v107
    v_add_f32 v216, v216, v208
    v_add_f32 v217, v217, v208
    v_add_u32 v248, 36864, v248
    v_mfma_f32_16x16x32_bf16 v[184:187], v[244:247], v[56:59], v[184:187]
    ds_read_b64_tr_b16 v[236:237], v249 offset:32768
    v_cvt_pk_bf16_f32 v107, v216, v217
    v_mfma_f32_16x16x32_bf16 v[188:191], v[244:247], v[60:63], v[188:191]
    s_waitcnt lgkmcnt(5)
    ds_read_b64_tr_b16 v[238:239], v249 offset:33280
    v_lshlrev_b32 v210, 16, v108
    v_and_b32 v211, 0xffff0000, v108
    v_add_f32 v210, v210, v209
    v_add_u32 v249, 36864, v249
    v_mfma_f32_16x16x32_bf16 v[192:195], v[224:227], v[56:59], v[192:195]
    ds_read_b64_tr_b16 v[240:241], v250 offset:32768
    v_add_f32 v211, v211, v209
    v_mfma_f32_16x16x32_bf16 v[196:199], v[224:227], v[60:63], v[196:199]
    s_waitcnt lgkmcnt(5)
    ds_read_b64_tr_b16 v[242:243], v250 offset:33280
    v_cvt_pk_bf16_f32 v108, v210, v211
    v_lshlrev_b32 v212, 16, v109
    v_and_b32 v213, 0xffff0000, v109
    v_add_u32 v250, 36864, v250
    v_mfma_f32_16x16x32_bf16 v[200:203], v[228:231], v[56:59], v[200:203]
    ds_read_b64_tr_b16 v[244:245], v251 offset:32768
    v_add_f32 v212, v212, v209
    v_mfma_f32_16x16x32_bf16 v[204:207], v[228:231], v[60:63], v[204:207]
    s_waitcnt lgkmcnt(5)
    ds_read_b64_tr_b16 v[246:247], v251 offset:33280
    v_add_f32 v213, v213, v209
    v_cvt_pk_bf16_f32 v109, v212, v213
    v_lshlrev_b32 v214, 16, v110
    v_add_u32 v251, 36864, v251
    v_mfma_f32_16x16x32_bf16 v[176:179], v[232:235], v[64:67], v[176:179]
    ds_read_b64_tr_b16 v[224:225], v248 offset:0
    v_and_b32 v215, 0xffff0000, v110
    v_mfma_f32_16x16x32_bf16 v[180:183], v[232:235], v[68:71], v[180:183]
    s_waitcnt lgkmcnt(5)
    ds_read_b64_tr_b16 v[226:227], v248 offset:512
    v_add_f32 v214, v214, v209
    v_add_f32 v215, v215, v209
    v_cvt_pk_bf16_f32 v110, v214, v215
    v_lshlrev_b32 v216, 16, v111
    v_mfma_f32_16x16x32_bf16 v[184:187], v[236:239], v[64:67], v[184:187]
    ds_read_b64_tr_b16 v[228:229], v249 offset:0
    v_and_b32 v217, 0xffff0000, v111
    v_mfma_f32_16x16x32_bf16 v[188:191], v[236:239], v[68:71], v[188:191]
    s_waitcnt lgkmcnt(5)
    ds_read_b64_tr_b16 v[230:231], v249 offset:512
    v_add_f32 v216, v216, v209
    v_add_f32 v217, v217, v209
    v_cvt_pk_bf16_f32 v111, v216, v217
    v_lshlrev_b32 v210, 16, v112
    v_mfma_f32_16x16x32_bf16 v[192:195], v[240:243], v[64:67], v[192:195]
    ds_read_b64_tr_b16 v[232:233], v250 offset:0
    v_and_b32 v211, 0xffff0000, v112
    v_mfma_f32_16x16x32_bf16 v[196:199], v[240:243], v[68:71], v[196:199]
    s_waitcnt lgkmcnt(5)
    ds_read_b64_tr_b16 v[234:235], v250 offset:512
    v_add_f32 v210, v210, v208
    v_add_f32 v211, v211, v208
    v_cvt_pk_bf16_f32 v112, v210, v211
    v_lshlrev_b32 v212, 16, v113
    v_mfma_f32_16x16x32_bf16 v[200:203], v[244:247], v[64:67], v[200:203]
    ds_read_b64_tr_b16 v[236:237], v251 offset:0
    v_and_b32 v213, 0xffff0000, v113
    v_mfma_f32_16x16x32_bf16 v[204:207], v[244:247], v[68:71], v[204:207]
    s_waitcnt lgkmcnt(5)
    ds_read_b64_tr_b16 v[238:239], v251 offset:512
    v_add_f32 v212, v212, v208
    v_add_f32 v213, v213, v208
    v_cvt_pk_bf16_f32 v113, v212, v213
    v_lshlrev_b32 v214, 16, v114
    v_mfma_f32_16x16x32_bf16 v[176:179], v[224:227], v[72:75], v[176:179]
    ds_read_b64_tr_b16 v[240:241], v248 offset:4096
    v_and_b32 v215, 0xffff0000, v114
    v_mfma_f32_16x16x32_bf16 v[180:183], v[224:227], v[76:79], v[180:183]
    s_waitcnt lgkmcnt(5)
    ds_read_b64_tr_b16 v[242:243], v248 offset:4608
    v_add_f32 v214, v214, v208
    v_add_f32 v215, v215, v208
    v_cvt_pk_bf16_f32 v114, v214, v215
    v_lshlrev_b32 v216, 16, v115
    v_mfma_f32_16x16x32_bf16 v[184:187], v[228:231], v[72:75], v[184:187]
    ds_read_b64_tr_b16 v[244:245], v249 offset:4096
    v_and_b32 v217, 0xffff0000, v115
    v_mfma_f32_16x16x32_bf16 v[188:191], v[228:231], v[76:79], v[188:191]
    s_waitcnt lgkmcnt(5)
    ds_read_b64_tr_b16 v[246:247], v249 offset:4608
    v_add_f32 v216, v216, v208
    v_add_f32 v217, v217, v208
    v_cvt_pk_bf16_f32 v115, v216, v217
    v_lshlrev_b32 v210, 16, v116
    v_mfma_f32_16x16x32_bf16 v[192:195], v[232:235], v[72:75], v[192:195]
    ds_read_b64_tr_b16 v[224:225], v250 offset:4096
    v_and_b32 v211, 0xffff0000, v116
    v_mfma_f32_16x16x32_bf16 v[196:199], v[232:235], v[76:79], v[196:199]
    s_waitcnt lgkmcnt(5)
    ds_read_b64_tr_b16 v[226:227], v250 offset:4608
    v_add_f32 v210, v210, v209
    v_add_f32 v211, v211, v209
    v_cvt_pk_bf16_f32 v116, v210, v211
    v_lshlrev_b32 v212, 16, v117
    v_mfma_f32_16x16x32_bf16 v[200:203], v[236:239], v[72:75], v[200:203]
    ds_read_b64_tr_b16 v[228:229], v251 offset:4096
    v_and_b32 v213, 0xffff0000, v117
    v_mfma_f32_16x16x32_bf16 v[204:207], v[236:239], v[76:79], v[204:207]
    s_waitcnt lgkmcnt(5)
    ds_read_b64_tr_b16 v[230:231], v251 offset:4608
    v_add_f32 v212, v212, v209
    v_add_f32 v213, v213, v209
    v_cvt_pk_bf16_f32 v117, v212, v213
    v_lshlrev_b32 v214, 16, v118
    v_mfma_f32_16x16x32_bf16 v[176:179], v[240:243], v[80:83], v[176:179]
    ds_read_b64_tr_b16 v[232:233], v248 offset:8192
    v_and_b32 v215, 0xffff0000, v118
    v_mfma_f32_16x16x32_bf16 v[180:183], v[240:243], v[84:87], v[180:183]
    s_waitcnt lgkmcnt(5)
    ds_read_b64_tr_b16 v[234:235], v248 offset:8704
    v_add_f32 v214, v214, v209
    v_add_f32 v215, v215, v209
    v_cvt_pk_bf16_f32 v118, v214, v215
    v_lshlrev_b32 v216, 16, v119
    v_mfma_f32_16x16x32_bf16 v[184:187], v[244:247], v[80:83], v[184:187]
    ds_read_b64_tr_b16 v[236:237], v249 offset:8192
    v_and_b32 v217, 0xffff0000, v119
    v_mfma_f32_16x16x32_bf16 v[188:191], v[244:247], v[84:87], v[188:191]
    s_waitcnt lgkmcnt(5)
    ds_read_b64_tr_b16 v[238:239], v249 offset:8704
    v_add_f32 v216, v216, v209
    v_add_f32 v217, v217, v209
    v_cvt_pk_bf16_f32 v119, v216, v217
    v_lshlrev_b32 v210, 16, v120
    v_mfma_f32_16x16x32_bf16 v[192:195], v[224:227], v[80:83], v[192:195]
    ds_read_b64_tr_b16 v[240:241], v250 offset:8192
    v_and_b32 v211, 0xffff0000, v120
    v_mfma_f32_16x16x32_bf16 v[196:199], v[224:227], v[84:87], v[196:199]
    s_waitcnt lgkmcnt(5)
    ds_read_b64_tr_b16 v[242:243], v250 offset:8704
    v_add_f32 v210, v210, v208
    v_add_f32 v211, v211, v208
    v_cvt_pk_bf16_f32 v120, v210, v211
    v_lshlrev_b32 v212, 16, v121
    v_mfma_f32_16x16x32_bf16 v[200:203], v[228:231], v[80:83], v[200:203]
    ds_read_b64_tr_b16 v[244:245], v251 offset:8192
    v_and_b32 v213, 0xffff0000, v121
    v_mfma_f32_16x16x32_bf16 v[204:207], v[228:231], v[84:87], v[204:207]
    s_waitcnt lgkmcnt(5)
    ds_read_b64_tr_b16 v[246:247], v251 offset:8704
    v_add_f32 v212, v212, v208
    v_add_f32 v213, v213, v208
    v_cvt_pk_bf16_f32 v121, v212, v213
    v_lshlrev_b32 v214, 16, v122
    v_mfma_f32_16x16x32_bf16 v[176:179], v[232:235], v[88:91], v[176:179]
    s_barrier
    ds_read_b64_tr_b16 v[224:225], v248 offset:12288
    v_and_b32 v215, 0xffff0000, v122
    v_mfma_f32_16x16x32_bf16 v[180:183], v[232:235], v[92:95], v[180:183]
    s_waitcnt lgkmcnt(5)
    ds_read_b64_tr_b16 v[226:227], v248 offset:12800
    v_add_f32 v214, v214, v208
    v_add_f32 v215, v215, v208
    v_cvt_pk_bf16_f32 v122, v214, v215
    v_mfma_f32_16x16x32_bf16 v[184:187], v[236:239], v[88:91], v[184:187]
    ds_read_b64_tr_b16 v[228:229], v249 offset:12288
    v_lshlrev_b32 v216, 16, v123
    v_mfma_f32_16x16x32_bf16 v[188:191], v[236:239], v[92:95], v[188:191]
    s_waitcnt lgkmcnt(5)
    ds_read_b64_tr_b16 v[230:231], v249 offset:12800
    v_and_b32 v217, 0xffff0000, v123
    v_add_f32 v216, v216, v208
    v_add_f32 v217, v217, v208
    v_cvt_pk_bf16_f32 v123, v216, v217
    v_mfma_f32_16x16x32_bf16 v[192:195], v[240:243], v[88:91], v[192:195]
    ds_read_b64_tr_b16 v[232:233], v250 offset:12288
    v_lshlrev_b32 v210, 16, v124
    v_mfma_f32_16x16x32_bf16 v[196:199], v[240:243], v[92:95], v[196:199]
    s_waitcnt lgkmcnt(5)
    ds_read_b64_tr_b16 v[234:235], v250 offset:12800
    v_and_b32 v211, 0xffff0000, v124
    v_add_f32 v210, v210, v209
    v_add_f32 v211, v211, v209
    v_mfma_f32_16x16x32_bf16 v[200:203], v[244:247], v[88:91], v[200:203]
    ds_read_b64_tr_b16 v[236:237], v251 offset:12288
    v_cvt_pk_bf16_f32 v124, v210, v211
    v_mfma_f32_16x16x32_bf16 v[204:207], v[244:247], v[92:95], v[204:207]
    s_waitcnt lgkmcnt(5)
    ds_read_b64_tr_b16 v[238:239], v251 offset:12800
    v_lshlrev_b32 v212, 16, v125
    v_and_b32 v213, 0xffff0000, v125
    v_add_f32 v212, v212, v209
    v_add_f32 v213, v213, v209
    v_mfma_f32_16x16x32_bf16 v[176:179], v[224:227], v[96:99], v[176:179]
    ds_read_b64_tr_b16 v[240:241], v248 offset:16384
    v_cvt_pk_bf16_f32 v125, v212, v213
    v_mfma_f32_16x16x32_bf16 v[180:183], v[224:227], v[100:103], v[180:183]
    s_waitcnt lgkmcnt(5)
    ds_read_b64_tr_b16 v[242:243], v248 offset:16896
    v_lshlrev_b32 v214, 16, v126
    v_and_b32 v215, 0xffff0000, v126
    v_add_f32 v214, v214, v209
    v_add_f32 v215, v215, v209
    v_mfma_f32_16x16x32_bf16 v[184:187], v[228:231], v[96:99], v[184:187]
    ds_read_b64_tr_b16 v[244:245], v249 offset:16384
    v_cvt_pk_bf16_f32 v126, v214, v215
    v_mfma_f32_16x16x32_bf16 v[188:191], v[228:231], v[100:103], v[188:191]
    s_waitcnt lgkmcnt(5)
    ds_read_b64_tr_b16 v[246:247], v249 offset:16896
    v_lshlrev_b32 v216, 16, v127
    v_and_b32 v217, 0xffff0000, v127
    v_add_f32 v216, v216, v209
    v_add_f32 v217, v217, v209
    v_mfma_f32_16x16x32_bf16 v[192:195], v[232:235], v[96:99], v[192:195]
    ds_read_b64_tr_b16 v[224:225], v250 offset:16384
    v_cvt_pk_bf16_f32 v127, v216, v217
    v_mfma_f32_16x16x32_bf16 v[196:199], v[232:235], v[100:103], v[196:199]
    s_waitcnt lgkmcnt(5)
    ds_read_b64_tr_b16 v[226:227], v250 offset:16896
    v_lshlrev_b32 v210, 16, v128
    v_and_b32 v211, 0xffff0000, v128
    v_add_f32 v210, v210, v208
    v_add_f32 v211, v211, v208
    v_mfma_f32_16x16x32_bf16 v[200:203], v[236:239], v[96:99], v[200:203]
    ds_read_b64_tr_b16 v[228:229], v251 offset:16384
    v_cvt_pk_bf16_f32 v128, v210, v211
    v_mfma_f32_16x16x32_bf16 v[204:207], v[236:239], v[100:103], v[204:207]
    s_waitcnt lgkmcnt(5)
    ds_read_b64_tr_b16 v[230:231], v251 offset:16896
    v_lshlrev_b32 v212, 16, v129
    v_and_b32 v213, 0xffff0000, v129
    v_add_f32 v212, v212, v208
    v_mfma_f32_16x16x32_bf16 v[176:179], v[240:243], v[104:107], v[176:179]
    ds_read_b64_tr_b16 v[232:233], v248 offset:20480
    v_add_f32 v213, v213, v208
    v_mfma_f32_16x16x32_bf16 v[180:183], v[240:243], v[108:111], v[180:183]
    s_waitcnt lgkmcnt(5)
    ds_read_b64_tr_b16 v[234:235], v248 offset:20992
    v_cvt_pk_bf16_f32 v129, v212, v213
    v_lshlrev_b32 v214, 16, v130
    v_and_b32 v215, 0xffff0000, v130
    v_add_f32 v214, v214, v208
    v_mfma_f32_16x16x32_bf16 v[184:187], v[244:247], v[104:107], v[184:187]
    ds_read_b64_tr_b16 v[236:237], v249 offset:20480
    v_add_f32 v215, v215, v208
    v_mfma_f32_16x16x32_bf16 v[188:191], v[244:247], v[108:111], v[188:191]
    s_waitcnt lgkmcnt(5)
    ds_read_b64_tr_b16 v[238:239], v249 offset:20992
    v_cvt_pk_bf16_f32 v130, v214, v215
    v_lshlrev_b32 v216, 16, v131
    v_and_b32 v217, 0xffff0000, v131
    v_add_f32 v216, v216, v208
    v_mfma_f32_16x16x32_bf16 v[192:195], v[224:227], v[104:107], v[192:195]
    ds_read_b64_tr_b16 v[240:241], v250 offset:20480
    v_add_f32 v217, v217, v208
    v_mfma_f32_16x16x32_bf16 v[196:199], v[224:227], v[108:111], v[196:199]
    s_waitcnt lgkmcnt(5)
    ds_read_b64_tr_b16 v[242:243], v250 offset:20992
    v_cvt_pk_bf16_f32 v131, v216, v217
    v_lshlrev_b32 v210, 16, v132
    v_and_b32 v211, 0xffff0000, v132
    v_add_f32 v210, v210, v209
    v_mfma_f32_16x16x32_bf16 v[200:203], v[228:231], v[104:107], v[200:203]
    ds_read_b64_tr_b16 v[244:245], v251 offset:20480
    v_add_f32 v211, v211, v209
    v_mfma_f32_16x16x32_bf16 v[204:207], v[228:231], v[108:111], v[204:207]
    s_waitcnt lgkmcnt(5)
    ds_read_b64_tr_b16 v[246:247], v251 offset:20992
    v_cvt_pk_bf16_f32 v132, v210, v211
    v_lshlrev_b32 v212, 16, v133
    v_and_b32 v213, 0xffff0000, v133
    v_add_f32 v212, v212, v209
    v_mfma_f32_16x16x32_bf16 v[176:179], v[232:235], v[112:115], v[176:179]
    ds_read_b64_tr_b16 v[224:225], v248 offset:24576
    v_add_f32 v213, v213, v209
    v_mfma_f32_16x16x32_bf16 v[180:183], v[232:235], v[116:119], v[180:183]
    s_waitcnt lgkmcnt(5)
    ds_read_b64_tr_b16 v[226:227], v248 offset:25088
    v_cvt_pk_bf16_f32 v133, v212, v213
    v_lshlrev_b32 v214, 16, v134
    v_and_b32 v215, 0xffff0000, v134
    v_add_f32 v214, v214, v209
    v_mfma_f32_16x16x32_bf16 v[184:187], v[236:239], v[112:115], v[184:187]
    ds_read_b64_tr_b16 v[228:229], v249 offset:24576
    v_add_f32 v215, v215, v209
    v_mfma_f32_16x16x32_bf16 v[188:191], v[236:239], v[116:119], v[188:191]
    s_waitcnt lgkmcnt(5)
    ds_read_b64_tr_b16 v[230:231], v249 offset:25088
    v_cvt_pk_bf16_f32 v134, v214, v215
    v_lshlrev_b32 v216, 16, v135
    v_and_b32 v217, 0xffff0000, v135
    v_add_f32 v216, v216, v209
    v_mfma_f32_16x16x32_bf16 v[192:195], v[240:243], v[112:115], v[192:195]
    ds_read_b64_tr_b16 v[232:233], v250 offset:24576
    v_add_f32 v217, v217, v209
    v_mfma_f32_16x16x32_bf16 v[196:199], v[240:243], v[116:119], v[196:199]
    s_waitcnt lgkmcnt(5)
    ds_read_b64_tr_b16 v[234:235], v250 offset:25088
    v_cvt_pk_bf16_f32 v135, v216, v217
    v_lshlrev_b32 v210, 16, v136
    v_and_b32 v211, 0xffff0000, v136
    v_add_f32 v210, v210, v208
    v_mfma_f32_16x16x32_bf16 v[200:203], v[244:247], v[112:115], v[200:203]
    ds_read_b64_tr_b16 v[236:237], v251 offset:24576
    v_add_f32 v211, v211, v208
    v_mfma_f32_16x16x32_bf16 v[204:207], v[244:247], v[116:119], v[204:207]
    s_waitcnt lgkmcnt(5)
    ds_read_b64_tr_b16 v[238:239], v251 offset:25088
    v_cvt_pk_bf16_f32 v136, v210, v211
    v_lshlrev_b32 v212, 16, v137
    v_and_b32 v213, 0xffff0000, v137
    v_add_f32 v212, v212, v208
    v_mfma_f32_16x16x32_bf16 v[176:179], v[224:227], v[120:123], v[176:179]
    ds_read_b64_tr_b16 v[240:241], v248 offset:28672
    v_add_f32 v213, v213, v208
    v_mfma_f32_16x16x32_bf16 v[180:183], v[224:227], v[124:127], v[180:183]
    s_waitcnt lgkmcnt(5)
    ds_read_b64_tr_b16 v[242:243], v248 offset:29184
    v_cvt_pk_bf16_f32 v137, v212, v213
    v_lshlrev_b32 v214, 16, v138
    v_and_b32 v215, 0xffff0000, v138
    v_add_f32 v214, v214, v208
    v_mfma_f32_16x16x32_bf16 v[184:187], v[228:231], v[120:123], v[184:187]
    ds_read_b64_tr_b16 v[244:245], v249 offset:28672
    v_add_f32 v215, v215, v208
    v_mfma_f32_16x16x32_bf16 v[188:191], v[228:231], v[124:127], v[188:191]
    s_waitcnt lgkmcnt(5)
    ds_read_b64_tr_b16 v[246:247], v249 offset:29184
    v_cvt_pk_bf16_f32 v138, v214, v215
    v_lshlrev_b32 v216, 16, v139
    v_and_b32 v217, 0xffff0000, v139
    v_add_f32 v216, v216, v208
    v_mfma_f32_16x16x32_bf16 v[192:195], v[232:235], v[120:123], v[192:195]
    ds_read_b64_tr_b16 v[224:225], v250 offset:28672
    v_add_f32 v217, v217, v208
    v_mfma_f32_16x16x32_bf16 v[196:199], v[232:235], v[124:127], v[196:199]
    s_waitcnt lgkmcnt(5)
    ds_read_b64_tr_b16 v[226:227], v250 offset:29184
    v_cvt_pk_bf16_f32 v139, v216, v217
    v_lshlrev_b32 v210, 16, v140
    v_and_b32 v211, 0xffff0000, v140
    v_add_f32 v210, v210, v209
    v_mfma_f32_16x16x32_bf16 v[200:203], v[236:239], v[120:123], v[200:203]
    ds_read_b64_tr_b16 v[228:229], v251 offset:28672
    v_add_f32 v211, v211, v209
    v_mfma_f32_16x16x32_bf16 v[204:207], v[236:239], v[124:127], v[204:207]
    s_waitcnt lgkmcnt(5)
    ds_read_b64_tr_b16 v[230:231], v251 offset:29184
    v_cvt_pk_bf16_f32 v140, v210, v211
    v_lshlrev_b32 v212, 16, v141
    v_and_b32 v213, 0xffff0000, v141
    v_add_f32 v212, v212, v209
    v_mfma_f32_16x16x32_bf16 v[176:179], v[240:243], v[128:131], v[176:179]
    ds_read_b64_tr_b16 v[232:233], v248 offset:32768
    v_add_f32 v213, v213, v209
    v_mfma_f32_16x16x32_bf16 v[180:183], v[240:243], v[132:135], v[180:183]
    s_waitcnt lgkmcnt(5)
    ds_read_b64_tr_b16 v[234:235], v248 offset:33280
    v_cvt_pk_bf16_f32 v141, v212, v213
    v_lshlrev_b32 v214, 16, v142
    v_and_b32 v215, 0xffff0000, v142
    v_add_u32 v248, -110592, v248
    v_mfma_f32_16x16x32_bf16 v[184:187], v[244:247], v[128:131], v[184:187]
    ds_read_b64_tr_b16 v[236:237], v249 offset:32768
    v_add_f32 v214, v214, v209
    v_mfma_f32_16x16x32_bf16 v[188:191], v[244:247], v[132:135], v[188:191]
    s_waitcnt lgkmcnt(5)
    ds_read_b64_tr_b16 v[238:239], v249 offset:33280
    v_add_f32 v215, v215, v209
    v_cvt_pk_bf16_f32 v142, v214, v215
    v_lshlrev_b32 v216, 16, v143
    v_add_u32 v249, -110592, v249
    v_mfma_f32_16x16x32_bf16 v[192:195], v[224:227], v[128:131], v[192:195]
    ds_read_b64_tr_b16 v[240:241], v250 offset:32768
    v_and_b32 v217, 0xffff0000, v143
    v_mfma_f32_16x16x32_bf16 v[196:199], v[224:227], v[132:135], v[196:199]
    s_waitcnt lgkmcnt(5)
    ds_read_b64_tr_b16 v[242:243], v250 offset:33280
    v_add_f32 v216, v216, v209
    v_add_f32 v217, v217, v209
    v_cvt_pk_bf16_f32 v143, v216, v217
    v_add_u32 v250, -110592, v250
    v_mfma_f32_16x16x32_bf16 v[200:203], v[228:231], v[128:131], v[200:203]
    ds_read_b64_tr_b16 v[244:245], v251 offset:32768
    ds_read_b64_tr_b16 v[246:247], v251 offset:33280
    v_mfma_f32_16x16x32_bf16 v[204:207], v[228:231], v[132:135], v[204:207]
    s_waitcnt lgkmcnt(6)
    v_add_u32 v251, -110592, v251
    v_mfma_f32_16x16x32_bf16 v[176:179], v[232:235], v[136:139], v[176:179]
    s_barrier
    ds_read_b64_tr_b16 v[224:225], v248 offset:0
    ds_read_b64_tr_b16 v[226:227], v248 offset:512
    v_mfma_f32_16x16x32_bf16 v[180:183], v[232:235], v[140:143], v[180:183]
    s_waitcnt lgkmcnt(6)
    v_mfma_f32_16x16x32_bf16 v[184:187], v[236:239], v[136:139], v[184:187]
    ds_read_b64_tr_b16 v[228:229], v249 offset:0
    ds_read_b64_tr_b16 v[230:231], v249 offset:512
    v_mfma_f32_16x16x32_bf16 v[188:191], v[236:239], v[140:143], v[188:191]
    s_waitcnt lgkmcnt(6)
    v_mfma_f32_16x16x32_bf16 v[192:195], v[240:243], v[136:139], v[192:195]
    ds_read_b64_tr_b16 v[232:233], v250 offset:0
    ds_read_b64_tr_b16 v[234:235], v250 offset:512
    v_mfma_f32_16x16x32_bf16 v[196:199], v[240:243], v[140:143], v[196:199]
    s_waitcnt lgkmcnt(6)
    v_mfma_f32_16x16x32_bf16 v[200:203], v[244:247], v[136:139], v[200:203]
    ds_read_b64_tr_b16 v[236:237], v251 offset:0
    ds_read_b64_tr_b16 v[238:239], v251 offset:512
    v_mfma_f32_16x16x32_bf16 v[204:207], v[244:247], v[140:143], v[204:207]
    s_waitcnt lgkmcnt(6)
K1_X10:
    v_mfma_f32_16x16x32_bf16 v[144:147], v[224:227], v[0:3], 0
    ds_read_b64_tr_b16 v[240:241], v248 offset:4096
    ds_read_b64_tr_b16 v[242:243], v248 offset:4608
    v_mfma_f32_16x16x32_bf16 v[148:151], v[224:227], v[4:7], 0
    s_waitcnt lgkmcnt(6)
    v_mfma_f32_16x16x32_bf16 v[152:155], v[228:231], v[0:3], 0
    ds_read_b64_tr_b16 v[244:245], v249 offset:4096
    ds_read_b64_tr_b16 v[246:247], v249 offset:4608
    v_mfma_f32_16x16x32_bf16 v[156:159], v[228:231], v[4:7], 0
    s_waitcnt lgkmcnt(6)
    v_mfma_f32_16x16x32_bf16 v[160:163], v[232:235], v[0:3], 0
    ds_read_b64_tr_b16 v[224:225], v250 offset:4096
    ds_read_b64_tr_b16 v[226:227], v250 offset:4608
    v_mfma_f32_16x16x32_bf16 v[164:167], v[232:235], v[4:7], 0
    s_waitcnt lgkmcnt(6)
    v_mfma_f32_16x16x32_bf16 v[168:171], v[236:239], v[0:3], 0
    ds_read_b64_tr_b16 v[228:229], v251 offset:4096
    ds_read_b64_tr_b16 v[230:231], v251 offset:4608
    v_mfma_f32_16x16x32_bf16 v[172:175], v[236:239], v[4:7], 0
    s_waitcnt lgkmcnt(6)
    s_mov_b32 s34, 0xbf317218
    v_mfma_f32_16x16x32_bf16 v[144:147], v[240:243], v[8:11], v[144:147]
    ds_read_b64_tr_b16 v[232:233], v248 offset:8192
    ds_read_b64_tr_b16 v[234:235], v248 offset:8704
    v_mfma_f32_16x16x32_bf16 v[148:151], v[240:243], v[12:15], v[148:151]
    s_waitcnt lgkmcnt(6)
    s_cmp_lt_u32 s43, 9
    s_cselect_b32 s33, 0xbe715bef, s34
    v_mfma_f32_16x16x32_bf16 v[152:155], v[244:247], v[8:11], v[152:155]
    ds_read_b64_tr_b16 v[236:237], v249 offset:8192
    ds_read_b64_tr_b16 v[238:239], v249 offset:8704
    v_mfma_f32_16x16x32_bf16 v[156:159], v[244:247], v[12:15], v[156:159]
    s_waitcnt lgkmcnt(6)
    v_mfma_f32_16x16x32_bf16 v[160:163], v[224:227], v[8:11], v[160:163]
    ds_read_b64_tr_b16 v[240:241], v250 offset:8192
    v_mfma_f32_16x16x32_bf16 v[164:167], v[224:227], v[12:15], v[164:167]
    s_waitcnt lgkmcnt(5)
    ds_read_b64_tr_b16 v[242:243], v250 offset:8704
    v_mul_f32 v218, s33, v252
    v_mfma_f32_16x16x32_bf16 v[168:171], v[228:231], v[8:11], v[168:171]
    ds_read_b64_tr_b16 v[244:245], v251 offset:8192
    v_mfma_f32_16x16x32_bf16 v[172:175], v[228:231], v[12:15], v[172:175]
    s_waitcnt lgkmcnt(5)
    ds_read_b64_tr_b16 v[246:247], v251 offset:8704
    v_mul_f32 v219, s33, v253
    v_mfma_f32_16x16x32_bf16 v[144:147], v[232:235], v[16:19], v[144:147]
    ds_read_b64_tr_b16 v[224:225], v248 offset:12288
    v_mfma_f32_16x16x32_bf16 v[148:151], v[232:235], v[20:23], v[148:151]
    s_waitcnt lgkmcnt(5)
    ds_read_b64_tr_b16 v[226:227], v248 offset:12800
    v_mul_f32 v176, v176, v218
    v_mfma_f32_16x16x32_bf16 v[152:155], v[236:239], v[16:19], v[152:155]
    ds_read_b64_tr_b16 v[228:229], v249 offset:12288
    v_mfma_f32_16x16x32_bf16 v[156:159], v[236:239], v[20:23], v[156:159]
    s_waitcnt lgkmcnt(5)
    ds_read_b64_tr_b16 v[230:231], v249 offset:12800
    v_mul_f32 v177, v177, v218
    v_mfma_f32_16x16x32_bf16 v[160:163], v[240:243], v[16:19], v[160:163]
    ds_read_b64_tr_b16 v[232:233], v250 offset:12288
    v_mfma_f32_16x16x32_bf16 v[164:167], v[240:243], v[20:23], v[164:167]
    s_waitcnt lgkmcnt(5)
    ds_read_b64_tr_b16 v[234:235], v250 offset:12800
    v_mul_f32 v178, v178, v218
    v_mfma_f32_16x16x32_bf16 v[168:171], v[244:247], v[16:19], v[168:171]
    ds_read_b64_tr_b16 v[236:237], v251 offset:12288
    v_mfma_f32_16x16x32_bf16 v[172:175], v[244:247], v[20:23], v[172:175]
    s_waitcnt lgkmcnt(5)
    ds_read_b64_tr_b16 v[238:239], v251 offset:12800
    v_mul_f32 v179, v179, v218
    v_mfma_f32_16x16x32_bf16 v[144:147], v[224:227], v[24:27], v[144:147]
    ds_read_b64_tr_b16 v[240:241], v248 offset:16384
    v_mfma_f32_16x16x32_bf16 v[148:151], v[224:227], v[28:31], v[148:151]
    s_waitcnt lgkmcnt(5)
    ds_read_b64_tr_b16 v[242:243], v248 offset:16896
    v_mul_f32 v180, v180, v219
    v_mfma_f32_16x16x32_bf16 v[152:155], v[228:231], v[24:27], v[152:155]
    ds_read_b64_tr_b16 v[244:245], v249 offset:16384
    v_mfma_f32_16x16x32_bf16 v[156:159], v[228:231], v[28:31], v[156:159]
    s_waitcnt lgkmcnt(5)
    ds_read_b64_tr_b16 v[246:247], v249 offset:16896
    v_mul_f32 v181, v181, v219
    v_mfma_f32_16x16x32_bf16 v[160:163], v[232:235], v[24:27], v[160:163]
    ds_read_b64_tr_b16 v[224:225], v250 offset:16384
    v_mfma_f32_16x16x32_bf16 v[164:167], v[232:235], v[28:31], v[164:167]
    s_waitcnt lgkmcnt(5)
    ds_read_b64_tr_b16 v[226:227], v250 offset:16896
    v_mul_f32 v182, v182, v219
    v_mfma_f32_16x16x32_bf16 v[168:171], v[236:239], v[24:27], v[168:171]
    ds_read_b64_tr_b16 v[228:229], v251 offset:16384
    v_mfma_f32_16x16x32_bf16 v[172:175], v[236:239], v[28:31], v[172:175]
    s_waitcnt lgkmcnt(5)
    ds_read_b64_tr_b16 v[230:231], v251 offset:16896
    v_mul_f32 v183, v183, v219
    v_mfma_f32_16x16x32_bf16 v[144:147], v[240:243], v[32:35], v[144:147]
    ds_read_b64_tr_b16 v[232:233], v248 offset:20480
    v_mfma_f32_16x16x32_bf16 v[148:151], v[240:243], v[36:39], v[148:151]
    s_waitcnt lgkmcnt(5)
    ds_read_b64_tr_b16 v[234:235], v248 offset:20992
    v_cvt_pk_bf16_f32 v176, v176, v177
    v_mfma_f32_16x16x32_bf16 v[152:155], v[244:247], v[32:35], v[152:155]
    ds_read_b64_tr_b16 v[236:237], v249 offset:20480
    v_mfma_f32_16x16x32_bf16 v[156:159], v[244:247], v[36:39], v[156:159]
    s_waitcnt lgkmcnt(5)
    ds_read_b64_tr_b16 v[238:239], v249 offset:20992
    v_cvt_pk_bf16_f32 v177, v178, v179
    v_mfma_f32_16x16x32_bf16 v[160:163], v[224:227], v[32:35], v[160:163]
    ds_read_b64_tr_b16 v[240:241], v250 offset:20480
    v_mfma_f32_16x16x32_bf16 v[164:167], v[224:227], v[36:39], v[164:167]
    s_waitcnt lgkmcnt(5)
    ds_read_b64_tr_b16 v[242:243], v250 offset:20992
    v_cvt_pk_bf16_f32 v178, v180, v181
    v_mfma_f32_16x16x32_bf16 v[168:171], v[228:231], v[32:35], v[168:171]
    ds_read_b64_tr_b16 v[244:245], v251 offset:20480
    v_mfma_f32_16x16x32_bf16 v[172:175], v[228:231], v[36:39], v[172:175]
    s_waitcnt lgkmcnt(5)
    ds_read_b64_tr_b16 v[246:247], v251 offset:20992
    v_cvt_pk_bf16_f32 v179, v182, v183
    v_mfma_f32_16x16x32_bf16 v[144:147], v[232:235], v[40:43], v[144:147]
    s_barrier
    ds_read_b64_tr_b16 v[224:225], v248 offset:24576
    v_mfma_f32_16x16x32_bf16 v[148:151], v[232:235], v[44:47], v[148:151]
    s_waitcnt lgkmcnt(5)
    ds_read_b64_tr_b16 v[226:227], v248 offset:25088
    v_mul_f32 v184, v184, v218
    v_mfma_f32_16x16x32_bf16 v[152:155], v[236:239], v[40:43], v[152:155]
    ds_read_b64_tr_b16 v[228:229], v249 offset:24576
    v_mfma_f32_16x16x32_bf16 v[156:159], v[236:239], v[44:47], v[156:159]
    s_waitcnt lgkmcnt(5)
    ds_read_b64_tr_b16 v[230:231], v249 offset:25088
    v_mul_f32 v185, v185, v218
    v_mfma_f32_16x16x32_bf16 v[160:163], v[240:243], v[40:43], v[160:163]
    ds_read_b64_tr_b16 v[232:233], v250 offset:24576
    v_mfma_f32_16x16x32_bf16 v[164:167], v[240:243], v[44:47], v[164:167]
    s_waitcnt lgkmcnt(5)
    ds_read_b64_tr_b16 v[234:235], v250 offset:25088
    v_mul_f32 v186, v186, v218
    v_mfma_f32_16x16x32_bf16 v[168:171], v[244:247], v[40:43], v[168:171]
    ds_read_b64_tr_b16 v[236:237], v251 offset:24576
    v_mfma_f32_16x16x32_bf16 v[172:175], v[244:247], v[44:47], v[172:175]
    s_waitcnt lgkmcnt(5)
    ds_read_b64_tr_b16 v[238:239], v251 offset:25088
    v_mul_f32 v187, v187, v218
    v_mfma_f32_16x16x32_bf16 v[144:147], v[224:227], v[48:51], v[144:147]
    ds_read_b64_tr_b16 v[240:241], v248 offset:28672
    v_mfma_f32_16x16x32_bf16 v[148:151], v[224:227], v[52:55], v[148:151]
    s_waitcnt lgkmcnt(5)
    ds_read_b64_tr_b16 v[242:243], v248 offset:29184
    v_permlane16_swap_b32 v176, v178
    v_mfma_f32_16x16x32_bf16 v[152:155], v[228:231], v[48:51], v[152:155]
    ds_read_b64_tr_b16 v[244:245], v249 offset:28672
    v_mfma_f32_16x16x32_bf16 v[156:159], v[228:231], v[52:55], v[156:159]
    s_waitcnt lgkmcnt(5)
    ds_read_b64_tr_b16 v[246:247], v249 offset:29184
    v_permlane16_swap_b32 v177, v179
    v_mfma_f32_16x16x32_bf16 v[160:163], v[232:235], v[48:51], v[160:163]
    ds_read_b64_tr_b16 v[224:225], v250 offset:28672
    ds_read_b64_tr_b16 v[226:227], v250 offset:29184
    v_mfma_f32_16x16x32_bf16 v[164:167], v[232:235], v[52:55], v[164:167]
    s_waitcnt lgkmcnt(6)
    buffer_store_dwordx4 v[176:179], v254, s[20:23], s42 offen offset:0 sc1
    v_mfma_f32_16x16x32_bf16 v[168:171], v[236:239], v[48:51], v[168:171]
    ds_read_b64_tr_b16 v[228:229], v251 offset:28672
    v_mfma_f32_16x16x32_bf16 v[172:175], v[236:239], v[52:55], v[172:175]
    s_waitcnt lgkmcnt(5)
    ds_read_b64_tr_b16 v[230:231], v251 offset:29184
    v_mul_f32 v188, v188, v219
    v_mfma_f32_16x16x32_bf16 v[144:147], v[240:243], v[56:59], v[144:147]
    ds_read_b64_tr_b16 v[232:233], v248 offset:32768
    ds_read_b64_tr_b16 v[234:235], v248 offset:33280
    v_mfma_f32_16x16x32_bf16 v[148:151], v[240:243], v[60:63], v[148:151]
    s_waitcnt lgkmcnt(6)
    v_mul_f32 v189, v189, v219
    v_add_u32 v248, 36864, v248
    v_mfma_f32_16x16x32_bf16 v[152:155], v[244:247], v[56:59], v[152:155]
    ds_read_b64_tr_b16 v[236:237], v249 offset:32768
    ds_read_b64_tr_b16 v[238:239], v249 offset:33280
    v_mfma_f32_16x16x32_bf16 v[156:159], v[244:247], v[60:63], v[156:159]
    s_waitcnt lgkmcnt(6)
    v_mul_f32 v190, v190, v219
    v_add_u32 v249, 36864, v249
    v_mfma_f32_16x16x32_bf16 v[160:163], v[224:227], v[56:59], v[160:163]
    ds_read_b64_tr_b16 v[240:241], v250 offset:32768
    ds_read_b64_tr_b16 v[242:243], v250 offset:33280
    v_mfma_f32_16x16x32_bf16 v[164:167], v[224:227], v[60:63], v[164:167]
    s_waitcnt lgkmcnt(6)
    v_mul_f32 v191, v191, v219
    v_add_u32 v250, 36864, v250
    v_mfma_f32_16x16x32_bf16 v[168:171], v[228:231], v[56:59], v[168:171]
    ds_read_b64_tr_b16 v[244:245], v251 offset:32768
    ds_read_b64_tr_b16 v[246:247], v251 offset:33280
    v_mfma_f32_16x16x32_bf16 v[172:175], v[228:231], v[60:63], v[172:175]
    s_waitcnt lgkmcnt(6)
    v_cvt_pk_bf16_f32 v184, v184, v185
    v_add_u32 v251, 36864, v251
    v_mfma_f32_16x16x32_bf16 v[144:147], v[232:235], v[64:67], v[144:147]
    ds_read_b64_tr_b16 v[224:225], v248 offset:0
    v_mfma_f32_16x16x32_bf16 v[148:151], v[232:235], v[68:71], v[148:151]
    s_waitcnt lgkmcnt(5)
    ds_read_b64_tr_b16 v[226:227], v248 offset:512
    v_cvt_pk_bf16_f32 v185, v186, v187
    v_mfma_f32_16x16x32_bf16 v[152:155], v[236:239], v[64:67], v[152:155]
    ds_read_b64_tr_b16 v[228:229], v249 offset:0
    v_mfma_f32_16x16x32_bf16 v[156:159], v[236:239], v[68:71], v[156:159]
    s_waitcnt lgkmcnt(5)
    ds_read_b64_tr_b16 v[230:231], v249 offset:512
    v_cvt_pk_bf16_f32 v186, v188, v189
    v_mfma_f32_16x16x32_bf16 v[160:163], v[240:243], v[64:67], v[160:163]
    ds_read_b64_tr_b16 v[232:233], v250 offset:0
    v_mfma_f32_16x16x32_bf16 v[164:167], v[240:243], v[68:71], v[164:167]
    s_waitcnt lgkmcnt(5)
    ds_read_b64_tr_b16 v[234:235], v250 offset:512
    v_cvt_pk_bf16_f32 v187, v190, v191
    v_mfma_f32_16x16x32_bf16 v[168:171], v[244:247], v[64:67], v[168:171]
    ds_read_b64_tr_b16 v[236:237], v251 offset:0
    v_mfma_f32_16x16x32_bf16 v[172:175], v[244:247], v[68:71], v[172:175]
    s_waitcnt lgkmcnt(5)
    ds_read_b64_tr_b16 v[238:239], v251 offset:512
    v_mul_f32 v192, v192, v218
    v_mfma_f32_16x16x32_bf16 v[144:147], v[224:227], v[72:75], v[144:147]
    ds_read_b64_tr_b16 v[240:241], v248 offset:4096
    ds_read_b64_tr_b16 v[242:243], v248 offset:4608
    v_mfma_f32_16x16x32_bf16 v[148:151], v[224:227], v[76:79], v[148:151]
    s_waitcnt lgkmcnt(6)
    v_mul_f32 v193, v193, v218
    v_mul_f32 v194, v194, v218
    v_mfma_f32_16x16x32_bf16 v[152:155], v[228:231], v[72:75], v[152:155]
    ds_read_b64_tr_b16 v[244:245], v249 offset:4096
    v_mfma_f32_16x16x32_bf16 v[156:159], v[228:231], v[76:79], v[156:159]
    s_waitcnt lgkmcnt(5)
    ds_read_b64_tr_b16 v[246:247], v249 offset:4608
    v_mul_f32 v195, v195, v218
    v_mfma_f32_16x16x32_bf16 v[160:163], v[232:235], v[72:75], v[160:163]
    ds_read_b64_tr_b16 v[224:225], v250 offset:4096
    v_mfma_f32_16x16x32_bf16 v[164:167], v[232:235], v[76:79], v[164:167]
    s_waitcnt lgkmcnt(5)
    ds_read_b64_tr_b16 v[226:227], v250 offset:4608
    v_permlane16_swap_b32 v184, v186
    v_mfma_f32_16x16x32_bf16 v[168:171], v[236:239], v[72:75], v[168:171]
    ds_read_b64_tr_b16 v[228:229], v251 offset:4096
    v_mfma_f32_16x16x32_bf16 v[172:175], v[236:239], v[76:79], v[172:175]
    s_waitcnt lgkmcnt(5)
    ds_read_b64_tr_b16 v[230:231], v251 offset:4608
    v_permlane16_swap_b32 v185, v187
    v_mfma_f32_16x16x32_bf16 v[144:147], v[240:243], v[80:83], v[144:147]
    ds_read_b64_tr_b16 v[232:233], v248 offset:8192
    ds_read_b64_tr_b16 v[234:235], v248 offset:8704
    v_mfma_f32_16x16x32_bf16 v[148:151], v[240:243], v[84:87], v[148:151]
    s_waitcnt lgkmcnt(6)
    buffer_store_dwordx4 v[184:187], v254, s[20:23], s42 offen offset:1024 sc1
    v_mfma_f32_16x16x32_bf16 v[152:155], v[244:247], v[80:83], v[152:155]
    ds_read_b64_tr_b16 v[236:237], v249 offset:8192
    v_mfma_f32_16x16x32_bf16 v[156:159], v[244:247], v[84:87], v[156:159]
    s_waitcnt lgkmcnt(5)
    ds_read_b64_tr_b16 v[238:239], v249 offset:8704
    v_mul_f32 v196, v196, v219
    v_mfma_f32_16x16x32_bf16 v[160:163], v[224:227], v[80:83], v[160:163]
    ds_read_b64_tr_b16 v[240:241], v250 offset:8192
    v_mfma_f32_16x16x32_bf16 v[164:167], v[224:227], v[84:87], v[164:167]
    s_waitcnt lgkmcnt(5)
    ds_read_b64_tr_b16 v[242:243], v250 offset:8704
    v_mul_f32 v197, v197, v219
    v_mfma_f32_16x16x32_bf16 v[168:171], v[228:231], v[80:83], v[168:171]
    ds_read_b64_tr_b16 v[244:245], v251 offset:8192
    v_mfma_f32_16x16x32_bf16 v[172:175], v[228:231], v[84:87], v[172:175]
    s_waitcnt lgkmcnt(5)
    ds_read_b64_tr_b16 v[246:247], v251 offset:8704
    v_mul_f32 v198, v198, v219
    v_mfma_f32_16x16x32_bf16 v[144:147], v[232:235], v[88:91], v[144:147]
    s_barrier
    ds_read_b64_tr_b16 v[224:225], v248 offset:12288
    v_mfma_f32_16x16x32_bf16 v[148:151], v[232:235], v[92:95], v[148:151]
    s_waitcnt lgkmcnt(5)
    ds_read_b64_tr_b16 v[226:227], v248 offset:12800
    v_mul_f32 v199, v199, v219
    v_mfma_f32_16x16x32_bf16 v[152:155], v[236:239], v[88:91], v[152:155]
    ds_read_b64_tr_b16 v[228:229], v249 offset:12288
    v_mfma_f32_16x16x32_bf16 v[156:159], v[236:239], v[92:95], v[156:159]
    s_waitcnt lgkmcnt(5)
    ds_read_b64_tr_b16 v[230:231], v249 offset:12800
    v_cvt_pk_bf16_f32 v192, v192, v193
    v_mfma_f32_16x16x32_bf16 v[160:163], v[240:243], v[88:91], v[160:163]
    ds_read_b64_tr_b16 v[232:233], v250 offset:12288
    v_mfma_f32_16x16x32_bf16 v[164:167], v[240:243], v[92:95], v[164:167]
    s_waitcnt lgkmcnt(5)
    ds_read_b64_tr_b16 v[234:235], v250 offset:12800
    v_cvt_pk_bf16_f32 v193, v194, v195
    v_mfma_f32_16x16x32_bf16 v[168:171], v[244:247], v[88:91], v[168:171]
    ds_read_b64_tr_b16 v[236:237], v251 offset:12288
    v_mfma_f32_16x16x32_bf16 v[172:175], v[244:247], v[92:95], v[172:175]
    s_waitcnt lgkmcnt(5)
    ds_read_b64_tr_b16 v[238:239], v251 offset:12800
    v_cvt_pk_bf16_f32 v194, v196, v197
    v_mfma_f32_16x16x32_bf16 v[144:147], v[224:227], v[96:99], v[144:147]
    ds_read_b64_tr_b16 v[240:241], v248 offset:16384
    v_mfma_f32_16x16x32_bf16 v[148:151], v[224:227], v[100:103], v[148:151]
    s_waitcnt lgkmcnt(5)
    ds_read_b64_tr_b16 v[242:243], v248 offset:16896
    v_cvt_pk_bf16_f32 v195, v198, v199
    v_mfma_f32_16x16x32_bf16 v[152:155], v[228:231], v[96:99], v[152:155]
    ds_read_b64_tr_b16 v[244:245], v249 offset:16384
    v_mfma_f32_16x16x32_bf16 v[156:159], v[228:231], v[100:103], v[156:159]
    s_waitcnt lgkmcnt(5)
    ds_read_b64_tr_b16 v[246:247], v249 offset:16896
    v_mul_f32 v200, v200, v218
    v_mfma_f32_16x16x32_bf16 v[160:163], v[232:235], v[96:99], v[160:163]
    ds_read_b64_tr_b16 v[224:225], v250 offset:16384
    v_mfma_f32_16x16x32_bf16 v[164:167], v[232:235], v[100:103], v[164:167]
    s_waitcnt lgkmcnt(5)
    ds_read_b64_tr_b16 v[226:227], v250 offset:16896
    v_mul_f32 v201, v201, v218
    v_mfma_f32_16x16x32_bf16 v[168:171], v[236:239], v[96:99], v[168:171]
    ds_read_b64_tr_b16 v[228:229], v251 offset:16384
    v_mfma_f32_16x16x32_bf16 v[172:175], v[236:239], v[100:103], v[172:175]
    s_waitcnt lgkmcnt(5)
    ds_read_b64_tr_b16 v[230:231], v251 offset:16896
    v_mul_f32 v202, v202, v218
    v_mfma_f32_16x16x32_bf16 v[144:147], v[240:243], v[104:107], v[144:147]
    ds_read_b64_tr_b16 v[232:233], v248 offset:20480
    v_mfma_f32_16x16x32_bf16 v[148:151], v[240:243], v[108:111], v[148:151]
    s_waitcnt lgkmcnt(5)
    ds_read_b64_tr_b16 v[234:235], v248 offset:20992
    v_mul_f32 v203, v203, v218
    v_mfma_f32_16x16x32_bf16 v[152:155], v[244:247], v[104:107], v[152:155]
    ds_read_b64_tr_b16 v[236:237], v249 offset:20480
    v_mfma_f32_16x16x32_bf16 v[156:159], v[244:247], v[108:111], v[156:159]
    s_waitcnt lgkmcnt(5)
    ds_read_b64_tr_b16 v[238:239], v249 offset:20992
    v_permlane16_swap_b32 v192, v194
    v_mfma_f32_16x16x32_bf16 v[160:163], v[224:227], v[104:107], v[160:163]
    ds_read_b64_tr_b16 v[240:241], v250 offset:20480
    v_mfma_f32_16x16x32_bf16 v[164:167], v[224:227], v[108:111], v[164:167]
    s_waitcnt lgkmcnt(5)
    ds_read_b64_tr_b16 v[242:243], v250 offset:20992
    v_permlane16_swap_b32 v193, v195
    v_mfma_f32_16x16x32_bf16 v[168:171], v[228:231], v[104:107], v[168:171]
    ds_read_b64_tr_b16 v[244:245], v251 offset:20480
    ds_read_b64_tr_b16 v[246:247], v251 offset:20992
    v_mfma_f32_16x16x32_bf16 v[172:175], v[228:231], v[108:111], v[172:175]
    s_waitcnt lgkmcnt(6)
    buffer_store_dwordx4 v[192:195], v254, s[20:23], s42 offen offset:2048 sc1
    v_mfma_f32_16x16x32_bf16 v[144:147], v[232:235], v[112:115], v[144:147]
    ds_read_b64_tr_b16 v[224:225], v248 offset:24576
    v_mfma_f32_16x16x32_bf16 v[148:151], v[232:235], v[116:119], v[148:151]
    s_waitcnt lgkmcnt(5)
    ds_read_b64_tr_b16 v[226:227], v248 offset:25088
    v_mul_f32 v204, v204, v219
    v_mfma_f32_16x16x32_bf16 v[152:155], v[236:239], v[112:115], v[152:155]
    ds_read_b64_tr_b16 v[228:229], v249 offset:24576
    v_mfma_f32_16x16x32_bf16 v[156:159], v[236:239], v[116:119], v[156:159]
    s_waitcnt lgkmcnt(5)
    ds_read_b64_tr_b16 v[230:231], v249 offset:25088
    v_mul_f32 v205, v205, v219
    v_mfma_f32_16x16x32_bf16 v[160:163], v[240:243], v[112:115], v[160:163]
    ds_read_b64_tr_b16 v[232:233], v250 offset:24576
    v_mfma_f32_16x16x32_bf16 v[164:167], v[240:243], v[116:119], v[164:167]
    s_waitcnt lgkmcnt(5)
    ds_read_b64_tr_b16 v[234:235], v250 offset:25088
    v_mul_f32 v206, v206, v219
    v_mfma_f32_16x16x32_bf16 v[168:171], v[244:247], v[112:115], v[168:171]
    ds_read_b64_tr_b16 v[236:237], v251 offset:24576
    v_mfma_f32_16x16x32_bf16 v[172:175], v[244:247], v[116:119], v[172:175]
    s_waitcnt lgkmcnt(5)
    ds_read_b64_tr_b16 v[238:239], v251 offset:25088
    v_mul_f32 v207, v207, v219
    v_mfma_f32_16x16x32_bf16 v[144:147], v[224:227], v[120:123], v[144:147]
    ds_read_b64_tr_b16 v[240:241], v248 offset:28672
    v_mfma_f32_16x16x32_bf16 v[148:151], v[224:227], v[124:127], v[148:151]
    s_waitcnt lgkmcnt(5)
    ds_read_b64_tr_b16 v[242:243], v248 offset:29184
    v_cvt_pk_bf16_f32 v200, v200, v201
    v_mfma_f32_16x16x32_bf16 v[152:155], v[228:231], v[120:123], v[152:155]
    ds_read_b64_tr_b16 v[244:245], v249 offset:28672
    v_mfma_f32_16x16x32_bf16 v[156:159], v[228:231], v[124:127], v[156:159]
    s_waitcnt lgkmcnt(5)
    ds_read_b64_tr_b16 v[246:247], v249 offset:29184
    v_cvt_pk_bf16_f32 v201, v202, v203
    v_mfma_f32_16x16x32_bf16 v[160:163], v[232:235], v[120:123], v[160:163]
    ds_read_b64_tr_b16 v[224:225], v250 offset:28672
    v_mfma_f32_16x16x32_bf16 v[164:167], v[232:235], v[124:127], v[164:167]
    s_waitcnt lgkmcnt(5)
    ds_read_b64_tr_b16 v[226:227], v250 offset:29184
    v_cvt_pk_bf16_f32 v202, v204, v205
    v_mfma_f32_16x16x32_bf16 v[168:171], v[236:239], v[120:123], v[168:171]
    ds_read_b64_tr_b16 v[228:229], v251 offset:28672
    v_mfma_f32_16x16x32_bf16 v[172:175], v[236:239], v[124:127], v[172:175]
    s_waitcnt lgkmcnt(5)
    ds_read_b64_tr_b16 v[230:231], v251 offset:29184
    v_cvt_pk_bf16_f32 v203, v206, v207
    v_mfma_f32_16x16x32_bf16 v[144:147], v[240:243], v[128:131], v[144:147]
    ds_read_b64_tr_b16 v[232:233], v248 offset:32768
    ds_read_b64_tr_b16 v[234:235], v248 offset:33280
    v_mfma_f32_16x16x32_bf16 v[148:151], v[240:243], v[132:135], v[148:151]
    s_waitcnt lgkmcnt(6)
    s_add_u32 s43, s43, 1
    v_add_u32 v248, 36864, v248
    v_mfma_f32_16x16x32_bf16 v[152:155], v[244:247], v[128:131], v[152:155]
    ds_read_b64_tr_b16 v[236:237], v249 offset:32768
    ds_read_b64_tr_b16 v[238:239], v249 offset:33280
    v_mfma_f32_16x16x32_bf16 v[156:159], v[244:247], v[132:135], v[156:159]
    s_waitcnt lgkmcnt(6)
    s_sub_u32 s44, s44, 1
    v_add_u32 v249, 36864, v249
    v_mfma_f32_16x16x32_bf16 v[160:163], v[224:227], v[128:131], v[160:163]
    ds_read_b64_tr_b16 v[240:241], v250 offset:32768
    ds_read_b64_tr_b16 v[242:243], v250 offset:33280
    v_mfma_f32_16x16x32_bf16 v[164:167], v[224:227], v[132:135], v[164:167]
    s_waitcnt lgkmcnt(6)
    v_permlane16_swap_b32 v200, v202
    v_add_u32 v250, 36864, v250
    v_mfma_f32_16x16x32_bf16 v[168:171], v[228:231], v[128:131], v[168:171]
    ds_read_b64_tr_b16 v[244:245], v251 offset:32768
    ds_read_b64_tr_b16 v[246:247], v251 offset:33280
    v_mfma_f32_16x16x32_bf16 v[172:175], v[228:231], v[132:135], v[172:175]
    s_waitcnt lgkmcnt(6)
    v_permlane16_swap_b32 v201, v203
    v_add_u32 v251, 36864, v251
    v_mfma_f32_16x16x32_bf16 v[144:147], v[232:235], v[136:139], v[144:147]
    s_barrier
    ds_read_b64_tr_b16 v[224:225], v248 offset:0
    ds_read_b64_tr_b16 v[226:227], v248 offset:512
    v_mfma_f32_16x16x32_bf16 v[148:151], v[232:235], v[140:143], v[148:151]
    s_waitcnt lgkmcnt(6)
    buffer_store_dwordx4 v[200:203], v254, s[20:23], s42 offen offset:3072 sc1
    v_mfma_f32_16x16x32_bf16 v[152:155], v[236:239], v[136:139], v[152:155]
    ds_read_b64_tr_b16 v[228:229], v249 offset:0
    ds_read_b64_tr_b16 v[230:231], v249 offset:512
    v_mfma_f32_16x16x32_bf16 v[156:159], v[236:239], v[140:143], v[156:159]
    s_waitcnt lgkmcnt(6)
    s_add_u32 s42, s42, 4096
    v_mfma_f32_16x16x32_bf16 v[160:163], v[240:243], v[136:139], v[160:163]
    ds_read_b64_tr_b16 v[232:233], v250 offset:0
    ds_read_b64_tr_b16 v[234:235], v250 offset:512
    v_mfma_f32_16x16x32_bf16 v[164:167], v[240:243], v[140:143], v[164:167]
    s_waitcnt lgkmcnt(6)
    v_mfma_f32_16x16x32_bf16 v[168:171], v[244:247], v[136:139], v[168:171]
    ds_read_b64_tr_b16 v[236:237], v251 offset:0
    ds_read_b64_tr_b16 v[238:239], v251 offset:512
    v_mfma_f32_16x16x32_bf16 v[172:175], v[244:247], v[140:143], v[172:175]
    s_waitcnt lgkmcnt(6)
    s_cmp_lg_u32 s44, 0
    s_cbranch_scc1 K1_X01
    s_branch K1_UG
K1_GU:
    v_mfma_f32_16x16x32_bf16 v[144:147], v[224:227], v[0:3], 0
    ds_read_b64_tr_b16 v[240:241], v248 offset:4096
    ds_read_b64_tr_b16 v[242:243], v248 offset:4608
    v_mfma_f32_16x16x32_bf16 v[148:151], v[224:227], v[4:7], 0
    s_waitcnt lgkmcnt(6)
    v_mfma_f32_16x16x32_bf16 v[152:155], v[228:231], v[0:3], 0
    ds_read_b64_tr_b16 v[244:245], v249 offset:4096
    ds_read_b64_tr_b16 v[246:247], v249 offset:4608
    v_mfma_f32_16x16x32_bf16 v[156:159], v[228:231], v[4:7], 0
    s_waitcnt lgkmcnt(6)
    v_mfma_f32_16x16x32_bf16 v[160:163], v[232:235], v[0:3], 0
    ds_read_b64_tr_b16 v[224:225], v250 offset:4096
    ds_read_b64_tr_b16 v[226:227], v250 offset:4608
    v_mfma_f32_16x16x32_bf16 v[164:167], v[232:235], v[4:7], 0
    s_waitcnt lgkmcnt(6)
    v_mfma_f32_16x16x32_bf16 v[168:171], v[236:239], v[0:3], 0
    ds_read_b64_tr_b16 v[228:229], v251 offset:4096
    ds_read_b64_tr_b16 v[230:231], v251 offset:4608
    v_mfma_f32_16x16x32_bf16 v[172:175], v[236:239], v[4:7], 0
    s_waitcnt lgkmcnt(6)
    v_rcp_f16_sdwa v208, v208 dst_sel:WORD_0 dst_unused:UNUSED_PRESERVE src0_sel:WORD_0
    v_mfma_f32_16x16x32_bf16 v[144:147], v[240:243], v[8:11], v[144:147]
    ds_read_b64_tr_b16 v[232:233], v248 offset:8192
    ds_read_b64_tr_b16 v[234:235], v248 offset:8704
    v_mfma_f32_16x16x32_bf16 v[148:151], v[240:243], v[12:15], v[148:151]
    s_waitcnt lgkmcnt(6)
    v_rcp_f16_sdwa v209, v209 dst_sel:WORD_0 dst_unused:UNUSED_PRESERVE src0_sel:WORD_0
    v_mfma_f32_16x16x32_bf16 v[152:155], v[244:247], v[8:11], v[152:155]
    ds_read_b64_tr_b16 v[236:237], v249 offset:8192
    ds_read_b64_tr_b16 v[238:239], v249 offset:8704
    v_mfma_f32_16x16x32_bf16 v[156:159], v[244:247], v[12:15], v[156:159]
    s_waitcnt lgkmcnt(6)
    v_rcp_f16_sdwa v208, v208 dst_sel:WORD_1 dst_unused:UNUSED_PRESERVE src0_sel:WORD_1
    v_mfma_f32_16x16x32_bf16 v[160:163], v[224:227], v[8:11], v[160:163]
    ds_read_b64_tr_b16 v[240:241], v250 offset:8192
    ds_read_b64_tr_b16 v[242:243], v250 offset:8704
    v_mfma_f32_16x16x32_bf16 v[164:167], v[224:227], v[12:15], v[164:167]
    s_waitcnt lgkmcnt(6)
    v_rcp_f16_sdwa v209, v209 dst_sel:WORD_1 dst_unused:UNUSED_PRESERVE src0_sel:WORD_1
    v_mfma_f32_16x16x32_bf16 v[168:171], v[228:231], v[8:11], v[168:171]
    ds_read_b64_tr_b16 v[244:245], v251 offset:8192
    ds_read_b64_tr_b16 v[246:247], v251 offset:8704
    v_mfma_f32_16x16x32_bf16 v[172:175], v[228:231], v[12:15], v[172:175]
    s_waitcnt lgkmcnt(6)
    v_rcp_f16_sdwa v212, v212 dst_sel:WORD_0 dst_unused:UNUSED_PRESERVE src0_sel:WORD_0
    v_mfma_f32_16x16x32_bf16 v[144:147], v[232:235], v[16:19], v[144:147]
    ds_read_b64_tr_b16 v[224:225], v248 offset:12288
    ds_read_b64_tr_b16 v[226:227], v248 offset:12800
    v_mfma_f32_16x16x32_bf16 v[148:151], v[232:235], v[20:23], v[148:151]
    s_waitcnt lgkmcnt(6)
    v_fma_mix_f32 v176, v176, v208, 0 op_sel:[0,0,0] op_sel_hi:[0,1,0]
    v_fma_mix_f32 v177, v177, v208, 0 op_sel:[0,1,0] op_sel_hi:[0,1,0]
    v_mfma_f32_16x16x32_bf16 v[152:155], v[236:239], v[16:19], v[152:155]
    ds_read_b64_tr_b16 v[228:229], v249 offset:12288
    ds_read_b64_tr_b16 v[230:231], v249 offset:12800
    v_mfma_f32_16x16x32_bf16 v[156:159], v[236:239], v[20:23], v[156:159]
    s_waitcnt lgkmcnt(6)
    v_rcp_f16_sdwa v213, v213 dst_sel:WORD_0 dst_unused:UNUSED_PRESERVE src0_sel:WORD_0
    v_mfma_f32_16x16x32_bf16 v[160:163], v[240:243], v[16:19], v[160:163]
    ds_read_b64_tr_b16 v[232:233], v250 offset:12288
    ds_read_b64_tr_b16 v[234:235], v250 offset:12800
    v_mfma_f32_16x16x32_bf16 v[164:167], v[240:243], v[20:23], v[164:167]
    s_waitcnt lgkmcnt(6)
    v_fma_mix_f32 v178, v178, v209, 0 op_sel:[0,0,0] op_sel_hi:[0,1,0]
    v_fma_mix_f32 v179, v179, v209, 0 op_sel:[0,1,0] op_sel_hi:[0,1,0]
    v_mfma_f32_16x16x32_bf16 v[168:171], v[244:247], v[16:19], v[168:171]
    ds_read_b64_tr_b16 v[236:237], v251 offset:12288
    ds_read_b64_tr_b16 v[238:239], v251 offset:12800
    v_mfma_f32_16x16x32_bf16 v[172:175], v[244:247], v[20:23], v[172:175]
    s_waitcnt lgkmcnt(6)
    v_rcp_f16_sdwa v212, v212 dst_sel:WORD_1 dst_unused:UNUSED_PRESERVE src0_sel:WORD_1
    v_mfma_f32_16x16x32_bf16 v[144:147], v[224:227], v[24:27], v[144:147]
    ds_read_b64_tr_b16 v[240:241], v248 offset:16384
    ds_read_b64_tr_b16 v[242:243], v248 offset:16896
    v_mfma_f32_16x16x32_bf16 v[148:151], v[224:227], v[28:31], v[148:151]
    s_waitcnt lgkmcnt(6)
    v_cvt_pk_bf16_f32 v176, v176, v177
    v_cvt_pk_bf16_f32 v177, v178, v179
    v_mfma_f32_16x16x32_bf16 v[152:155], v[228:231], v[24:27], v[152:155]
    ds_read_b64_tr_b16 v[244:245], v249 offset:16384
    ds_read_b64_tr_b16 v[246:247], v249 offset:16896
    v_mfma_f32_16x16x32_bf16 v[156:159], v[228:231], v[28:31], v[156:159]
    s_waitcnt lgkmcnt(6)
    v_rcp_f16_sdwa v213, v213 dst_sel:WORD_1 dst_unused:UNUSED_PRESERVE src0_sel:WORD_1
    v_mfma_f32_16x16x32_bf16 v[160:163], v[232:235], v[24:27], v[160:163]
    ds_read_b64_tr_b16 v[224:225], v250 offset:16384
    ds_read_b64_tr_b16 v[226:227], v250 offset:16896
    v_mfma_f32_16x16x32_bf16 v[164:167], v[232:235], v[28:31], v[164:167]
    s_waitcnt lgkmcnt(6)
    v_rcp_f16_sdwa v210, v210 dst_sel:WORD_0 dst_unused:UNUSED_PRESERVE src0_sel:WORD_0
    v_mfma_f32_16x16x32_bf16 v[168:171], v[236:239], v[24:27], v[168:171]
    ds_read_b64_tr_b16 v[228:229], v251 offset:16384
    ds_read_b64_tr_b16 v[230:231], v251 offset:16896
    v_mfma_f32_16x16x32_bf16 v[172:175], v[236:239], v[28:31], v[172:175]
    s_waitcnt lgkmcnt(6)
    v_fma_mix_f32 v184, v184, v212, 0 op_sel:[0,0,0] op_sel_hi:[0,1,0]
    v_fma_mix_f32 v185, v185, v212, 0 op_sel:[0,1,0] op_sel_hi:[0,1,0]
    v_mfma_f32_16x16x32_bf16 v[144:147], v[240:243], v[32:35], v[144:147]
    ds_read_b64_tr_b16 v[232:233], v248 offset:20480
    ds_read_b64_tr_b16 v[234:235], v248 offset:20992
    v_mfma_f32_16x16x32_bf16 v[148:151], v[240:243], v[36:39], v[148:151]
    s_waitcnt lgkmcnt(6)
    v_rcp_f16_sdwa v211, v211 dst_sel:WORD_0 dst_unused:UNUSED_PRESERVE src0_sel:WORD_0
    v_mfma_f32_16x16x32_bf16 v[152:155], v[244:247], v[32:35], v[152:155]
    ds_read_b64_tr_b16 v[236:237], v249 offset:20480
    ds_read_b64_tr_b16 v[238:239], v249 offset:20992
    v_mfma_f32_16x16x32_bf16 v[156:159], v[244:247], v[36:39], v[156:159]
    s_waitcnt lgkmcnt(6)
    v_fma_mix_f32 v186, v186, v213, 0 op_sel:[0,0,0] op_sel_hi:[0,1,0]
    v_fma_mix_f32 v187, v187, v213, 0 op_sel:[0,1,0] op_sel_hi:[0,1,0]
    v_mfma_f32_16x16x32_bf16 v[160:163], v[224:227], v[32:35], v[160:163]
    ds_read_b64_tr_b16 v[240:241], v250 offset:20480
    ds_read_b64_tr_b16 v[242:243], v250 offset:20992
    v_mfma_f32_16x16x32_bf16 v[164:167], v[224:227], v[36:39], v[164:167]
    s_waitcnt lgkmcnt(6)
    v_rcp_f16_sdwa v210, v210 dst_sel:WORD_1 dst_unused:UNUSED_PRESERVE src0_sel:WORD_1
    v_mfma_f32_16x16x32_bf16 v[168:171], v[228:231], v[32:35], v[168:171]
    ds_read_b64_tr_b16 v[244:245], v251 offset:20480
    v_mfma_f32_16x16x32_bf16 v[172:175], v[228:231], v[36:39], v[172:175]
    s_waitcnt lgkmcnt(5)
    ds_read_b64_tr_b16 v[246:247], v251 offset:20992
    v_cvt_pk_bf16_f32 v178, v184, v185
    v_mfma_f32_16x16x32_bf16 v[144:147], v[232:235], v[40:43], v[144:147]
    s_barrier
    ds_read_b64_tr_b16 v[224:225], v248 offset:24576
    v_mfma_f32_16x16x32_bf16 v[148:151], v[232:235], v[44:47], v[148:151]
    s_waitcnt lgkmcnt(5)
    ds_read_b64_tr_b16 v[226:227], v248 offset:25088
    v_cvt_pk_bf16_f32 v179, v186, v187
    v_mfma_f32_16x16x32_bf16 v[152:155], v[236:239], v[40:43], v[152:155]
    ds_read_b64_tr_b16 v[228:229], v249 offset:24576
    ds_read_b64_tr_b16 v[230:231], v249 offset:25088
    v_mfma_f32_16x16x32_bf16 v[156:159], v[236:239], v[44:47], v[156:159]
    s_waitcnt lgkmcnt(6)
    v_rcp_f16_sdwa v211, v211 dst_sel:WORD_1 dst_unused:UNUSED_PRESERVE src0_sel:WORD_1
    v_mfma_f32_16x16x32_bf16 v[160:163], v[240:243], v[40:43], v[160:163]
    ds_read_b64_tr_b16 v[232:233], v250 offset:24576
    ds_read_b64_tr_b16 v[234:235], v250 offset:25088
    v_mfma_f32_16x16x32_bf16 v[164:167], v[240:243], v[44:47], v[164:167]
    s_waitcnt lgkmcnt(6)
    buffer_store_dwordx4 v[176:179], v254, s[20:23], s41 offen offset:0 sc1
    v_mfma_f32_16x16x32_bf16 v[168:171], v[244:247], v[40:43], v[168:171]
    ds_read_b64_tr_b16 v[236:237], v251 offset:24576
    ds_read_b64_tr_b16 v[238:239], v251 offset:25088
    v_mfma_f32_16x16x32_bf16 v[172:175], v[244:247], v[44:47], v[172:175]
    s_waitcnt lgkmcnt(6)
    v_rcp_f16_sdwa v214, v214 dst_sel:WORD_0 dst_unused:UNUSED_PRESERVE src0_sel:WORD_0
    v_mfma_f32_16x16x32_bf16 v[144:147], v[224:227], v[48:51], v[144:147]
    ds_read_b64_tr_b16 v[240:241], v248 offset:28672
    ds_read_b64_tr_b16 v[242:243], v248 offset:29184
    v_mfma_f32_16x16x32_bf16 v[148:151], v[224:227], v[52:55], v[148:151]
    s_waitcnt lgkmcnt(6)
    v_fma_mix_f32 v180, v180, v210, 0 op_sel:[0,0,0] op_sel_hi:[0,1,0]
    v_fma_mix_f32 v181, v181, v210, 0 op_sel:[0,1,0] op_sel_hi:[0,1,0]
    v_mfma_f32_16x16x32_bf16 v[152:155], v[228:231], v[48:51], v[152:155]
    ds_read_b64_tr_b16 v[244:245], v249 offset:28672
    ds_read_b64_tr_b16 v[246:247], v249 offset:29184
    v_mfma_f32_16x16x32_bf16 v[156:159], v[228:231], v[52:55], v[156:159]
    s_waitcnt lgkmcnt(6)
    v_rcp_f16_sdwa v215, v215 dst_sel:WORD_0 dst_unused:UNUSED_PRESERVE src0_sel:WORD_0
    v_mfma_f32_16x16x32_bf16 v[160:163], v[232:235], v[48:51], v[160:163]
    ds_read_b64_tr_b16 v[224:225], v250 offset:28672
    ds_read_b64_tr_b16 v[226:227], v250 offset:29184
    v_mfma_f32_16x16x32_bf16 v[164:167], v[232:235], v[52:55], v[164:167]
    s_waitcnt lgkmcnt(6)
    v_fma_mix_f32 v182, v182, v211, 0 op_sel:[0,0,0] op_sel_hi:[0,1,0]
    v_fma_mix_f32 v183, v183, v211, 0 op_sel:[0,1,0] op_sel_hi:[0,1,0]
    v_mfma_f32_16x16x32_bf16 v[168:171], v[236:239], v[48:51], v[168:171]
    ds_read_b64_tr_b16 v[228:229], v251 offset:28672
    ds_read_b64_tr_b16 v[230:231], v251 offset:29184
    v_mfma_f32_16x16x32_bf16 v[172:175], v[236:239], v[52:55], v[172:175]
    s_waitcnt lgkmcnt(6)
    v_rcp_f16_sdwa v214, v214 dst_sel:WORD_1 dst_unused:UNUSED_PRESERVE src0_sel:WORD_1
    v_mfma_f32_16x16x32_bf16 v[144:147], v[240:243], v[56:59], v[144:147]
    ds_read_b64_tr_b16 v[232:233], v248 offset:32768
    ds_read_b64_tr_b16 v[234:235], v248 offset:33280
    v_mfma_f32_16x16x32_bf16 v[148:151], v[240:243], v[60:63], v[148:151]
    s_waitcnt lgkmcnt(6)
    v_add_u32 v248, 36864, v248
    v_mfma_f32_16x16x32_bf16 v[152:155], v[244:247], v[56:59], v[152:155]
    ds_read_b64_tr_b16 v[236:237], v249 offset:32768
    ds_read_b64_tr_b16 v[238:239], v249 offset:33280
    v_mfma_f32_16x16x32_bf16 v[156:159], v[244:247], v[60:63], v[156:159]
    s_waitcnt lgkmcnt(6)
    v_cvt_pk_bf16_f32 v180, v180, v181
    v_add_u32 v249, 36864, v249
    v_mfma_f32_16x16x32_bf16 v[160:163], v[224:227], v[56:59], v[160:163]
    ds_read_b64_tr_b16 v[240:241], v250 offset:32768
    ds_read_b64_tr_b16 v[242:243], v250 offset:33280
    v_mfma_f32_16x16x32_bf16 v[164:167], v[224:227], v[60:63], v[164:167]
    s_waitcnt lgkmcnt(6)
    v_cvt_pk_bf16_f32 v181, v182, v183
    v_add_u32 v250, 36864, v250
    v_mfma_f32_16x16x32_bf16 v[168:171], v[228:231], v[56:59], v[168:171]
    ds_read_b64_tr_b16 v[244:245], v251 offset:32768
    ds_read_b64_tr_b16 v[246:247], v251 offset:33280
    v_mfma_f32_16x16x32_bf16 v[172:175], v[228:231], v[60:63], v[172:175]
    s_waitcnt lgkmcnt(6)
    v_add_u32 v251, 36864, v251
    v_mfma_f32_16x16x32_bf16 v[144:147], v[232:235], v[64:67], v[144:147]
    ds_read_b64_tr_b16 v[224:225], v248 offset:0
    ds_read_b64_tr_b16 v[226:227], v248 offset:512
    v_mfma_f32_16x16x32_bf16 v[148:151], v[232:235], v[68:71], v[148:151]
    s_waitcnt lgkmcnt(6)
    v_rcp_f16_sdwa v215, v215 dst_sel:WORD_1 dst_unused:UNUSED_PRESERVE src0_sel:WORD_1
    v_mfma_f32_16x16x32_bf16 v[152:155], v[236:239], v[64:67], v[152:155]
    ds_read_b64_tr_b16 v[228:229], v249 offset:0
    ds_read_b64_tr_b16 v[230:231], v249 offset:512
    v_mfma_f32_16x16x32_bf16 v[156:159], v[236:239], v[68:71], v[156:159]
    s_waitcnt lgkmcnt(6)
    v_rcp_f16_sdwa v216, v216 dst_sel:WORD_0 dst_unused:UNUSED_PRESERVE src0_sel:WORD_0
    v_mfma_f32_16x16x32_bf16 v[160:163], v[240:243], v[64:67], v[160:163]
    ds_read_b64_tr_b16 v[232:233], v250 offset:0
    ds_read_b64_tr_b16 v[234:235], v250 offset:512
    v_mfma_f32_16x16x32_bf16 v[164:167], v[240:243], v[68:71], v[164:167]
    s_waitcnt lgkmcnt(6)
    v_fma_mix_f32 v188, v188, v214, 0 op_sel:[0,0,0] op_sel_hi:[0,1,0]
    v_fma_mix_f32 v189, v189, v214, 0 op_sel:[0,1,0] op_sel_hi:[0,1,0]
    v_mfma_f32_16x16x32_bf16 v[168:171], v[244:247], v[64:67], v[168:171]
    ds_read_b64_tr_b16 v[236:237], v251 offset:0
    ds_read_b64_tr_b16 v[238:239], v251 offset:512
    v_mfma_f32_16x16x32_bf16 v[172:175], v[244:247], v[68:71], v[172:175]
    s_waitcnt lgkmcnt(6)
    v_rcp_f16_sdwa v217, v217 dst_sel:WORD_0 dst_unused:UNUSED_PRESERVE src0_sel:WORD_0
    v_mfma_f32_16x16x32_bf16 v[144:147], v[224:227], v[72:75], v[144:147]
    ds_read_b64_tr_b16 v[240:241], v248 offset:4096
    ds_read_b64_tr_b16 v[242:243], v248 offset:4608
    v_mfma_f32_16x16x32_bf16 v[148:151], v[224:227], v[76:79], v[148:151]
    s_waitcnt lgkmcnt(6)
    v_fma_mix_f32 v190, v190, v215, 0 op_sel:[0,0,0] op_sel_hi:[0,1,0]
    v_fma_mix_f32 v191, v191, v215, 0 op_sel:[0,1,0] op_sel_hi:[0,1,0]
    v_mfma_f32_16x16x32_bf16 v[152:155], v[228:231], v[72:75], v[152:155]
    ds_read_b64_tr_b16 v[244:245], v249 offset:4096
    ds_read_b64_tr_b16 v[246:247], v249 offset:4608
    v_mfma_f32_16x16x32_bf16 v[156:159], v[228:231], v[76:79], v[156:159]
    s_waitcnt lgkmcnt(6)
    v_rcp_f16_sdwa v216, v216 dst_sel:WORD_1 dst_unused:UNUSED_PRESERVE src0_sel:WORD_1
    v_mfma_f32_16x16x32_bf16 v[160:163], v[232:235], v[72:75], v[160:163]
    ds_read_b64_tr_b16 v[224:225], v250 offset:4096
    ds_read_b64_tr_b16 v[226:227], v250 offset:4608
    v_mfma_f32_16x16x32_bf16 v[164:167], v[232:235], v[76:79], v[164:167]
    s_waitcnt lgkmcnt(6)
    v_cvt_pk_bf16_f32 v182, v188, v189
    v_cvt_pk_bf16_f32 v183, v190, v191
    v_mfma_f32_16x16x32_bf16 v[168:171], v[236:239], v[72:75], v[168:171]
    ds_read_b64_tr_b16 v[228:229], v251 offset:4096
    ds_read_b64_tr_b16 v[230:231], v251 offset:4608
    v_mfma_f32_16x16x32_bf16 v[172:175], v[236:239], v[76:79], v[172:175]
    s_waitcnt lgkmcnt(6)
    v_rcp_f16_sdwa v217, v217 dst_sel:WORD_1 dst_unused:UNUSED_PRESERVE src0_sel:WORD_1
    v_mfma_f32_16x16x32_bf16 v[144:147], v[240:243], v[80:83], v[144:147]
    ds_read_b64_tr_b16 v[232:233], v248 offset:8192
    ds_read_b64_tr_b16 v[234:235], v248 offset:8704
    v_mfma_f32_16x16x32_bf16 v[148:151], v[240:243], v[84:87], v[148:151]
    s_waitcnt lgkmcnt(6)
    buffer_store_dwordx4 v[180:183], v254, s[20:23], s41 offen offset:1024 sc1
    v_mfma_f32_16x16x32_bf16 v[152:155], v[244:247], v[80:83], v[152:155]
    ds_read_b64_tr_b16 v[236:237], v249 offset:8192
    ds_read_b64_tr_b16 v[238:239], v249 offset:8704
    v_mfma_f32_16x16x32_bf16 v[156:159], v[244:247], v[84:87], v[156:159]
    s_waitcnt lgkmcnt(6)
    v_rcp_f16_sdwa v220, v220 dst_sel:WORD_0 dst_unused:UNUSED_PRESERVE src0_sel:WORD_0
    v_mfma_f32_16x16x32_bf16 v[160:163], v[224:227], v[80:83], v[160:163]
    ds_read_b64_tr_b16 v[240:241], v250 offset:8192
    ds_read_b64_tr_b16 v[242:243], v250 offset:8704
    v_mfma_f32_16x16x32_bf16 v[164:167], v[224:227], v[84:87], v[164:167]
    s_waitcnt lgkmcnt(6)
    v_fma_mix_f32 v192, v192, v216, 0 op_sel:[0,0,0] op_sel_hi:[0,1,0]
    v_fma_mix_f32 v193, v193, v216, 0 op_sel:[0,1,0] op_sel_hi:[0,1,0]
    v_mfma_f32_16x16x32_bf16 v[168:171], v[228:231], v[80:83], v[168:171]
    ds_read_b64_tr_b16 v[244:245], v251 offset:8192
    ds_read_b64_tr_b16 v[246:247], v251 offset:8704
    v_mfma_f32_16x16x32_bf16 v[172:175], v[228:231], v[84:87], v[172:175]
    s_waitcnt lgkmcnt(6)
    v_rcp_f16_sdwa v221, v221 dst_sel:WORD_0 dst_unused:UNUSED_PRESERVE src0_sel:WORD_0
    v_mfma_f32_16x16x32_bf16 v[144:147], v[232:235], v[88:91], v[144:147]
    s_barrier
    ds_read_b64_tr_b16 v[224:225], v248 offset:12288
    v_mfma_f32_16x16x32_bf16 v[148:151], v[232:235], v[92:95], v[148:151]
    s_waitcnt lgkmcnt(5)
    ds_read_b64_tr_b16 v[226:227], v248 offset:12800
    v_fma_mix_f32 v194, v194, v217, 0 op_sel:[0,0,0] op_sel_hi:[0,1,0]
    v_mfma_f32_16x16x32_bf16 v[152:155], v[236:239], v[88:91], v[152:155]
    ds_read_b64_tr_b16 v[228:229], v249 offset:12288
    v_mfma_f32_16x16x32_bf16 v[156:159], v[236:239], v[92:95], v[156:159]
    s_waitcnt lgkmcnt(5)
    ds_read_b64_tr_b16 v[230:231], v249 offset:12800
    v_fma_mix_f32 v195, v195, v217, 0 op_sel:[0,1,0] op_sel_hi:[0,1,0]
    v_mfma_f32_16x16x32_bf16 v[160:163], v[240:243], v[88:91], v[160:163]
    ds_read_b64_tr_b16 v[232:233], v250 offset:12288
    ds_read_b64_tr_b16 v[234:235], v250 offset:12800
    v_mfma_f32_16x16x32_bf16 v[164:167], v[240:243], v[92:95], v[164:167]
    s_waitcnt lgkmcnt(6)
    v_rcp_f16_sdwa v220, v220 dst_sel:WORD_1 dst_unused:UNUSED_PRESERVE src0_sel:WORD_1
    v_mfma_f32_16x16x32_bf16 v[168:171], v[244:247], v[88:91], v[168:171]
    ds_read_b64_tr_b16 v[236:237], v251 offset:12288
    ds_read_b64_tr_b16 v[238:239], v251 offset:12800
    v_mfma_f32_16x16x32_bf16 v[172:175], v[244:247], v[92:95], v[172:175]
    s_waitcnt lgkmcnt(6)
    v_cvt_pk_bf16_f32 v192, v192, v193
    v_cvt_pk_bf16_f32 v193, v194, v195
    v_mfma_f32_16x16x32_bf16 v[144:147], v[224:227], v[96:99], v[144:147]
    ds_read_b64_tr_b16 v[240:241], v248 offset:16384
    ds_read_b64_tr_b16 v[242:243], v248 offset:16896
    v_mfma_f32_16x16x32_bf16 v[148:151], v[224:227], v[100:103], v[148:151]
    s_waitcnt lgkmcnt(6)
    v_rcp_f16_sdwa v221, v221 dst_sel:WORD_1 dst_unused:UNUSED_PRESERVE src0_sel:WORD_1
    v_mfma_f32_16x16x32_bf16 v[152:155], v[228:231], v[96:99], v[152:155]
    ds_read_b64_tr_b16 v[244:245], v249 offset:16384
    ds_read_b64_tr_b16 v[246:247], v249 offset:16896
    v_mfma_f32_16x16x32_bf16 v[156:159], v[228:231], v[100:103], v[156:159]
    s_waitcnt lgkmcnt(6)
    v_rcp_f16_sdwa v218, v218 dst_sel:WORD_0 dst_unused:UNUSED_PRESERVE src0_sel:WORD_0
    v_mfma_f32_16x16x32_bf16 v[160:163], v[232:235], v[96:99], v[160:163]
    ds_read_b64_tr_b16 v[224:225], v250 offset:16384
    ds_read_b64_tr_b16 v[226:227], v250 offset:16896
    v_mfma_f32_16x16x32_bf16 v[164:167], v[232:235], v[100:103], v[164:167]
    s_waitcnt lgkmcnt(6)
    v_fma_mix_f32 v200, v200, v220, 0 op_sel:[0,0,0] op_sel_hi:[0,1,0]
    v_fma_mix_f32 v201, v201, v220, 0 op_sel:[0,1,0] op_sel_hi:[0,1,0]
    v_mfma_f32_16x16x32_bf16 v[168:171], v[236:239], v[96:99], v[168:171]
    ds_read_b64_tr_b16 v[228:229], v251 offset:16384
    ds_read_b64_tr_b16 v[230:231], v251 offset:16896
    v_mfma_f32_16x16x32_bf16 v[172:175], v[236:239], v[100:103], v[172:175]
    s_waitcnt lgkmcnt(6)
    v_rcp_f16_sdwa v219, v219 dst_sel:WORD_0 dst_unused:UNUSED_PRESERVE src0_sel:WORD_0
    v_mfma_f32_16x16x32_bf16 v[144:147], v[240:243], v[104:107], v[144:147]
    ds_read_b64_tr_b16 v[232:233], v248 offset:20480
    ds_read_b64_tr_b16 v[234:235], v248 offset:20992
    v_mfma_f32_16x16x32_bf16 v[148:151], v[240:243], v[108:111], v[148:151]
    s_waitcnt lgkmcnt(6)
    v_fma_mix_f32 v202, v202, v221, 0 op_sel:[0,0,0] op_sel_hi:[0,1,0]
    v_fma_mix_f32 v203, v203, v221, 0 op_sel:[0,1,0] op_sel_hi:[0,1,0]
    v_mfma_f32_16x16x32_bf16 v[152:155], v[244:247], v[104:107], v[152:155]
    ds_read_b64_tr_b16 v[236:237], v249 offset:20480
    ds_read_b64_tr_b16 v[238:239], v249 offset:20992
    v_mfma_f32_16x16x32_bf16 v[156:159], v[244:247], v[108:111], v[156:159]
    s_waitcnt lgkmcnt(6)
    v_rcp_f16_sdwa v218, v218 dst_sel:WORD_1 dst_unused:UNUSED_PRESERVE src0_sel:WORD_1
    v_mfma_f32_16x16x32_bf16 v[160:163], v[224:227], v[104:107], v[160:163]
    ds_read_b64_tr_b16 v[240:241], v250 offset:20480
    ds_read_b64_tr_b16 v[242:243], v250 offset:20992
    v_mfma_f32_16x16x32_bf16 v[164:167], v[224:227], v[108:111], v[164:167]
    s_waitcnt lgkmcnt(6)
    v_cvt_pk_bf16_f32 v194, v200, v201
    v_cvt_pk_bf16_f32 v195, v202, v203
    v_mfma_f32_16x16x32_bf16 v[168:171], v[228:231], v[104:107], v[168:171]
    ds_read_b64_tr_b16 v[244:245], v251 offset:20480
    ds_read_b64_tr_b16 v[246:247], v251 offset:20992
    v_mfma_f32_16x16x32_bf16 v[172:175], v[228:231], v[108:111], v[172:175]
    s_waitcnt lgkmcnt(6)
    v_rcp_f16_sdwa v219, v219 dst_sel:WORD_1 dst_unused:UNUSED_PRESERVE src0_sel:WORD_1
    v_mfma_f32_16x16x32_bf16 v[144:147], v[232:235], v[112:115], v[144:147]
    ds_read_b64_tr_b16 v[224:225], v248 offset:24576
    ds_read_b64_tr_b16 v[226:227], v248 offset:25088
    v_mfma_f32_16x16x32_bf16 v[148:151], v[232:235], v[116:119], v[148:151]
    s_waitcnt lgkmcnt(6)
    buffer_store_dwordx4 v[192:195], v254, s[20:23], s41 offen offset:2048 sc1
    v_mfma_f32_16x16x32_bf16 v[152:155], v[236:239], v[112:115], v[152:155]
    ds_read_b64_tr_b16 v[228:229], v249 offset:24576
    ds_read_b64_tr_b16 v[230:231], v249 offset:25088
    v_mfma_f32_16x16x32_bf16 v[156:159], v[236:239], v[116:119], v[156:159]
    s_waitcnt lgkmcnt(6)
    v_rcp_f16_sdwa v222, v222 dst_sel:WORD_0 dst_unused:UNUSED_PRESERVE src0_sel:WORD_0
    v_mfma_f32_16x16x32_bf16 v[160:163], v[240:243], v[112:115], v[160:163]
    ds_read_b64_tr_b16 v[232:233], v250 offset:24576
    ds_read_b64_tr_b16 v[234:235], v250 offset:25088
    v_mfma_f32_16x16x32_bf16 v[164:167], v[240:243], v[116:119], v[164:167]
    s_waitcnt lgkmcnt(6)
    v_fma_mix_f32 v196, v196, v218, 0 op_sel:[0,0,0] op_sel_hi:[0,1,0]
    v_fma_mix_f32 v197, v197, v218, 0 op_sel:[0,1,0] op_sel_hi:[0,1,0]
    v_mfma_f32_16x16x32_bf16 v[168:171], v[244:247], v[112:115], v[168:171]
    ds_read_b64_tr_b16 v[236:237], v251 offset:24576
    ds_read_b64_tr_b16 v[238:239], v251 offset:25088
    v_mfma_f32_16x16x32_bf16 v[172:175], v[244:247], v[116:119], v[172:175]
    s_waitcnt lgkmcnt(6)
    v_rcp_f16_sdwa v223, v223 dst_sel:WORD_0 dst_unused:UNUSED_PRESERVE src0_sel:WORD_0
    v_mfma_f32_16x16x32_bf16 v[144:147], v[224:227], v[120:123], v[144:147]
    ds_read_b64_tr_b16 v[240:241], v248 offset:28672
    ds_read_b64_tr_b16 v[242:243], v248 offset:29184
    v_mfma_f32_16x16x32_bf16 v[148:151], v[224:227], v[124:127], v[148:151]
    s_waitcnt lgkmcnt(6)
    v_fma_mix_f32 v198, v198, v219, 0 op_sel:[0,0,0] op_sel_hi:[0,1,0]
    v_fma_mix_f32 v199, v199, v219, 0 op_sel:[0,1,0] op_sel_hi:[0,1,0]
    v_mfma_f32_16x16x32_bf16 v[152:155], v[228:231], v[120:123], v[152:155]
    ds_read_b64_tr_b16 v[244:245], v249 offset:28672
    ds_read_b64_tr_b16 v[246:247], v249 offset:29184
    v_mfma_f32_16x16x32_bf16 v[156:159], v[228:231], v[124:127], v[156:159]
    s_waitcnt lgkmcnt(6)
    v_rcp_f16_sdwa v222, v222 dst_sel:WORD_1 dst_unused:UNUSED_PRESERVE src0_sel:WORD_1
    v_mfma_f32_16x16x32_bf16 v[160:163], v[232:235], v[120:123], v[160:163]
    ds_read_b64_tr_b16 v[224:225], v250 offset:28672
    ds_read_b64_tr_b16 v[226:227], v250 offset:29184
    v_mfma_f32_16x16x32_bf16 v[164:167], v[232:235], v[124:127], v[164:167]
    s_waitcnt lgkmcnt(6)
    v_cvt_pk_bf16_f32 v196, v196, v197
    v_cvt_pk_bf16_f32 v197, v198, v199
    v_mfma_f32_16x16x32_bf16 v[168:171], v[236:239], v[120:123], v[168:171]
    ds_read_b64_tr_b16 v[228:229], v251 offset:28672
    ds_read_b64_tr_b16 v[230:231], v251 offset:29184
    v_mfma_f32_16x16x32_bf16 v[172:175], v[236:239], v[124:127], v[172:175]
    s_waitcnt lgkmcnt(6)
    v_rcp_f16_sdwa v223, v223 dst_sel:WORD_1 dst_unused:UNUSED_PRESERVE src0_sel:WORD_1
    v_mfma_f32_16x16x32_bf16 v[144:147], v[240:243], v[128:131], v[144:147]
    ds_read_b64_tr_b16 v[232:233], v248 offset:32768
    ds_read_b64_tr_b16 v[234:235], v248 offset:33280
    v_mfma_f32_16x16x32_bf16 v[148:151], v[240:243], v[132:135], v[148:151]
    s_waitcnt lgkmcnt(6)
    s_nop 0
    v_add_u32 v248, 36864, v248
    v_mfma_f32_16x16x32_bf16 v[152:155], v[244:247], v[128:131], v[152:155]
    ds_read_b64_tr_b16 v[236:237], v249 offset:32768
    ds_read_b64_tr_b16 v[238:239], v249 offset:33280
    v_mfma_f32_16x16x32_bf16 v[156:159], v[244:247], v[132:135], v[156:159]
    s_waitcnt lgkmcnt(6)
    v_fma_mix_f32 v204, v204, v222, 0 op_sel:[0,0,0] op_sel_hi:[0,1,0]
    v_add_u32 v249, 36864, v249
    v_mfma_f32_16x16x32_bf16 v[160:163], v[224:227], v[128:131], v[160:163]
    ds_read_b64_tr_b16 v[240:241], v250 offset:32768
    ds_read_b64_tr_b16 v[242:243], v250 offset:33280
    v_mfma_f32_16x16x32_bf16 v[164:167], v[224:227], v[132:135], v[164:167]
    s_waitcnt lgkmcnt(6)
    v_fma_mix_f32 v205, v205, v222, 0 op_sel:[0,1,0] op_sel_hi:[0,1,0]
    v_add_u32 v250, 36864, v250
    v_mfma_f32_16x16x32_bf16 v[168:171], v[228:231], v[128:131], v[168:171]
    ds_read_b64_tr_b16 v[244:245], v251 offset:32768
    ds_read_b64_tr_b16 v[246:247], v251 offset:33280
    v_mfma_f32_16x16x32_bf16 v[172:175], v[228:231], v[132:135], v[172:175]
    s_waitcnt lgkmcnt(6)
    v_fma_mix_f32 v206, v206, v223, 0 op_sel:[0,0,0] op_sel_hi:[0,1,0]
    v_add_u32 v251, 36864, v251
    v_mfma_f32_16x16x32_bf16 v[144:147], v[232:235], v[136:139], v[144:147]
    s_barrier
    ds_read_b64_tr_b16 v[224:225], v248 offset:0
    v_mfma_f32_16x16x32_bf16 v[148:151], v[232:235], v[140:143], v[148:151]
    s_waitcnt lgkmcnt(5)
    ds_read_b64_tr_b16 v[226:227], v248 offset:512
    v_fma_mix_f32 v207, v207, v223, 0 op_sel:[0,1,0] op_sel_hi:[0,1,0]
    v_mfma_f32_16x16x32_bf16 v[152:155], v[236:239], v[136:139], v[152:155]
    ds_read_b64_tr_b16 v[228:229], v249 offset:0
    ds_read_b64_tr_b16 v[230:231], v249 offset:512
    v_mfma_f32_16x16x32_bf16 v[156:159], v[236:239], v[140:143], v[156:159]
    s_waitcnt lgkmcnt(6)
    v_cvt_pk_bf16_f32 v198, v204, v205
    v_cvt_pk_bf16_f32 v199, v206, v207
    v_mfma_f32_16x16x32_bf16 v[160:163], v[240:243], v[136:139], v[160:163]
    ds_read_b64_tr_b16 v[232:233], v250 offset:0
    ds_read_b64_tr_b16 v[234:235], v250 offset:512
    v_mfma_f32_16x16x32_bf16 v[164:167], v[240:243], v[140:143], v[164:167]
    s_waitcnt lgkmcnt(6)
    buffer_store_dwordx4 v[196:199], v254, s[20:23], s41 offen offset:3072 sc1
    s_add_u32 s41, s41, 4096
    v_mfma_f32_16x16x32_bf16 v[168:171], v[244:247], v[136:139], v[168:171]
    ds_read_b64_tr_b16 v[236:237], v251 offset:0
    ds_read_b64_tr_b16 v[238:239], v251 offset:512
    v_mfma_f32_16x16x32_bf16 v[172:175], v[244:247], v[140:143], v[172:175]
    s_waitcnt lgkmcnt(6)
K1_UG:
    v_mfma_f32_16x16x32_bf16 v[176:179], v[224:227], v[0:3], 0
    ds_read_b64_tr_b16 v[240:241], v248 offset:4096
    ds_read_b64_tr_b16 v[242:243], v248 offset:4608
    v_mfma_f32_16x16x32_bf16 v[180:183], v[224:227], v[4:7], 0
    s_waitcnt lgkmcnt(6)
    v_mfma_f32_16x16x32_bf16 v[184:187], v[228:231], v[0:3], 0
    ds_read_b64_tr_b16 v[244:245], v249 offset:4096
    ds_read_b64_tr_b16 v[246:247], v249 offset:4608
    v_mfma_f32_16x16x32_bf16 v[188:191], v[228:231], v[4:7], 0
    s_waitcnt lgkmcnt(6)
    v_mfma_f32_16x16x32_bf16 v[192:195], v[232:235], v[0:3], 0
    ds_read_b64_tr_b16 v[224:225], v250 offset:4096
    ds_read_b64_tr_b16 v[226:227], v250 offset:4608
    v_mfma_f32_16x16x32_bf16 v[196:199], v[232:235], v[4:7], 0
    s_waitcnt lgkmcnt(6)
    v_mfma_f32_16x16x32_bf16 v[200:203], v[236:239], v[0:3], 0
    ds_read_b64_tr_b16 v[228:229], v251 offset:4096
    ds_read_b64_tr_b16 v[230:231], v251 offset:4608
    v_mfma_f32_16x16x32_bf16 v[204:207], v[236:239], v[4:7], 0
    s_waitcnt lgkmcnt(6)
    v_mul_f32 v144, v144, v252
    v_mul_f32 v145, v145, v252
    v_mfma_f32_16x16x32_bf16 v[176:179], v[240:243], v[8:11], v[176:179]
    ds_read_b64_tr_b16 v[232:233], v248 offset:8192
    ds_read_b64_tr_b16 v[234:235], v248 offset:8704
    v_mfma_f32_16x16x32_bf16 v[180:183], v[240:243], v[12:15], v[180:183]
    s_waitcnt lgkmcnt(6)
    v_exp_f32 v144, v144
    v_mfma_f32_16x16x32_bf16 v[184:187], v[244:247], v[8:11], v[184:187]
    ds_read_b64_tr_b16 v[236:237], v249 offset:8192
    ds_read_b64_tr_b16 v[238:239], v249 offset:8704
    v_mfma_f32_16x16x32_bf16 v[188:191], v[244:247], v[12:15], v[188:191]
    s_waitcnt lgkmcnt(6)
    v_mul_f32 v146, v146, v252
    v_fma_f32 v144, v144, s59, s59
    v_mfma_f32_16x16x32_bf16 v[192:195], v[224:227], v[8:11], v[192:195]
    ds_read_b64_tr_b16 v[240:241], v250 offset:8192
    ds_read_b64_tr_b16 v[242:243], v250 offset:8704
    v_mfma_f32_16x16x32_bf16 v[196:199], v[224:227], v[12:15], v[196:199]
    s_waitcnt lgkmcnt(6)
    v_exp_f32 v145, v145
    v_mfma_f32_16x16x32_bf16 v[200:203], v[228:231], v[8:11], v[200:203]
    ds_read_b64_tr_b16 v[244:245], v251 offset:8192
    ds_read_b64_tr_b16 v[246:247], v251 offset:8704
    v_mfma_f32_16x16x32_bf16 v[204:207], v[228:231], v[12:15], v[204:207]
    s_waitcnt lgkmcnt(6)
    v_mul_f32 v147, v147, v252
    v_fma_f32 v145, v145, s59, s59
    v_mfma_f32_16x16x32_bf16 v[176:179], v[232:235], v[16:19], v[176:179]
    ds_read_b64_tr_b16 v[224:225], v248 offset:12288
    ds_read_b64_tr_b16 v[226:227], v248 offset:12800
    v_mfma_f32_16x16x32_bf16 v[180:183], v[232:235], v[20:23], v[180:183]
    s_waitcnt lgkmcnt(6)
    v_exp_f32 v146, v146
    v_mul_f32 v148, v148, v253
    v_mfma_f32_16x16x32_bf16 v[184:187], v[236:239], v[16:19], v[184:187]
    ds_read_b64_tr_b16 v[228:229], v249 offset:12288
    v_fma_f32 v146, v146, s59, s59
    v_mfma_f32_16x16x32_bf16 v[188:191], v[236:239], v[20:23], v[188:191]
    s_waitcnt lgkmcnt(5)
    ds_read_b64_tr_b16 v[230:231], v249 offset:12800
    v_exp_f32 v147, v147
    v_mfma_f32_16x16x32_bf16 v[192:195], v[240:243], v[16:19], v[192:195]
    ds_read_b64_tr_b16 v[232:233], v250 offset:12288
    ds_read_b64_tr_b16 v[234:235], v250 offset:12800
    v_mfma_f32_16x16x32_bf16 v[196:199], v[240:243], v[20:23], v[196:199]
    s_waitcnt lgkmcnt(6)
    v_mul_f32 v149, v149, v253
    v_fma_f32 v147, v147, s59, s59
    v_mfma_f32_16x16x32_bf16 v[200:203], v[244:247], v[16:19], v[200:203]
    ds_read_b64_tr_b16 v[236:237], v251 offset:12288
    ds_read_b64_tr_b16 v[238:239], v251 offset:12800
    v_mfma_f32_16x16x32_bf16 v[204:207], v[244:247], v[20:23], v[204:207]
    s_waitcnt lgkmcnt(6)
    v_exp_f32 v148, v148
    v_mfma_f32_16x16x32_bf16 v[176:179], v[224:227], v[24:27], v[176:179]
    ds_read_b64_tr_b16 v[240:241], v248 offset:16384
    ds_read_b64_tr_b16 v[242:243], v248 offset:16896
    v_mfma_f32_16x16x32_bf16 v[180:183], v[224:227], v[28:31], v[180:183]
    s_waitcnt lgkmcnt(6)
    v_mul_f32 v150, v150, v253
    v_fma_f32 v148, v148, s59, s59
    v_mfma_f32_16x16x32_bf16 v[184:187], v[228:231], v[24:27], v[184:187]
    ds_read_b64_tr_b16 v[244:245], v249 offset:16384
    ds_read_b64_tr_b16 v[246:247], v249 offset:16896
    v_mfma_f32_16x16x32_bf16 v[188:191], v[228:231], v[28:31], v[188:191]
    s_waitcnt lgkmcnt(6)
    v_exp_f32 v149, v149
    v_mfma_f32_16x16x32_bf16 v[192:195], v[232:235], v[24:27], v[192:195]
    ds_read_b64_tr_b16 v[224:225], v250 offset:16384
    ds_read_b64_tr_b16 v[226:227], v250 offset:16896
    v_mfma_f32_16x16x32_bf16 v[196:199], v[232:235], v[28:31], v[196:199]
    s_waitcnt lgkmcnt(6)
    v_mul_f32 v151, v151, v253
    v_fma_f32 v149, v149, s59, s59
    v_mfma_f32_16x16x32_bf16 v[200:203], v[236:239], v[24:27], v[200:203]
    ds_read_b64_tr_b16 v[228:229], v251 offset:16384
    ds_read_b64_tr_b16 v[230:231], v251 offset:16896
    v_mfma_f32_16x16x32_bf16 v[204:207], v[236:239], v[28:31], v[204:207]
    s_waitcnt lgkmcnt(6)
    v_exp_f32 v150, v150
    v_mfma_f32_16x16x32_bf16 v[176:179], v[240:243], v[32:35], v[176:179]
    ds_read_b64_tr_b16 v[232:233], v248 offset:20480
    ds_read_b64_tr_b16 v[234:235], v248 offset:20992
    v_mfma_f32_16x16x32_bf16 v[180:183], v[240:243], v[36:39], v[180:183]
    s_waitcnt lgkmcnt(6)
    v_cvt_pk_f16_f32 v208, v144, v145
    v_cvt_pk_f16_f32 v209, v146, v147
    v_mfma_f32_16x16x32_bf16 v[184:187], v[244:247], v[32:35], v[184:187]
    ds_read_b64_tr_b16 v[236:237], v249 offset:20480
    ds_read_b64_tr_b16 v[238:239], v249 offset:20992
    v_mfma_f32_16x16x32_bf16 v[188:191], v[244:247], v[36:39], v[188:191]
    s_waitcnt lgkmcnt(6)
    v_mul_f32 v152, v152, v252
    v_fma_f32 v150, v150, s59, s59
    v_mfma_f32_16x16x32_bf16 v[192:195], v[224:227], v[32:35], v[192:195]
    ds_read_b64_tr_b16 v[240:241], v250 offset:20480
    ds_read_b64_tr_b16 v[242:243], v250 offset:20992
    v_mfma_f32_16x16x32_bf16 v[196:199], v[224:227], v[36:39], v[196:199]
    s_waitcnt lgkmcnt(6)
    v_exp_f32 v151, v151
    v_mul_f32 v153, v153, v252
    v_mfma_f32_16x16x32_bf16 v[200:203], v[228:231], v[32:35], v[200:203]
    ds_read_b64_tr_b16 v[244:245], v251 offset:20480
    v_fma_f32 v151, v151, s59, s59
    v_mfma_f32_16x16x32_bf16 v[204:207], v[228:231], v[36:39], v[204:207]
    s_waitcnt lgkmcnt(5)
    ds_read_b64_tr_b16 v[246:247], v251 offset:20992
    v_exp_f32 v152, v152
    v_mfma_f32_16x16x32_bf16 v[176:179], v[232:235], v[40:43], v[176:179]
    s_barrier
    ds_read_b64_tr_b16 v[224:225], v248 offset:24576
    v_mfma_f32_16x16x32_bf16 v[180:183], v[232:235], v[44:47], v[180:183]
    s_waitcnt lgkmcnt(5)
    ds_read_b64_tr_b16 v[226:227], v248 offset:25088
    v_mul_f32 v154, v154, v252
    v_mfma_f32_16x16x32_bf16 v[184:187], v[236:239], v[40:43], v[184:187]
    ds_read_b64_tr_b16 v[228:229], v249 offset:24576
    v_fma_f32 v152, v152, s59, s59
    v_mfma_f32_16x16x32_bf16 v[188:191], v[236:239], v[44:47], v[188:191]
    s_waitcnt lgkmcnt(5)
    ds_read_b64_tr_b16 v[230:231], v249 offset:25088
    v_exp_f32 v153, v153
    v_mfma_f32_16x16x32_bf16 v[192:195], v[240:243], v[40:43], v[192:195]
    ds_read_b64_tr_b16 v[232:233], v250 offset:24576
    ds_read_b64_tr_b16 v[234:235], v250 offset:25088
    v_mfma_f32_16x16x32_bf16 v[196:199], v[240:243], v[44:47], v[196:199]
    s_waitcnt lgkmcnt(6)
    v_mul_f32 v155, v155, v252
    v_fma_f32 v153, v153, s59, s59
    v_mfma_f32_16x16x32_bf16 v[200:203], v[244:247], v[40:43], v[200:203]
    ds_read_b64_tr_b16 v[236:237], v251 offset:24576
    ds_read_b64_tr_b16 v[238:239], v251 offset:25088
    v_mfma_f32_16x16x32_bf16 v[204:207], v[244:247], v[44:47], v[204:207]
    s_waitcnt lgkmcnt(6)
    v_exp_f32 v154, v154
    v_mfma_f32_16x16x32_bf16 v[176:179], v[224:227], v[48:51], v[176:179]
    ds_read_b64_tr_b16 v[240:241], v248 offset:28672
    ds_read_b64_tr_b16 v[242:243], v248 offset:29184
    v_mfma_f32_16x16x32_bf16 v[180:183], v[224:227], v[52:55], v[180:183]
    s_waitcnt lgkmcnt(6)
    v_cvt_pk_f16_f32 v210, v148, v149
    v_cvt_pk_f16_f32 v211, v150, v151
    v_mfma_f32_16x16x32_bf16 v[184:187], v[228:231], v[48:51], v[184:187]
    ds_read_b64_tr_b16 v[244:245], v249 offset:28672
    ds_read_b64_tr_b16 v[246:247], v249 offset:29184
    v_mfma_f32_16x16x32_bf16 v[188:191], v[228:231], v[52:55], v[188:191]
    s_waitcnt lgkmcnt(6)
    v_mul_f32 v156, v156, v253
    v_fma_f32 v154, v154, s59, s59
    v_mfma_f32_16x16x32_bf16 v[192:195], v[232:235], v[48:51], v[192:195]
    ds_read_b64_tr_b16 v[224:225], v250 offset:28672
    ds_read_b64_tr_b16 v[226:227], v250 offset:29184
    v_mfma_f32_16x16x32_bf16 v[196:199], v[232:235], v[52:55], v[196:199]
    s_waitcnt lgkmcnt(6)
    v_exp_f32 v155, v155
    v_mfma_f32_16x16x32_bf16 v[200:203], v[236:239], v[48:51], v[200:203]
    ds_read_b64_tr_b16 v[228:229], v251 offset:28672
    ds_read_b64_tr_b16 v[230:231], v251 offset:29184
    v_mfma_f32_16x16x32_bf16 v[204:207], v[236:239], v[52:55], v[204:207]
    s_waitcnt lgkmcnt(6)
    v_mul_f32 v157, v157, v253
    v_fma_f32 v155, v155, s59, s59
    v_mfma_f32_16x16x32_bf16 v[176:179], v[240:243], v[56:59], v[176:179]
    ds_read_b64_tr_b16 v[232:233], v248 offset:32768
    ds_read_b64_tr_b16 v[234:235], v248 offset:33280
    v_mfma_f32_16x16x32_bf16 v[180:183], v[240:243], v[60:63], v[180:183]
    s_waitcnt lgkmcnt(6)
    v_exp_f32 v156, v156
    v_add_u32 v248, 36864, v248
    v_mfma_f32_16x16x32_bf16 v[184:187], v[244:247], v[56:59], v[184:187]
    ds_read_b64_tr_b16 v[236:237], v249 offset:32768
    v_mul_f32 v158, v158, v253
    v_mfma_f32_16x16x32_bf16 v[188:191], v[244:247], v[60:63], v[188:191]
    s_waitcnt lgkmcnt(5)
    ds_read_b64_tr_b16 v[238:239], v249 offset:33280
    v_fma_f32 v156, v156, s59, s59
    v_add_u32 v249, 36864, v249
    v_mfma_f32_16x16x32_bf16 v[192:195], v[224:227], v[56:59], v[192:195]
    ds_read_b64_tr_b16 v[240:241], v250 offset:32768
    ds_read_b64_tr_b16 v[242:243], v250 offset:33280
    v_mfma_f32_16x16x32_bf16 v[196:199], v[224:227], v[60:63], v[196:199]
    s_waitcnt lgkmcnt(6)
    v_exp_f32 v157, v157
    v_add_u32 v250, 36864, v250
    v_mfma_f32_16x16x32_bf16 v[200:203], v[228:231], v[56:59], v[200:203]
    ds_read_b64_tr_b16 v[244:245], v251 offset:32768
    v_mul_f32 v159, v159, v253
    v_mfma_f32_16x16x32_bf16 v[204:207], v[228:231], v[60:63], v[204:207]
    s_waitcnt lgkmcnt(5)
    ds_read_b64_tr_b16 v[246:247], v251 offset:33280
    v_fma_f32 v157, v157, s59, s59
    v_add_u32 v251, 36864, v251
    v_mfma_f32_16x16x32_bf16 v[176:179], v[232:235], v[64:67], v[176:179]
    ds_read_b64_tr_b16 v[224:225], v248 offset:0
    ds_read_b64_tr_b16 v[226:227], v248 offset:512
    v_mfma_f32_16x16x32_bf16 v[180:183], v[232:235], v[68:71], v[180:183]
    s_waitcnt lgkmcnt(6)
    v_exp_f32 v158, v158
    v_cvt_pk_f16_f32 v212, v152, v153
    v_mfma_f32_16x16x32_bf16 v[184:187], v[236:239], v[64:67], v[184:187]
    ds_read_b64_tr_b16 v[228:229], v249 offset:0
    v_cvt_pk_f16_f32 v213, v154, v155
    v_mfma_f32_16x16x32_bf16 v[188:191], v[236:239], v[68:71], v[188:191]
    s_waitcnt lgkmcnt(5)
    ds_read_b64_tr_b16 v[230:231], v249 offset:512
    v_mul_f32 v160, v160, v252
    v_fma_f32 v158, v158, s59, s59
    v_mfma_f32_16x16x32_bf16 v[192:195], v[240:243], v[64:67], v[192:195]
    ds_read_b64_tr_b16 v[232:233], v250 offset:0
    ds_read_b64_tr_b16 v[234:235], v250 offset:512
    v_mfma_f32_16x16x32_bf16 v[196:199], v[240:243], v[68:71], v[196:199]
    s_waitcnt lgkmcnt(6)
    v_exp_f32 v159, v159
    v_mfma_f32_16x16x32_bf16 v[200:203], v[244:247], v[64:67], v[200:203]
    ds_read_b64_tr_b16 v[236:237], v251 offset:0
    ds_read_b64_tr_b16 v[238:239], v251 offset:512
    v_mfma_f32_16x16x32_bf16 v[204:207], v[244:247], v[68:71], v[204:207]
    s_waitcnt lgkmcnt(6)
    v_mul_f32 v161, v161, v252
    v_fma_f32 v159, v159, s59, s59
    v_mfma_f32_16x16x32_bf16 v[176:179], v[224:227], v[72:75], v[176:179]
    ds_read_b64_tr_b16 v[240:241], v248 offset:4096
    ds_read_b64_tr_b16 v[242:243], v248 offset:4608
    v_mfma_f32_16x16x32_bf16 v[180:183], v[224:227], v[76:79], v[180:183]
    s_waitcnt lgkmcnt(6)
    v_exp_f32 v160, v160
    v_mfma_f32_16x16x32_bf16 v[184:187], v[228:231], v[72:75], v[184:187]
    ds_read_b64_tr_b16 v[244:245], v249 offset:4096
    ds_read_b64_tr_b16 v[246:247], v249 offset:4608
    v_mfma_f32_16x16x32_bf16 v[188:191], v[228:231], v[76:79], v[188:191]
    s_waitcnt lgkmcnt(6)
    v_mul_f32 v162, v162, v252
    v_fma_f32 v160, v160, s59, s59
    v_mfma_f32_16x16x32_bf16 v[192:195], v[232:235], v[72:75], v[192:195]
    ds_read_b64_tr_b16 v[224:225], v250 offset:4096
    ds_read_b64_tr_b16 v[226:227], v250 offset:4608
    v_mfma_f32_16x16x32_bf16 v[196:199], v[232:235], v[76:79], v[196:199]
    s_waitcnt lgkmcnt(6)
    v_exp_f32 v161, v161
    v_mfma_f32_16x16x32_bf16 v[200:203], v[236:239], v[72:75], v[200:203]
    ds_read_b64_tr_b16 v[228:229], v251 offset:4096
    ds_read_b64_tr_b16 v[230:231], v251 offset:4608
    v_mfma_f32_16x16x32_bf16 v[204:207], v[236:239], v[76:79], v[204:207]
    s_waitcnt lgkmcnt(6)
    v_mul_f32 v163, v163, v252
    v_fma_f32 v161, v161, s59, s59
    v_mfma_f32_16x16x32_bf16 v[176:179], v[240:243], v[80:83], v[176:179]
    ds_read_b64_tr_b16 v[232:233], v248 offset:8192
    ds_read_b64_tr_b16 v[234:235], v248 offset:8704
    v_mfma_f32_16x16x32_bf16 v[180:183], v[240:243], v[84:87], v[180:183]
    s_waitcnt lgkmcnt(6)
    v_exp_f32 v162, v162
    v_cvt_pk_f16_f32 v214, v156, v157
    v_mfma_f32_16x16x32_bf16 v[184:187], v[244:247], v[80:83], v[184:187]
    ds_read_b64_tr_b16 v[236:237], v249 offset:8192
    ds_read_b64_tr_b16 v[238:239], v249 offset:8704
    v_mfma_f32_16x16x32_bf16 v[188:191], v[244:247], v[84:87], v[188:191]
    s_waitcnt lgkmcnt(6)
    v_cvt_pk_f16_f32 v215, v158, v159
    v_mul_f32 v164, v164, v253
    v_mfma_f32_16x16x32_bf16 v[192:195], v[224:227], v[80:83], v[192:195]
    ds_read_b64_tr_b16 v[240:241], v250 offset:8192
    v_fma_f32 v162, v162, s59, s59
    v_mfma_f32_16x16x32_bf16 v[196:199], v[224:227], v[84:87], v[196:199]
    s_waitcnt lgkmcnt(5)
    ds_read_b64_tr_b16 v[242:243], v250 offset:8704
    v_exp_f32 v163, v163
    v_mfma_f32_16x16x32_bf16 v[200:203], v[228:231], v[80:83], v[200:203]
    ds_read_b64_tr_b16 v[244:245], v251 offset:8192
    ds_read_b64_tr_b16 v[246:247], v251 offset:8704
    v_mfma_f32_16x16x32_bf16 v[204:207], v[228:231], v[84:87], v[204:207]
    s_waitcnt lgkmcnt(6)
    v_mul_f32 v165, v165, v253
    v_fma_f32 v163, v163, s59, s59
    v_mfma_f32_16x16x32_bf16 v[176:179], v[232:235], v[88:91], v[176:179]
    s_barrier
    ds_read_b64_tr_b16 v[224:225], v248 offset:12288
    ds_read_b64_tr_b16 v[226:227], v248 offset:12800
    v_mfma_f32_16x16x32_bf16 v[180:183], v[232:235], v[92:95], v[180:183]
    s_waitcnt lgkmcnt(6)
    v_exp_f32 v164, v164
    v_mfma_f32_16x16x32_bf16 v[184:187], v[236:239], v[88:91], v[184:187]
    ds_read_b64_tr_b16 v[228:229], v249 offset:12288
    ds_read_b64_tr_b16 v[230:231], v249 offset:12800
    v_mfma_f32_16x16x32_bf16 v[188:191], v[236:239], v[92:95], v[188:191]
    s_waitcnt lgkmcnt(6)
    v_mul_f32 v166, v166, v253
    v_fma_f32 v164, v164, s59, s59
    v_mfma_f32_16x16x32_bf16 v[192:195], v[240:243], v[88:91], v[192:195]
    ds_read_b64_tr_b16 v[232:233], v250 offset:12288
    ds_read_b64_tr_b16 v[234:235], v250 offset:12800
    v_mfma_f32_16x16x32_bf16 v[196:199], v[240:243], v[92:95], v[196:199]
    s_waitcnt lgkmcnt(6)
    v_exp_f32 v165, v165
    v_mfma_f32_16x16x32_bf16 v[200:203], v[244:247], v[88:91], v[200:203]
    ds_read_b64_tr_b16 v[236:237], v251 offset:12288
    ds_read_b64_tr_b16 v[238:239], v251 offset:12800
    v_mfma_f32_16x16x32_bf16 v[204:207], v[244:247], v[92:95], v[204:207]
    s_waitcnt lgkmcnt(6)
    v_mul_f32 v167, v167, v253
    v_fma_f32 v165, v165, s59, s59
    v_mfma_f32_16x16x32_bf16 v[176:179], v[224:227], v[96:99], v[176:179]
    ds_read_b64_tr_b16 v[240:241], v248 offset:16384
    ds_read_b64_tr_b16 v[242:243], v248 offset:16896
    v_mfma_f32_16x16x32_bf16 v[180:183], v[224:227], v[100:103], v[180:183]
    s_waitcnt lgkmcnt(6)
    v_exp_f32 v166, v166
    v_mfma_f32_16x16x32_bf16 v[184:187], v[228:231], v[96:99], v[184:187]
    ds_read_b64_tr_b16 v[244:245], v249 offset:16384
    ds_read_b64_tr_b16 v[246:247], v249 offset:16896
    v_mfma_f32_16x16x32_bf16 v[188:191], v[228:231], v[100:103], v[188:191]
    s_waitcnt lgkmcnt(6)
    v_cvt_pk_f16_f32 v216, v160, v161
    v_cvt_pk_f16_f32 v217, v162, v163
    v_mfma_f32_16x16x32_bf16 v[192:195], v[232:235], v[96:99], v[192:195]
    ds_read_b64_tr_b16 v[224:225], v250 offset:16384
    ds_read_b64_tr_b16 v[226:227], v250 offset:16896
    v_mfma_f32_16x16x32_bf16 v[196:199], v[232:235], v[100:103], v[196:199]
    s_waitcnt lgkmcnt(6)
    v_mul_f32 v168, v168, v252
    v_fma_f32 v166, v166, s59, s59
    v_mfma_f32_16x16x32_bf16 v[200:203], v[236:239], v[96:99], v[200:203]
    ds_read_b64_tr_b16 v[228:229], v251 offset:16384
    ds_read_b64_tr_b16 v[230:231], v251 offset:16896
    v_mfma_f32_16x16x32_bf16 v[204:207], v[236:239], v[100:103], v[204:207]
    s_waitcnt lgkmcnt(6)
    v_exp_f32 v167, v167
    v_mfma_f32_16x16x32_bf16 v[176:179], v[240:243], v[104:107], v[176:179]
    ds_read_b64_tr_b16 v[232:233], v248 offset:20480
    ds_read_b64_tr_b16 v[234:235], v248 offset:20992
    v_mfma_f32_16x16x32_bf16 v[180:183], v[240:243], v[108:111], v[180:183]
    s_waitcnt lgkmcnt(6)
    v_mul_f32 v169, v169, v252
    v_fma_f32 v167, v167, s59, s59
    v_mfma_f32_16x16x32_bf16 v[184:187], v[244:247], v[104:107], v[184:187]
    ds_read_b64_tr_b16 v[236:237], v249 offset:20480
    ds_read_b64_tr_b16 v[238:239], v249 offset:20992
    v_mfma_f32_16x16x32_bf16 v[188:191], v[244:247], v[108:111], v[188:191]
    s_waitcnt lgkmcnt(6)
    v_exp_f32 v168, v168
    v_mul_f32 v170, v170, v252
    v_mfma_f32_16x16x32_bf16 v[192:195], v[224:227], v[104:107], v[192:195]
    ds_read_b64_tr_b16 v[240:241], v250 offset:20480
    v_fma_f32 v168, v168, s59, s59
    v_mfma_f32_16x16x32_bf16 v[196:199], v[224:227], v[108:111], v[196:199]
    s_waitcnt lgkmcnt(5)
    ds_read_b64_tr_b16 v[242:243], v250 offset:20992
    v_exp_f32 v169, v169
    v_mfma_f32_16x16x32_bf16 v[200:203], v[228:231], v[104:107], v[200:203]
    ds_read_b64_tr_b16 v[244:245], v251 offset:20480
    ds_read_b64_tr_b16 v[246:247], v251 offset:20992
    v_mfma_f32_16x16x32_bf16 v[204:207], v[228:231], v[108:111], v[204:207]
    s_waitcnt lgkmcnt(6)
    v_mul_f32 v171, v171, v252
    v_fma_f32 v169, v169, s59, s59
    v_mfma_f32_16x16x32_bf16 v[176:179], v[232:235], v[112:115], v[176:179]
    ds_read_b64_tr_b16 v[224:225], v248 offset:24576
    ds_read_b64_tr_b16 v[226:227], v248 offset:25088
    v_mfma_f32_16x16x32_bf16 v[180:183], v[232:235], v[116:119], v[180:183]
    s_waitcnt lgkmcnt(6)
    v_exp_f32 v170, v170
    v_mfma_f32_16x16x32_bf16 v[184:187], v[236:239], v[112:115], v[184:187]
    ds_read_b64_tr_b16 v[228:229], v249 offset:24576
    ds_read_b64_tr_b16 v[230:231], v249 offset:25088
    v_mfma_f32_16x16x32_bf16 v[188:191], v[236:239], v[116:119], v[188:191]
    s_waitcnt lgkmcnt(6)
    v_cvt_pk_f16_f32 v218, v164, v165
    v_cvt_pk_f16_f32 v219, v166, v167
    v_mfma_f32_16x16x32_bf16 v[192:195], v[240:243], v[112:115], v[192:195]
    ds_read_b64_tr_b16 v[232:233], v250 offset:24576
    ds_read_b64_tr_b16 v[234:235], v250 offset:25088
    v_mfma_f32_16x16x32_bf16 v[196:199], v[240:243], v[116:119], v[196:199]
    s_waitcnt lgkmcnt(6)
    v_mul_f32 v172, v172, v253
    v_fma_f32 v170, v170, s59, s59
    v_mfma_f32_16x16x32_bf16 v[200:203], v[244:247], v[112:115], v[200:203]
    ds_read_b64_tr_b16 v[236:237], v251 offset:24576
    ds_read_b64_tr_b16 v[238:239], v251 offset:25088
    v_mfma_f32_16x16x32_bf16 v[204:207], v[244:247], v[116:119], v[204:207]
    s_waitcnt lgkmcnt(6)
    v_exp_f32 v171, v171
    v_mfma_f32_16x16x32_bf16 v[176:179], v[224:227], v[120:123], v[176:179]
    ds_read_b64_tr_b16 v[240:241], v248 offset:28672
    ds_read_b64_tr_b16 v[242:243], v248 offset:29184
    v_mfma_f32_16x16x32_bf16 v[180:183], v[224:227], v[124:127], v[180:183]
    s_waitcnt lgkmcnt(6)
    v_mul_f32 v173, v173, v253
    v_fma_f32 v171, v171, s59, s59
    v_mfma_f32_16x16x32_bf16 v[184:187], v[228:231], v[120:123], v[184:187]
    ds_read_b64_tr_b16 v[244:245], v249 offset:28672
    ds_read_b64_tr_b16 v[246:247], v249 offset:29184
    v_mfma_f32_16x16x32_bf16 v[188:191], v[228:231], v[124:127], v[188:191]
    s_waitcnt lgkmcnt(6)
    v_exp_f32 v172, v172
    v_mul_f32 v174, v174, v253
    v_mfma_f32_16x16x32_bf16 v[192:195], v[232:235], v[120:123], v[192:195]
    ds_read_b64_tr_b16 v[224:225], v250 offset:28672
    v_fma_f32 v172, v172, s59, s59
    v_mfma_f32_16x16x32_bf16 v[196:199], v[232:235], v[124:127], v[196:199]
    s_waitcnt lgkmcnt(5)
    ds_read_b64_tr_b16 v[226:227], v250 offset:29184
    v_exp_f32 v173, v173
    v_mfma_f32_16x16x32_bf16 v[200:203], v[236:239], v[120:123], v[200:203]
    ds_read_b64_tr_b16 v[228:229], v251 offset:28672
    ds_read_b64_tr_b16 v[230:231], v251 offset:29184
    v_mfma_f32_16x16x32_bf16 v[204:207], v[236:239], v[124:127], v[204:207]
    s_waitcnt lgkmcnt(6)
    v_mul_f32 v175, v175, v253
    v_fma_f32 v173, v173, s59, s59
    v_mfma_f32_16x16x32_bf16 v[176:179], v[240:243], v[128:131], v[176:179]
    ds_read_b64_tr_b16 v[232:233], v248 offset:32768
    ds_read_b64_tr_b16 v[234:235], v248 offset:33280
    v_mfma_f32_16x16x32_bf16 v[180:183], v[240:243], v[132:135], v[180:183]
    s_waitcnt lgkmcnt(6)
    v_exp_f32 v174, v174
    v_add_u32 v248, -110592, v248
    v_mfma_f32_16x16x32_bf16 v[184:187], v[244:247], v[128:131], v[184:187]
    ds_read_b64_tr_b16 v[236:237], v249 offset:32768
    ds_read_b64_tr_b16 v[238:239], v249 offset:33280
    v_mfma_f32_16x16x32_bf16 v[188:191], v[244:247], v[132:135], v[188:191]
    s_waitcnt lgkmcnt(6)
    v_cvt_pk_f16_f32 v220, v168, v169
    v_add_u32 v249, -110592, v249
    v_mfma_f32_16x16x32_bf16 v[192:195], v[224:227], v[128:131], v[192:195]
    ds_read_b64_tr_b16 v[240:241], v250 offset:32768
    v_cvt_pk_f16_f32 v221, v170, v171
    v_mfma_f32_16x16x32_bf16 v[196:199], v[224:227], v[132:135], v[196:199]
    s_waitcnt lgkmcnt(5)
    ds_read_b64_tr_b16 v[242:243], v250 offset:33280
    v_fma_f32 v174, v174, s59, s59
    v_add_u32 v250, -110592, v250
    v_mfma_f32_16x16x32_bf16 v[200:203], v[228:231], v[128:131], v[200:203]
    ds_read_b64_tr_b16 v[244:245], v251 offset:32768
    ds_read_b64_tr_b16 v[246:247], v251 offset:33280
    v_mfma_f32_16x16x32_bf16 v[204:207], v[228:231], v[132:135], v[204:207]
    s_waitcnt lgkmcnt(6)
    v_exp_f32 v175, v175
    v_add_u32 v251, -110592, v251
    v_mfma_f32_16x16x32_bf16 v[176:179], v[232:235], v[136:139], v[176:179]
    s_waitcnt vmcnt(0)
    s_barrier
    ds_read_b64_tr_b16 v[224:225], v248 offset:0
    ds_read_b64_tr_b16 v[226:227], v248 offset:512
    v_mfma_f32_16x16x32_bf16 v[180:183], v[232:235], v[140:143], v[180:183]
    s_waitcnt lgkmcnt(6)
    s_nop 0
    v_fma_f32 v175, v175, s59, s59
    v_mfma_f32_16x16x32_bf16 v[184:187], v[236:239], v[136:139], v[184:187]
    ds_read_b64_tr_b16 v[228:229], v249 offset:0
    ds_read_b64_tr_b16 v[230:231], v249 offset:512
    v_mfma_f32_16x16x32_bf16 v[188:191], v[236:239], v[140:143], v[188:191]
    s_waitcnt lgkmcnt(6)
    v_cvt_pk_f16_f32 v222, v172, v173
    v_cvt_pk_f16_f32 v223, v174, v175
    v_mfma_f32_16x16x32_bf16 v[192:195], v[240:243], v[136:139], v[192:195]
    ds_read_b64_tr_b16 v[232:233], v250 offset:0
    ds_read_b64_tr_b16 v[234:235], v250 offset:512
    v_mfma_f32_16x16x32_bf16 v[196:199], v[240:243], v[140:143], v[196:199]
    s_waitcnt lgkmcnt(6)
    s_sub_u32 s45, s45, 1
    v_mfma_f32_16x16x32_bf16 v[200:203], v[244:247], v[136:139], v[200:203]
    ds_read_b64_tr_b16 v[236:237], v251 offset:0
    ds_read_b64_tr_b16 v[238:239], v251 offset:512
    v_mfma_f32_16x16x32_bf16 v[204:207], v[244:247], v[140:143], v[204:207]
    s_waitcnt lgkmcnt(6)
    s_cmp_lg_u32 s45, 0
    s_cbranch_scc1 K1_GU
    s_setprio 3
    s_barrier
    s_mov_b32 s27, s36
    s_and_b32 s25, s3, 3
    s_and_b32 s26, s14, 3
    s_mul_i32 s30, s27, 72
    s_mul_i32 s33, s25, 18
    s_add_u32 s30, s30, s33
    s_lshl_b32 s30, s30, 12
    s_add_u32 s46, s30, 8388608
    s_add_u32 s53, s46, 73728
    s_and_b32 s35, s14, 3
    s_mul_i32 s35, s35, 9
    s_add_u32 s35, s35, 1
    s_lshr_b32 s35, s35, 1
    s_lshl_b32 s33, s35, 12
    s_add_u32 s30, s46, s33
    buffer_load_dwordx4 v[144:147], v254, s[20:23], s30 offen offset:0 sc1
    buffer_load_dwordx4 v[148:151], v254, s[20:23], s30 offen offset:1024 sc1
    buffer_load_dwordx4 v[152:155], v254, s[20:23], s30 offen offset:2048 sc1
    buffer_load_dwordx4 v[156:159], v254, s[20:23], s30 offen offset:3072 sc1
    s_add_u32 s30, s30, 4096
    s_cmp_eq_u32 s30, s53
    s_cselect_b32 s30, s46, s30
    buffer_load_dwordx4 v[160:163], v254, s[20:23], s30 offen offset:0 sc1
    buffer_load_dwordx4 v[164:167], v254, s[20:23], s30 offen offset:1024 sc1
    buffer_load_dwordx4 v[168:171], v254, s[20:23], s30 offen offset:2048 sc1
    buffer_load_dwordx4 v[172:175], v254, s[20:23], s30 offen offset:3072 sc1
    s_add_u32 s30, s30, 4096
    s_cmp_eq_u32 s30, s53
    s_cselect_b32 s30, s46, s30
    s_load_dwordx4 s[4:7], s[0:1], 48
    s_load_dwordx2 s[8:9], s[0:1], 16
    s_load_dwordx2 s[10:11], s[0:1], 0
    v_mov_b32 v7, v254
    v_lshrrev_b32 v0, 4, v254
    s_mul_i32 s33, s24, 3072
    s_add_u32 s33, s33, 150016
    v_add_u32 v13, s33, v7
    ds_read_b128 v[40:43], v13 offset:0
    ds_read_b128 v[44:47], v13 offset:1024
    ds_read_b128 v[48:51], v13 offset:2048
    v_mov_b32 v63, 150008
    ds_read_b32 v62, v63
    v_and_b32 v2, 31, v0
    v_lshrrev_b32 v3, 5, v0
    v_bfe_u32 v4, v0, 2, 2
    v_and_b32 v5, 3, v0
    v_bfe_u32 v6, v0, 4, 1
    v_lshrrev_b32 v8, 2, v0
    v_mul_u32_u24 v8, 288, v8
    v_lshl_add_u32 v8, v5, 3, v8
    v_add_u32 v10, 36864, v8
    v_rcp_f16_sdwa v208, v208 dst_sel:WORD_0 dst_unused:UNUSED_PRESERVE src0_sel:WORD_0
    v_rcp_f16_sdwa v209, v209 dst_sel:WORD_0 dst_unused:UNUSED_PRESERVE src0_sel:WORD_0
    v_rcp_f16_sdwa v208, v208 dst_sel:WORD_1 dst_unused:UNUSED_PRESERVE src0_sel:WORD_1
    v_rcp_f16_sdwa v209, v209 dst_sel:WORD_1 dst_unused:UNUSED_PRESERVE src0_sel:WORD_1
    v_rcp_f16_sdwa v212, v212 dst_sel:WORD_0 dst_unused:UNUSED_PRESERVE src0_sel:WORD_0
    v_fma_mix_f32 v176, v176, v208, 0 op_sel:[0,0,0] op_sel_hi:[0,1,0]
    v_fma_mix_f32 v177, v177, v208, 0 op_sel:[0,1,0] op_sel_hi:[0,1,0]
    v_rcp_f16_sdwa v213, v213 dst_sel:WORD_0 dst_unused:UNUSED_PRESERVE src0_sel:WORD_0
    v_fma_mix_f32 v178, v178, v209, 0 op_sel:[0,0,0] op_sel_hi:[0,1,0]
    v_fma_mix_f32 v179, v179, v209, 0 op_sel:[0,1,0] op_sel_hi:[0,1,0]
    v_rcp_f16_sdwa v212, v212 dst_sel:WORD_1 dst_unused:UNUSED_PRESERVE src0_sel:WORD_1
    v_cvt_pk_bf16_f32 v176, v176, v177
    v_cvt_pk_bf16_f32 v177, v178, v179
    v_rcp_f16_sdwa v213, v213 dst_sel:WORD_1 dst_unused:UNUSED_PRESERVE src0_sel:WORD_1
    v_rcp_f16_sdwa v210, v210 dst_sel:WORD_0 dst_unused:UNUSED_PRESERVE src0_sel:WORD_0
    v_fma_mix_f32 v184, v184, v212, 0 op_sel:[0,0,0] op_sel_hi:[0,1,0]
    v_fma_mix_f32 v185, v185, v212, 0 op_sel:[0,1,0] op_sel_hi:[0,1,0]
    v_rcp_f16_sdwa v211, v211 dst_sel:WORD_0 dst_unused:UNUSED_PRESERVE src0_sel:WORD_0
    v_fma_mix_f32 v186, v186, v213, 0 op_sel:[0,0,0] op_sel_hi:[0,1,0]
    v_fma_mix_f32 v187, v187, v213, 0 op_sel:[0,1,0] op_sel_hi:[0,1,0]
    v_rcp_f16_sdwa v210, v210 dst_sel:WORD_1 dst_unused:UNUSED_PRESERVE src0_sel:WORD_1
    v_cvt_pk_bf16_f32 v178, v184, v185
    v_cvt_pk_bf16_f32 v179, v186, v187
    v_rcp_f16_sdwa v211, v211 dst_sel:WORD_1 dst_unused:UNUSED_PRESERVE src0_sel:WORD_1
    buffer_store_dwordx4 v[176:179], v254, s[20:23], s41 offen offset:0 sc1
    v_rcp_f16_sdwa v214, v214 dst_sel:WORD_0 dst_unused:UNUSED_PRESERVE src0_sel:WORD_0
    v_fma_mix_f32 v180, v180, v210, 0 op_sel:[0,0,0] op_sel_hi:[0,1,0]
    v_fma_mix_f32 v181, v181, v210, 0 op_sel:[0,1,0] op_sel_hi:[0,1,0]
    v_rcp_f16_sdwa v215, v215 dst_sel:WORD_0 dst_unused:UNUSED_PRESERVE src0_sel:WORD_0
    v_fma_mix_f32 v182, v182, v211, 0 op_sel:[0,0,0] op_sel_hi:[0,1,0]
    v_fma_mix_f32 v183, v183, v211, 0 op_sel:[0,1,0] op_sel_hi:[0,1,0]
    v_rcp_f16_sdwa v214, v214 dst_sel:WORD_1 dst_unused:UNUSED_PRESERVE src0_sel:WORD_1
    v_cvt_pk_bf16_f32 v180, v180, v181
    v_cvt_pk_bf16_f32 v181, v182, v183
    v_rcp_f16_sdwa v215, v215 dst_sel:WORD_1 dst_unused:UNUSED_PRESERVE src0_sel:WORD_1
    v_rcp_f16_sdwa v216, v216 dst_sel:WORD_0 dst_unused:UNUSED_PRESERVE src0_sel:WORD_0
    v_fma_mix_f32 v188, v188, v214, 0 op_sel:[0,0,0] op_sel_hi:[0,1,0]
    v_fma_mix_f32 v189, v189, v214, 0 op_sel:[0,1,0] op_sel_hi:[0,1,0]
    v_rcp_f16_sdwa v217, v217 dst_sel:WORD_0 dst_unused:UNUSED_PRESERVE src0_sel:WORD_0
    v_fma_mix_f32 v190, v190, v215, 0 op_sel:[0,0,0] op_sel_hi:[0,1,0]
    v_fma_mix_f32 v191, v191, v215, 0 op_sel:[0,1,0] op_sel_hi:[0,1,0]
    v_rcp_f16_sdwa v216, v216 dst_sel:WORD_1 dst_unused:UNUSED_PRESERVE src0_sel:WORD_1
    v_cvt_pk_bf16_f32 v182, v188, v189
    v_cvt_pk_bf16_f32 v183, v190, v191
    v_rcp_f16_sdwa v217, v217 dst_sel:WORD_1 dst_unused:UNUSED_PRESERVE src0_sel:WORD_1
    buffer_store_dwordx4 v[180:183], v254, s[20:23], s41 offen offset:1024 sc1
    v_rcp_f16_sdwa v220, v220 dst_sel:WORD_0 dst_unused:UNUSED_PRESERVE src0_sel:WORD_0
    v_fma_mix_f32 v192, v192, v216, 0 op_sel:[0,0,0] op_sel_hi:[0,1,0]
    v_fma_mix_f32 v193, v193, v216, 0 op_sel:[0,1,0] op_sel_hi:[0,1,0]
    v_rcp_f16_sdwa v221, v221 dst_sel:WORD_0 dst_unused:UNUSED_PRESERVE src0_sel:WORD_0
    v_fma_mix_f32 v194, v194, v217, 0 op_sel:[0,0,0] op_sel_hi:[0,1,0]
    v_fma_mix_f32 v195, v195, v217, 0 op_sel:[0,1,0] op_sel_hi:[0,1,0]
    v_rcp_f16_sdwa v220, v220 dst_sel:WORD_1 dst_unused:UNUSED_PRESERVE src0_sel:WORD_1
    v_cvt_pk_bf16_f32 v192, v192, v193
    v_cvt_pk_bf16_f32 v193, v194, v195
    v_rcp_f16_sdwa v221, v221 dst_sel:WORD_1 dst_unused:UNUSED_PRESERVE src0_sel:WORD_1
    v_rcp_f16_sdwa v218, v218 dst_sel:WORD_0 dst_unused:UNUSED_PRESERVE src0_sel:WORD_0
    v_fma_mix_f32 v200, v200, v220, 0 op_sel:[0,0,0] op_sel_hi:[0,1,0]
    v_fma_mix_f32 v201, v201, v220, 0 op_sel:[0,1,0] op_sel_hi:[0,1,0]
    v_rcp_f16_sdwa v219, v219 dst_sel:WORD_0 dst_unused:UNUSED_PRESERVE src0_sel:WORD_0
    v_fma_mix_f32 v202, v202, v221, 0 op_sel:[0,0,0] op_sel_hi:[0,1,0]
    v_fma_mix_f32 v203, v203, v221, 0 op_sel:[0,1,0] op_sel_hi:[0,1,0]
    v_rcp_f16_sdwa v218, v218 dst_sel:WORD_1 dst_unused:UNUSED_PRESERVE src0_sel:WORD_1
    v_cvt_pk_bf16_f32 v194, v200, v201
    v_cvt_pk_bf16_f32 v195, v202, v203
    v_rcp_f16_sdwa v219, v219 dst_sel:WORD_1 dst_unused:UNUSED_PRESERVE src0_sel:WORD_1
    buffer_store_dwordx4 v[192:195], v254, s[20:23], s41 offen offset:2048 sc1
    v_rcp_f16_sdwa v222, v222 dst_sel:WORD_0 dst_unused:UNUSED_PRESERVE src0_sel:WORD_0
    v_fma_mix_f32 v196, v196, v218, 0 op_sel:[0,0,0] op_sel_hi:[0,1,0]
    v_fma_mix_f32 v197, v197, v218, 0 op_sel:[0,1,0] op_sel_hi:[0,1,0]
    v_rcp_f16_sdwa v223, v223 dst_sel:WORD_0 dst_unused:UNUSED_PRESERVE src0_sel:WORD_0
    v_fma_mix_f32 v198, v198, v219, 0 op_sel:[0,0,0] op_sel_hi:[0,1,0]
    v_fma_mix_f32 v199, v199, v219, 0 op_sel:[0,1,0] op_sel_hi:[0,1,0]
    v_rcp_f16_sdwa v222, v222 dst_sel:WORD_1 dst_unused:UNUSED_PRESERVE src0_sel:WORD_1
    v_cvt_pk_bf16_f32 v196, v196, v197
    v_cvt_pk_bf16_f32 v197, v198, v199
    v_rcp_f16_sdwa v223, v223 dst_sel:WORD_1 dst_unused:UNUSED_PRESERVE src0_sel:WORD_1
    s_nop 0
    s_nop 0
    v_fma_mix_f32 v204, v204, v222, 0 op_sel:[0,0,0] op_sel_hi:[0,1,0]
    v_fma_mix_f32 v205, v205, v222, 0 op_sel:[0,1,0] op_sel_hi:[0,1,0]
    v_fma_mix_f32 v206, v206, v223, 0 op_sel:[0,0,0] op_sel_hi:[0,1,0]
    v_fma_mix_f32 v207, v207, v223, 0 op_sel:[0,1,0] op_sel_hi:[0,1,0]
    v_cvt_pk_bf16_f32 v198, v204, v205
    v_cvt_pk_bf16_f32 v199, v206, v207
    buffer_store_dwordx4 v[196:199], v254, s[20:23], s41 offen offset:3072 sc1
    s_add_u32 s41, s41, 4096
    s_mul_i32 s57, s25, 1327104
    s_mul_i32 s55, s25, 165888
    s_add_u32 s75, s57, 1327104
    s_add_u32 s35, s35, 3
    s_mul_i32 s33, s35, 73728
    s_add_u32 s29, s57, s33
    s_lshl_b32 s38, s24, 10
    s_add_u32 s36, s38, 16384
    s_cmp_lt_u32 s24, 2
    s_cselect_b32 s40, s36, 0x28000
    v_and_b32 v12, 15, v0
    v_lshlrev_b32 v13, 2, v12
    s_mul_i32 s72, s15, 768
    s_add_u32 s72, s72, 55574528
    s_add_u32 s39, s72, 128
    s_mov_b64 s[36:37], 15
    s_andn2_b32 s32, s15, 0x18
    s_mul_i32 s32, s32, 768
    s_lshl_b32 s34, s26, 2
    s_add_u32 s32, s32, s34
    s_add_u32 s32, s32, 55574656
    s_cmp_eq_u32 s24, 0
    s_cselect_b64 vcc, 15, 0
    v_mul_u32_u24 v61, 6144, v0
    v_mov_b32 v63, 0x7ffffff0
    v_cndmask_b32 v61, v63, v61, vcc
    s_waitcnt lgkmcnt(0)
    v_readfirstlane_b32 s101, v62
    s_nop 0
    ds_read_b64_tr_b16 v[16:17], v8 offset:256
    ds_read_b64_tr_b16 v[18:19], v8 offset:4864
    ds_read_b64_tr_b16 v[20:21], v8 offset:64
    ds_read_b64_tr_b16 v[22:23], v8 offset:4672
    ds_read_b64_tr_b16 v[24:25], v8 offset:96
    ds_read_b64_tr_b16 v[26:27], v8 offset:4704
    ds_read_b64_tr_b16 v[28:29], v8 offset:128
    ds_read_b64_tr_b16 v[30:31], v8 offset:4736
    s_mov_b32 s16, s4
    s_mov_b32 s17, s5
    s_mov_b32 s18, 5308416
    s_mov_b32 s19, 0x00020000
    s_mov_b32 s68, s8
    s_mov_b32 s69, s9
    s_mov_b32 s70, 663552
    s_mov_b32 s71, 0x00020000
    s_mov_b32 s60, s10
    s_mov_b32 s61, s11
    s_mov_b32 s62, 2359296
    s_mov_b32 s63, 0x00020000
    s_mov_b32 s64, s6
    s_mov_b32 s65, s7
    s_mov_b32 s66, 2359296
    s_mov_b32 s67, 0x00020000
    s_mov_b32 s31, 1
    s_setprio 0
    s_waitcnt vmcnt(8)
    s_waitcnt lgkmcnt(6)
    v_mfma_f32_16x16x32_bf16 v[128:131], v[16:19], v[144:147], 0
    ds_read_b64_tr_b16 v[32:33], v8 offset:160
    v_mfma_f32_16x16x32_bf16 v[132:135], v[16:19], v[148:151], 0
    s_waitcnt lgkmcnt(5)
    ds_read_b64_tr_b16 v[34:35], v8 offset:4768
    v_mfma_f32_16x16x32_bf16 v[80:83], v[20:23], v[144:147], 0
    ds_read_b64_tr_b16 v[36:37], v8 offset:192
    v_mfma_f32_16x16x32_bf16 v[84:87], v[20:23], v[148:151], 0
    s_waitcnt lgkmcnt(5)
    ds_read_b64_tr_b16 v[38:39], v8 offset:4800
    v_mfma_f32_16x16x32_bf16 v[88:91], v[24:27], v[144:147], 0
    ds_read_b64_tr_b16 v[16:17], v8 offset:224
    v_mfma_f32_16x16x32_bf16 v[92:95], v[24:27], v[148:151], 0
    s_waitcnt lgkmcnt(5)
    ds_read_b64_tr_b16 v[18:19], v8 offset:4832
    v_mfma_f32_16x16x32_bf16 v[96:99], v[28:31], v[144:147], 0
    ds_read_b64_tr_b16 v[20:21], v8 offset:0
    v_mfma_f32_16x16x32_bf16 v[100:103], v[28:31], v[148:151], 0
    s_waitcnt lgkmcnt(5)
    ds_read_b64_tr_b16 v[22:23], v8 offset:4608
    v_mfma_f32_16x16x32_bf16 v[104:107], v[32:35], v[144:147], 0
    ds_read_b64_tr_b16 v[24:25], v8 offset:32
    v_mfma_f32_16x16x32_bf16 v[108:111], v[32:35], v[148:151], 0
    s_waitcnt lgkmcnt(5)
    ds_read_b64_tr_b16 v[26:27], v8 offset:4640
    v_mfma_f32_16x16x32_bf16 v[112:115], v[36:39], v[144:147], 0
    s_barrier
    ds_read_b64_tr_b16 v[28:29], v8 offset:9472
    v_mfma_f32_16x16x32_bf16 v[116:119], v[36:39], v[148:151], 0
    s_waitcnt lgkmcnt(5)
    ds_read_b64_tr_b16 v[30:31], v8 offset:14080
    v_mfma_f32_16x16x32_bf16 v[120:123], v[16:19], v[144:147], 0
    ds_read_b64_tr_b16 v[32:33], v8 offset:9280
    v_mfma_f32_16x16x32_bf16 v[124:127], v[16:19], v[148:151], 0
    s_waitcnt lgkmcnt(5)
    ds_read_b64_tr_b16 v[34:35], v8 offset:13888
    v_mfma_f32_16x16x32_bf16 v[64:67], v[20:23], v[144:147], 0
    ds_read_b64_tr_b16 v[36:37], v8 offset:9312
    v_mfma_f32_16x16x32_bf16 v[68:71], v[20:23], v[148:151], 0
    s_waitcnt lgkmcnt(5)
    ds_read_b64_tr_b16 v[38:39], v8 offset:13920
    v_mfma_f32_16x16x32_bf16 v[72:75], v[24:27], v[144:147], 0
    ds_read_b64_tr_b16 v[16:17], v8 offset:9344
    v_mfma_f32_16x16x32_bf16 v[76:79], v[24:27], v[148:151], 0
    s_waitcnt lgkmcnt(5)
    ds_read_b64_tr_b16 v[18:19], v8 offset:13952
    v_mfma_f32_16x16x32_bf16 v[128:131], v[28:31], v[152:155], v[128:131]
    ds_read_b64_tr_b16 v[20:21], v8 offset:9376
    v_mfma_f32_16x16x32_bf16 v[132:135], v[28:31], v[156:159], v[132:135]
    s_waitcnt lgkmcnt(5)
    ds_read_b64_tr_b16 v[22:23], v8 offset:13984
    v_mfma_f32_16x16x32_bf16 v[80:83], v[32:35], v[152:155], v[80:83]
    ds_read_b64_tr_b16 v[24:25], v8 offset:9408
    v_mfma_f32_16x16x32_bf16 v[84:87], v[32:35], v[156:159], v[84:87]
    s_waitcnt lgkmcnt(5)
    ds_read_b64_tr_b16 v[26:27], v8 offset:14016
    v_mfma_f32_16x16x32_bf16 v[88:91], v[36:39], v[152:155], v[88:91]
    ds_read_b64_tr_b16 v[28:29], v8 offset:9440
    v_mfma_f32_16x16x32_bf16 v[92:95], v[36:39], v[156:159], v[92:95]
    s_waitcnt lgkmcnt(5)
    ds_read_b64_tr_b16 v[30:31], v8 offset:14048
    v_mfma_f32_16x16x32_bf16 v[96:99], v[16:19], v[152:155], v[96:99]
    ds_read_b64_tr_b16 v[32:33], v8 offset:9216
    v_mfma_f32_16x16x32_bf16 v[100:103], v[16:19], v[156:159], v[100:103]
    s_waitcnt lgkmcnt(5)
    ds_read_b64_tr_b16 v[34:35], v8 offset:13824
    v_mfma_f32_16x16x32_bf16 v[104:107], v[20:23], v[152:155], v[104:107]
    ds_read_b64_tr_b16 v[36:37], v8 offset:9248
    v_mfma_f32_16x16x32_bf16 v[108:111], v[20:23], v[156:159], v[108:111]
    s_waitcnt lgkmcnt(5)
    ds_read_b64_tr_b16 v[38:39], v8 offset:13856
    v_mfma_f32_16x16x32_bf16 v[112:115], v[24:27], v[152:155], v[112:115]
    s_waitcnt vmcnt(0)
    s_barrier
    buffer_store_dword v62, v61, s[20:23], s32 offen sc1
    ds_read_b64_tr_b16 v[16:17], v8 offset:18688
    v_mfma_f32_16x16x32_bf16 v[116:119], v[24:27], v[156:159], v[116:119]
    s_waitcnt lgkmcnt(5)
    ds_read_b64_tr_b16 v[18:19], v8 offset:23296
    buffer_load_dwordx4 v[176:179], v7, s[20:23], s30 offen offset:0 sc1
    buffer_load_dwordx4 v[180:183], v7, s[20:23], s30 offen offset:1024 sc1
    v_mfma_f32_16x16x32_bf16 v[120:123], v[28:31], v[152:155], v[120:123]
    ds_read_b64_tr_b16 v[20:21], v8 offset:18496
    v_mfma_f32_16x16x32_bf16 v[124:127], v[28:31], v[156:159], v[124:127]
    s_waitcnt lgkmcnt(5)
    ds_read_b64_tr_b16 v[22:23], v8 offset:23104
    v_mfma_f32_16x16x32_bf16 v[64:67], v[32:35], v[152:155], v[64:67]
    ds_read_b64_tr_b16 v[24:25], v8 offset:18528
    v_mfma_f32_16x16x32_bf16 v[68:71], v[32:35], v[156:159], v[68:71]
    s_waitcnt lgkmcnt(5)
    ds_read_b64_tr_b16 v[26:27], v8 offset:23136
    v_mfma_f32_16x16x32_bf16 v[72:75], v[36:39], v[152:155], v[72:75]
    ds_read_b64_tr_b16 v[28:29], v8 offset:18560
    v_mfma_f32_16x16x32_bf16 v[76:79], v[36:39], v[156:159], v[76:79]
    s_waitcnt lgkmcnt(5)
    ds_read_b64_tr_b16 v[30:31], v8 offset:23168
    buffer_load_dwordx4 v[184:187], v7, s[20:23], s30 offen offset:2048 sc1
    buffer_load_dwordx4 v[188:191], v7, s[20:23], s30 offen offset:3072 sc1
    s_add_u32 s30, s30, 4096
    s_cmp_eq_u32 s30, s53
    s_cselect_b32 s30, s46, s30
    v_mfma_f32_16x16x32_bf16 v[128:131], v[16:19], v[160:163], v[128:131]
    ds_read_b64_tr_b16 v[32:33], v8 offset:18592
    v_mfma_f32_16x16x32_bf16 v[132:135], v[16:19], v[164:167], v[132:135]
    s_waitcnt lgkmcnt(5)
    ds_read_b64_tr_b16 v[34:35], v8 offset:23200
    v_mfma_f32_16x16x32_bf16 v[80:83], v[20:23], v[160:163], v[80:83]
    ds_read_b64_tr_b16 v[36:37], v8 offset:18624
    v_mfma_f32_16x16x32_bf16 v[84:87], v[20:23], v[164:167], v[84:87]
    s_waitcnt lgkmcnt(5)
    ds_read_b64_tr_b16 v[38:39], v8 offset:23232
    v_mfma_f32_16x16x32_bf16 v[88:91], v[24:27], v[160:163], v[88:91]
    ds_read_b64_tr_b16 v[16:17], v8 offset:18656
    v_mfma_f32_16x16x32_bf16 v[92:95], v[24:27], v[164:167], v[92:95]
    s_waitcnt lgkmcnt(5)
    ds_read_b64_tr_b16 v[18:19], v8 offset:23264
    s_add_u32 m0, s38, 55296
    s_nop 0
    buffer_load_dwordx4 v40, s[16:19], s29 offen lds
    s_add_u32 m0, s38, 59392
    s_nop 0
    buffer_load_dwordx4 v41, s[16:19], s29 offen lds
    v_mfma_f32_16x16x32_bf16 v[96:99], v[28:31], v[160:163], v[96:99]
    ds_read_b64_tr_b16 v[20:21], v8 offset:18432
    v_mfma_f32_16x16x32_bf16 v[100:103], v[28:31], v[164:167], v[100:103]
    s_waitcnt lgkmcnt(5)
    ds_read_b64_tr_b16 v[22:23], v8 offset:23040
    v_mfma_f32_16x16x32_bf16 v[104:107], v[32:35], v[160:163], v[104:107]
    ds_read_b64_tr_b16 v[24:25], v8 offset:18464
    v_mfma_f32_16x16x32_bf16 v[108:111], v[32:35], v[164:167], v[108:111]
    s_waitcnt lgkmcnt(5)
    ds_read_b64_tr_b16 v[26:27], v8 offset:23072
    v_mfma_f32_16x16x32_bf16 v[112:115], v[36:39], v[160:163], v[112:115]
    s_barrier
    ds_read_b64_tr_b16 v[28:29], v8 offset:27904
    v_mfma_f32_16x16x32_bf16 v[116:119], v[36:39], v[164:167], v[116:119]
    s_waitcnt lgkmcnt(5)
    ds_read_b64_tr_b16 v[30:31], v8 offset:32512
    v_mfma_f32_16x16x32_bf16 v[120:123], v[16:19], v[160:163], v[120:123]
    ds_read_b64_tr_b16 v[32:33], v8 offset:27712
    v_mfma_f32_16x16x32_bf16 v[124:127], v[16:19], v[164:167], v[124:127]
    s_waitcnt lgkmcnt(5)
    ds_read_b64_tr_b16 v[34:35], v8 offset:32320
    s_add_u32 m0, s38, 63488
    s_nop 0
    buffer_load_dwordx4 v42, s[16:19], s29 offen lds
    s_add_u32 m0, s38, 67584
    s_nop 0
    buffer_load_dwordx4 v43, s[16:19], s29 offen lds
    v_mfma_f32_16x16x32_bf16 v[64:67], v[20:23], v[160:163], v[64:67]
    ds_read_b64_tr_b16 v[36:37], v8 offset:27744
    v_mfma_f32_16x16x32_bf16 v[68:71], v[20:23], v[164:167], v[68:71]
    s_waitcnt lgkmcnt(5)
    ds_read_b64_tr_b16 v[38:39], v8 offset:32352
    v_mfma_f32_16x16x32_bf16 v[72:75], v[24:27], v[160:163], v[72:75]
    ds_read_b64_tr_b16 v[16:17], v8 offset:27776
    v_mfma_f32_16x16x32_bf16 v[76:79], v[24:27], v[164:167], v[76:79]
    s_waitcnt lgkmcnt(5)
    ds_read_b64_tr_b16 v[18:19], v8 offset:32384
    v_mfma_f32_16x16x32_bf16 v[128:131], v[28:31], v[168:171], v[128:131]
    ds_read_b64_tr_b16 v[20:21], v8 offset:27808
    v_mfma_f32_16x16x32_bf16 v[132:135], v[28:31], v[172:175], v[132:135]
    s_waitcnt lgkmcnt(5)
    ds_read_b64_tr_b16 v[22:23], v8 offset:32416
    s_add_u32 m0, s40, 55296
    s_nop 0
    buffer_load_dwordx4 v44, s[16:19], s29 offen lds
    s_add_u32 s29, s29, 73728
    s_cmp_eq_u32 s29, s75
    s_cselect_b32 s29, s57, s29
    v_mfma_f32_16x16x32_bf16 v[80:83], v[32:35], v[168:171], v[80:83]
    ds_read_b64_tr_b16 v[24:25], v8 offset:27840
    v_mfma_f32_16x16x32_bf16 v[84:87], v[32:35], v[172:175], v[84:87]
    s_waitcnt lgkmcnt(5)
    ds_read_b64_tr_b16 v[26:27], v8 offset:32448
    v_mfma_f32_16x16x32_bf16 v[88:91], v[36:39], v[168:171], v[88:91]
    ds_read_b64_tr_b16 v[28:29], v8 offset:27872
    v_mfma_f32_16x16x32_bf16 v[92:95], v[36:39], v[172:175], v[92:95]
    s_waitcnt lgkmcnt(5)
    ds_read_b64_tr_b16 v[30:31], v8 offset:32480
    v_mfma_f32_16x16x32_bf16 v[96:99], v[16:19], v[168:171], v[96:99]
    ds_read_b64_tr_b16 v[32:33], v8 offset:27648
    v_mfma_f32_16x16x32_bf16 v[100:103], v[16:19], v[172:175], v[100:103]
    s_waitcnt lgkmcnt(5)
    ds_read_b64_tr_b16 v[34:35], v8 offset:32256
    v_mfma_f32_16x16x32_bf16 v[104:107], v[20:23], v[168:171], v[104:107]
    ds_read_b64_tr_b16 v[36:37], v8 offset:27680
    v_mfma_f32_16x16x32_bf16 v[108:111], v[20:23], v[172:175], v[108:111]
    s_waitcnt lgkmcnt(5)
    ds_read_b64_tr_b16 v[38:39], v8 offset:32288
    v_mfma_f32_16x16x32_bf16 v[112:115], v[24:27], v[168:171], v[112:115]
    s_waitcnt vmcnt(5)
    s_barrier
    ds_read_b64_tr_b16 v[16:17], v10 offset:256
    v_mfma_f32_16x16x32_bf16 v[116:119], v[24:27], v[172:175], v[116:119]
    s_waitcnt lgkmcnt(5)
    ds_read_b64_tr_b16 v[18:19], v10 offset:4864
    buffer_load_dwordx4 v[192:195], v7, s[20:23], s30 offen offset:0 sc1
    buffer_load_dwordx4 v[196:199], v7, s[20:23], s30 offen offset:1024 sc1
    v_mfma_f32_16x16x32_bf16 v[120:123], v[28:31], v[168:171], v[120:123]
    ds_read_b64_tr_b16 v[20:21], v10 offset:64
    v_mfma_f32_16x16x32_bf16 v[124:127], v[28:31], v[172:175], v[124:127]
    s_waitcnt lgkmcnt(5)
    ds_read_b64_tr_b16 v[22:23], v10 offset:4672
    v_mfma_f32_16x16x32_bf16 v[64:67], v[32:35], v[168:171], v[64:67]
    ds_read_b64_tr_b16 v[24:25], v10 offset:96
    v_mfma_f32_16x16x32_bf16 v[68:71], v[32:35], v[172:175], v[68:71]
    s_waitcnt lgkmcnt(5)
    ds_read_b64_tr_b16 v[26:27], v10 offset:4704
    v_mfma_f32_16x16x32_bf16 v[72:75], v[36:39], v[168:171], v[72:75]
    ds_read_b64_tr_b16 v[28:29], v10 offset:128
    v_mfma_f32_16x16x32_bf16 v[76:79], v[36:39], v[172:175], v[76:79]
    s_waitcnt lgkmcnt(5)
    ds_read_b64_tr_b16 v[30:31], v10 offset:4736
    buffer_load_dwordx4 v[200:203], v7, s[20:23], s30 offen offset:2048 sc1
    buffer_load_dwordx4 v[204:207], v7, s[20:23], s30 offen offset:3072 sc1
    s_add_u32 s30, s30, 4096
    s_cmp_eq_u32 s30, s53
    s_cselect_b32 s30, s46, s30
    v_mfma_f32_16x16x32_bf16 v[128:131], v[16:19], v[176:179], v[128:131]
    ds_read_b64_tr_b16 v[32:33], v10 offset:160
    v_mfma_f32_16x16x32_bf16 v[132:135], v[16:19], v[180:183], v[132:135]
    s_waitcnt lgkmcnt(5)
    ds_read_b64_tr_b16 v[34:35], v10 offset:4768
    v_mfma_f32_16x16x32_bf16 v[80:83], v[20:23], v[176:179], v[80:83]
    ds_read_b64_tr_b16 v[36:37], v10 offset:192
    v_mfma_f32_16x16x32_bf16 v[84:87], v[20:23], v[180:183], v[84:87]
    s_waitcnt lgkmcnt(5)
    ds_read_b64_tr_b16 v[38:39], v10 offset:4800
    buffer_load_dword v60, v13, s[20:23], s39 offen sc1
    v_mfma_f32_16x16x32_bf16 v[88:91], v[24:27], v[176:179], v[88:91]
    ds_read_b64_tr_b16 v[16:17], v10 offset:224
    v_mfma_f32_16x16x32_bf16 v[92:95], v[24:27], v[180:183], v[92:95]
    s_waitcnt lgkmcnt(5)
    ds_read_b64_tr_b16 v[18:19], v10 offset:4832
    s_add_u32 m0, s38, 0
    s_nop 0
    buffer_load_dwordx4 v40, s[16:19], s29 offen lds
    s_add_u32 m0, s38, 4096
    s_nop 0
    buffer_load_dwordx4 v41, s[16:19], s29 offen lds
    v_mfma_f32_16x16x32_bf16 v[96:99], v[28:31], v[176:179], v[96:99]
    ds_read_b64_tr_b16 v[20:21], v10 offset:0
    v_mfma_f32_16x16x32_bf16 v[100:103], v[28:31], v[180:183], v[100:103]
    s_waitcnt lgkmcnt(5)
    ds_read_b64_tr_b16 v[22:23], v10 offset:4608
    v_mfma_f32_16x16x32_bf16 v[104:107], v[32:35], v[176:179], v[104:107]
    ds_read_b64_tr_b16 v[24:25], v10 offset:32
    v_mfma_f32_16x16x32_bf16 v[108:111], v[32:35], v[180:183], v[108:111]
    s_waitcnt lgkmcnt(5)
    ds_read_b64_tr_b16 v[26:27], v10 offset:4640
    v_mfma_f32_16x16x32_bf16 v[112:115], v[36:39], v[176:179], v[112:115]
    s_barrier
    ds_read_b64_tr_b16 v[28:29], v10 offset:9472
    v_mfma_f32_16x16x32_bf16 v[116:119], v[36:39], v[180:183], v[116:119]
    s_waitcnt lgkmcnt(5)
    ds_read_b64_tr_b16 v[30:31], v10 offset:14080
    v_mfma_f32_16x16x32_bf16 v[120:123], v[16:19], v[176:179], v[120:123]
    ds_read_b64_tr_b16 v[32:33], v10 offset:9280
    v_mfma_f32_16x16x32_bf16 v[124:127], v[16:19], v[180:183], v[124:127]
    s_waitcnt lgkmcnt(5)
    ds_read_b64_tr_b16 v[34:35], v10 offset:13888
    s_add_u32 m0, s38, 8192
    s_nop 0
    buffer_load_dwordx4 v42, s[16:19], s29 offen lds
    s_add_u32 m0, s38, 12288
    s_nop 0
    buffer_load_dwordx4 v43, s[16:19], s29 offen lds
    v_mfma_f32_16x16x32_bf16 v[64:67], v[20:23], v[176:179], v[64:67]
    ds_read_b64_tr_b16 v[36:37], v10 offset:9312
    v_mfma_f32_16x16x32_bf16 v[68:71], v[20:23], v[180:183], v[68:71]
    s_waitcnt lgkmcnt(5)
    ds_read_b64_tr_b16 v[38:39], v10 offset:13920
    v_mfma_f32_16x16x32_bf16 v[72:75], v[24:27], v[176:179], v[72:75]
    ds_read_b64_tr_b16 v[16:17], v10 offset:9344
    v_mfma_f32_16x16x32_bf16 v[76:79], v[24:27], v[180:183], v[76:79]
    s_waitcnt lgkmcnt(5)
    ds_read_b64_tr_b16 v[18:19], v10 offset:13952
    v_mfma_f32_16x16x32_bf16 v[128:131], v[28:31], v[184:187], v[128:131]
    ds_read_b64_tr_b16 v[20:21], v10 offset:9376
    v_mfma_f32_16x16x32_bf16 v[132:135], v[28:31], v[188:191], v[132:135]
    s_waitcnt lgkmcnt(5)
    ds_read_b64_tr_b16 v[22:23], v10 offset:13984
    s_add_u32 m0, s40, 0
    s_nop 0
    buffer_load_dwordx4 v44, s[16:19], s29 offen lds
    s_add_u32 s29, s29, 73728
    s_cmp_eq_u32 s29, s75
    s_cselect_b32 s29, s57, s29
    v_mfma_f32_16x16x32_bf16 v[80:83], v[32:35], v[184:187], v[80:83]
    ds_read_b64_tr_b16 v[24:25], v10 offset:9408
    v_mfma_f32_16x16x32_bf16 v[84:87], v[32:35], v[188:191], v[84:87]
    s_waitcnt lgkmcnt(5)
    ds_read_b64_tr_b16 v[26:27], v10 offset:14016
    v_mfma_f32_16x16x32_bf16 v[88:91], v[36:39], v[184:187], v[88:91]
    ds_read_b64_tr_b16 v[28:29], v10 offset:9440
    v_mfma_f32_16x16x32_bf16 v[92:95], v[36:39], v[188:191], v[92:95]
    s_waitcnt lgkmcnt(5)
    ds_read_b64_tr_b16 v[30:31], v10 offset:14048
    v_mfma_f32_16x16x32_bf16 v[96:99], v[16:19], v[184:187], v[96:99]
    ds_read_b64_tr_b16 v[32:33], v10 offset:9216
    v_mfma_f32_16x16x32_bf16 v[100:103], v[16:19], v[188:191], v[100:103]
    s_waitcnt lgkmcnt(5)
    ds_read_b64_tr_b16 v[34:35], v10 offset:13824
    v_mfma_f32_16x16x32_bf16 v[104:107], v[20:23], v[184:187], v[104:107]
    ds_read_b64_tr_b16 v[36:37], v10 offset:9248
    v_mfma_f32_16x16x32_bf16 v[108:111], v[20:23], v[188:191], v[108:111]
    s_waitcnt lgkmcnt(5)
    ds_read_b64_tr_b16 v[38:39], v10 offset:13856
    s_waitcnt vmcnt(5)
    v_cmp_ne_u32 vcc, s101, v60
    s_nop 0
    s_and_b64 vcc, vcc, s[36:37]
    s_cbranch_scc0 K2_GPH_D
    s_mov_b32 s47, 0
K2_GPH:
    buffer_load_dword v60, v13, s[20:23], s39 offen sc1
    s_add_u32 s47, s47, 1
    s_waitcnt vmcnt(0)
    v_cmp_ne_u32 vcc, s101, v60
    s_cmp_ge_u32 s47, 0x40000
    s_cbranch_scc1 K2_GPH_D
    s_and_b64 vcc, vcc, s[36:37]
    s_cbranch_scc0 K2_GPH_D
    s_sleep 2
    s_branch K2_GPH
K2_GPH_D:
    v_mfma_f32_16x16x32_bf16 v[112:115], v[24:27], v[184:187], v[112:115]
    s_barrier
    ds_read_b64_tr_b16 v[16:17], v10 offset:18688
    v_mfma_f32_16x16x32_bf16 v[116:119], v[24:27], v[188:191], v[116:119]
    s_waitcnt lgkmcnt(5)
    ds_read_b64_tr_b16 v[18:19], v10 offset:23296
    buffer_load_dwordx4 v[144:147], v7, s[20:23], s30 offen offset:0 sc1
    buffer_load_dwordx4 v[148:151], v7, s[20:23], s30 offen offset:1024 sc1
    buffer_load_dwordx4 v[152:155], v7, s[20:23], s30 offen offset:2048 sc1
    buffer_load_dwordx4 v[156:159], v7, s[20:23], s30 offen offset:3072 sc1
    s_add_u32 s30, s30, 4096
    s_cmp_eq_u32 s30, s53
    s_cselect_b32 s30, s46, s30
    v_mfma_f32_16x16x32_bf16 v[120:123], v[28:31], v[184:187], v[120:123]
    ds_read_b64_tr_b16 v[20:21], v10 offset:18496
    v_mfma_f32_16x16x32_bf16 v[124:127], v[28:31], v[188:191], v[124:127]
    s_waitcnt lgkmcnt(5)
    ds_read_b64_tr_b16 v[22:23], v10 offset:23104
    v_mfma_f32_16x16x32_bf16 v[64:67], v[32:35], v[184:187], v[64:67]
    ds_read_b64_tr_b16 v[24:25], v10 offset:18528
    v_mfma_f32_16x16x32_bf16 v[68:71], v[32:35], v[188:191], v[68:71]
    s_waitcnt lgkmcnt(5)
    ds_read_b64_tr_b16 v[26:27], v10 offset:23136
    v_mfma_f32_16x16x32_bf16 v[72:75], v[36:39], v[184:187], v[72:75]
    ds_read_b64_tr_b16 v[28:29], v10 offset:18560
    v_mfma_f32_16x16x32_bf16 v[76:79], v[36:39], v[188:191], v[76:79]
    s_waitcnt lgkmcnt(5)
    ds_read_b64_tr_b16 v[30:31], v10 offset:23168
    buffer_load_dwordx4 v[160:163], v7, s[20:23], s30 offen offset:0 sc1
    buffer_load_dwordx4 v[164:167], v7, s[20:23], s30 offen offset:1024 sc1
    buffer_load_dwordx4 v[168:171], v7, s[20:23], s30 offen offset:2048 sc1
    buffer_load_dwordx4 v[172:175], v7, s[20:23], s30 offen offset:3072 sc1
    s_add_u32 s30, s30, 4096
    s_cmp_eq_u32 s30, s53
    s_cselect_b32 s30, s46, s30
    v_mfma_f32_16x16x32_bf16 v[128:131], v[16:19], v[192:195], v[128:131]
    ds_read_b64_tr_b16 v[32:33], v10 offset:18592
    v_mfma_f32_16x16x32_bf16 v[132:135], v[16:19], v[196:199], v[132:135]
    s_waitcnt lgkmcnt(5)
    ds_read_b64_tr_b16 v[34:35], v10 offset:23200
    v_mfma_f32_16x16x32_bf16 v[80:83], v[20:23], v[192:195], v[80:83]
    ds_read_b64_tr_b16 v[36:37], v10 offset:18624
    v_mfma_f32_16x16x32_bf16 v[84:87], v[20:23], v[196:199], v[84:87]
    s_waitcnt lgkmcnt(5)
    ds_read_b64_tr_b16 v[38:39], v10 offset:23232
    v_mul_u32_u24 v220, 1152, v2
    v_lshl_add_u32 v220, v3, 4, v220
    v_mul_u32_u24 v9, 2304, v3
    v_add_u32 v9, v9, v10
    v_lshrrev_b32 v222, 4, v0
    v_mov_b32 v14, 0x7ffffff0
    v_add_u32 v15, 150016, v8
    v_lshlrev_b32 v11, 9, v222
    v_lshl_add_u32 v11, v12, 4, v11
    v_lshlrev_b32 v223, 8, v222
    v_lshl_add_u32 v223, v12, 2, v223
    s_add_u32 s58, s55, 18432
    s_mul_i32 s34, s27, 36864
    s_mul_i32 s33, s25, 9216
    s_add_u32 s73, s34, s33
    s_add_u32 s73, s73, 29360128
    s_lshr_b32 s33, s24, 1
    s_lshl_b32 s33, s33, 3
    s_lshl_b32 s44, 0xff, s33
    s_mov_b32 s45, 0
    v_mul_f32 v252, 0xb8317218, v252
    v_mul_f32 v253, 0xb8317218, v253
    v_mfma_f32_16x16x32_bf16 v[88:91], v[24:27], v[192:195], v[88:91]
    ds_read_b64_tr_b16 v[16:17], v10 offset:18656
    v_mfma_f32_16x16x32_bf16 v[92:95], v[24:27], v[196:199], v[92:95]
    s_waitcnt lgkmcnt(5)
    ds_read_b64_tr_b16 v[18:19], v10 offset:23264
    s_add_u32 m0, s38, 18432
    s_nop 0
    buffer_load_dwordx4 v40, s[16:19], s29 offen lds
    s_add_u32 m0, s38, 22528
    s_nop 0
    buffer_load_dwordx4 v41, s[16:19], s29 offen lds
    v_mfma_f32_16x16x32_bf16 v[96:99], v[28:31], v[192:195], v[96:99]
    ds_read_b64_tr_b16 v[20:21], v10 offset:18432
    v_mfma_f32_16x16x32_bf16 v[100:103], v[28:31], v[196:199], v[100:103]
    s_waitcnt lgkmcnt(5)
    ds_read_b64_tr_b16 v[22:23], v10 offset:23040
    v_mfma_f32_16x16x32_bf16 v[104:107], v[32:35], v[192:195], v[104:107]
    ds_read_b64_tr_b16 v[24:25], v10 offset:18464
    v_mfma_f32_16x16x32_bf16 v[108:111], v[32:35], v[196:199], v[108:111]
    s_waitcnt lgkmcnt(5)
    ds_read_b64_tr_b16 v[26:27], v10 offset:23072
    s_lshl_b32 s33, s26, 8
    s_add_u32 s54, s34, s33
    s_lshl_b32 s33, s25, 6
    s_add_u32 s54, s54, s33
    s_lshl_b32 s33, s26, 5
    s_add_u32 s56, s34, s33
    s_add_u32 s56, s56, 1024
    s_add_u32 s35, s56, 18432
    v_cmp_eq_u32 vcc, s25, v222
    v_mul_u32_u24 v249, 1152, v12
    v_lshl_add_u32 v249, v222, 3, v249
    v_lshlrev_b32 v248, 4, v12
    v_cndmask_b32 v249, v14, v249, vcc
    v_cndmask_b32 v248, v14, v248, vcc
    buffer_load_dwordx4 v[136:139], v220, s[60:63], s54 offen offset:0
    buffer_load_dwordx4 v[140:143], v220, s[60:63], s54 offen offset:32
    buffer_load_dwordx2 v[216:217], v249, s[60:63], s56 offen
    buffer_load_dwordx2 v[218:219], v249, s[60:63], s35 offen
    v_mfma_f32_16x16x32_bf16 v[112:115], v[36:39], v[192:195], v[112:115]
    s_barrier
    ds_read_b64_tr_b16 v[28:29], v10 offset:27904
    v_mfma_f32_16x16x32_bf16 v[116:119], v[36:39], v[196:199], v[116:119]
    s_waitcnt lgkmcnt(5)
    ds_read_b64_tr_b16 v[30:31], v10 offset:32512
    v_mfma_f32_16x16x32_bf16 v[120:123], v[16:19], v[192:195], v[120:123]
    ds_read_b64_tr_b16 v[32:33], v10 offset:27712
    v_mfma_f32_16x16x32_bf16 v[124:127], v[16:19], v[196:199], v[124:127]
    s_waitcnt lgkmcnt(5)
    ds_read_b64_tr_b16 v[34:35], v10 offset:32320
    s_add_u32 m0, s38, 26624
    s_nop 0
    buffer_load_dwordx4 v42, s[16:19], s29 offen lds
    s_add_u32 m0, s38, 30720
    s_nop 0
    buffer_load_dwordx4 v43, s[16:19], s29 offen lds
    v_mfma_f32_16x16x32_bf16 v[64:67], v[20:23], v[192:195], v[64:67]
    ds_read_b64_tr_b16 v[36:37], v10 offset:27744
    v_mfma_f32_16x16x32_bf16 v[68:71], v[20:23], v[196:199], v[68:71]
    s_waitcnt lgkmcnt(5)
    ds_read_b64_tr_b16 v[38:39], v10 offset:32352
    s_lshl_b32 s32, s27, 2
    s_add_u32 s32, s32, s26
    s_mul_i32 s36, s32, 27648
    s_add_u32 s36, s36, 33554432
    s_add_u32 s33, s25, 0
    s_and_b32 s33, s33, 3
    s_mul_i32 s33, s33, 6912
    s_add_u32 s48, s33, s36
    s_add_u32 s33, s25, 1
    s_and_b32 s33, s33, 3
    s_mul_i32 s33, s33, 6912
    s_add_u32 s49, s33, s36
    s_add_u32 s33, s25, 2
    s_and_b32 s33, s33, 3
    s_mul_i32 s33, s33, 6912
    s_add_u32 s50, s33, s36
    s_add_u32 s50, s50, 2304
    s_add_u32 s33, s25, 3
    s_and_b32 s33, s33, 3
    s_mul_i32 s33, s33, 6912
    s_add_u32 s51, s33, s36
    s_add_u32 s51, s51, 4608
    s_add_u32 m0, s38, 150016
    s_nop 0
    buffer_load_dwordx4 v50, s[68:71], s58 offen lds
    s_add_u32 m0, s38, 154112
    s_nop 0
    buffer_load_dwordx4 v51, s[68:71], s58 offen lds
    v_mfma_f32_16x16x32_bf16 v[72:75], v[24:27], v[192:195], v[72:75]
    ds_read_b64_tr_b16 v[16:17], v10 offset:27776
    v_mfma_f32_16x16x32_bf16 v[76:79], v[24:27], v[196:199], v[76:79]
    s_waitcnt lgkmcnt(5)
    ds_read_b64_tr_b16 v[18:19], v10 offset:32384
    v_mfma_f32_16x16x32_bf16 v[128:131], v[28:31], v[200:203], v[128:131]
    ds_read_b64_tr_b16 v[20:21], v10 offset:27808
    v_mfma_f32_16x16x32_bf16 v[132:135], v[28:31], v[204:207], v[132:135]
    s_waitcnt lgkmcnt(5)
    ds_read_b64_tr_b16 v[22:23], v10 offset:32416
    s_add_u32 m0, s40, 18432
    s_nop 0
    buffer_load_dwordx4 v44, s[16:19], s29 offen lds
    s_add_u32 s29, s29, 73728
    s_cmp_eq_u32 s29, s75
    s_cselect_b32 s29, s57, s29
    v_mfma_f32_16x16x32_bf16 v[80:83], v[32:35], v[200:203], v[80:83]
    ds_read_b64_tr_b16 v[24:25], v10 offset:27840
    v_mfma_f32_16x16x32_bf16 v[84:87], v[32:35], v[204:207], v[84:87]
    s_waitcnt lgkmcnt(5)
    ds_read_b64_tr_b16 v[26:27], v10 offset:32448
    v_mfma_f32_16x16x32_bf16 v[88:91], v[36:39], v[200:203], v[88:91]
    ds_read_b64_tr_b16 v[28:29], v10 offset:27872
    v_mfma_f32_16x16x32_bf16 v[92:95], v[36:39], v[204:207], v[92:95]
    s_waitcnt lgkmcnt(5)
    ds_read_b64_tr_b16 v[30:31], v10 offset:32480
    s_lshl_b32 s33, s24, 7
    s_add_u32 s33, s33, 256
    s_add_u32 s39, s72, s33
    s_andn2_b32 s37, s15, 3
    s_mul_i32 s37, s37, 768
    s_add_u32 s37, s37, s33
    s_add_u32 s37, s37, 55574528
    v_add_u32 v58, s25, v0
    v_and_b32 v58, 3, v58
    v_mul_u32_u24 v58, 768, v58
    v_lshl_add_u32 v58, v0, 2, v58
    s_mov_b64 vcc, 14
    v_cndmask_b32 v58, v14, v58, vcc
    v_subrev_u32 v59, s25, v222
    v_and_b32 v59, 3, v59
    v_cmp_ne_u32 vcc, 0, v59
    v_mul_u32_u24 v59, 2304, v59
    v_mul_u32_u24 v60, 6912, v222
    v_add_u32 v59, v59, v60
    v_lshl_add_u32 v59, v12, 4, v59
    v_subrev_u32 v59, 256, v59
    v_cndmask_b32 v59, v14, v59, vcc
    v_mfma_f32_16x16x32_bf16 v[96:99], v[16:19], v[200:203], v[96:99]
    ds_read_b64_tr_b16 v[32:33], v10 offset:27648
    v_mfma_f32_16x16x32_bf16 v[100:103], v[16:19], v[204:207], v[100:103]
    s_waitcnt lgkmcnt(5)
    ds_read_b64_tr_b16 v[34:35], v10 offset:32256
    v_mfma_f32_16x16x32_bf16 v[104:107], v[20:23], v[200:203], v[104:107]
    ds_read_b64_tr_b16 v[36:37], v10 offset:27680
    v_mfma_f32_16x16x32_bf16 v[108:111], v[20:23], v[204:207], v[108:111]
    s_waitcnt lgkmcnt(5)
    ds_read_b64_tr_b16 v[38:39], v10 offset:32288
    v_mfma_f32_16x16x32_bf16 v[112:115], v[24:27], v[200:203], v[112:115]
    s_waitcnt vmcnt(15)
    s_barrier
    ds_read_b64_tr_b16 v[16:17], v8 offset:256
    v_mfma_f32_16x16x32_bf16 v[116:119], v[24:27], v[204:207], v[116:119]
    s_waitcnt lgkmcnt(5)
    ds_read_b64_tr_b16 v[18:19], v8 offset:4864
    buffer_load_dwordx4 v[176:179], v7, s[20:23], s30 offen offset:0 sc1
    buffer_load_dwordx4 v[180:183], v7, s[20:23], s30 offen offset:1024 sc1
    v_mfma_f32_16x16x32_bf16 v[120:123], v[28:31], v[200:203], v[120:123]
    ds_read_b64_tr_b16 v[20:21], v8 offset:64
    v_mfma_f32_16x16x32_bf16 v[124:127], v[28:31], v[204:207], v[124:127]
    s_waitcnt lgkmcnt(5)
    ds_read_b64_tr_b16 v[22:23], v8 offset:4672
    v_mfma_f32_16x16x32_bf16 v[64:67], v[32:35], v[200:203], v[64:67]
    ds_read_b64_tr_b16 v[24:25], v8 offset:96
    v_mfma_f32_16x16x32_bf16 v[68:71], v[32:35], v[204:207], v[68:71]
    s_waitcnt lgkmcnt(5)
    ds_read_b64_tr_b16 v[26:27], v8 offset:4704
    v_mfma_f32_16x16x32_bf16 v[72:75], v[36:39], v[200:203], v[72:75]
    ds_read_b64_tr_b16 v[28:29], v8 offset:128
    v_mfma_f32_16x16x32_bf16 v[76:79], v[36:39], v[204:207], v[76:79]
    s_waitcnt lgkmcnt(5)
    ds_read_b64_tr_b16 v[30:31], v8 offset:4736
    buffer_load_dwordx4 v[184:187], v7, s[20:23], s30 offen offset:2048 sc1
    buffer_load_dwordx4 v[188:191], v7, s[20:23], s30 offen offset:3072 sc1
    s_add_u32 s30, s30, 4096
    s_cmp_eq_u32 s30, s53
    s_cselect_b32 s30, s46, s30
K2_GLOOP:
    v_mfma_f32_16x16x32_bf16 v[128:131], v[16:19], v[144:147], v[128:131]
    ds_read_b64_tr_b16 v[32:33], v8 offset:160
    v_mfma_f32_16x16x32_bf16 v[132:135], v[16:19], v[148:151], v[132:135]
    s_waitcnt lgkmcnt(5)
    ds_read_b64_tr_b16 v[34:35], v8 offset:4768
    v_mfma_f32_16x16x32_bf16 v[80:83], v[20:23], v[144:147], v[80:83]
    ds_read_b64_tr_b16 v[36:37], v8 offset:192
    v_mfma_f32_16x16x32_bf16 v[84:87], v[20:23], v[148:151], v[84:87]
    s_waitcnt lgkmcnt(5)
    ds_read_b64_tr_b16 v[38:39], v8 offset:4800
    v_mfma_f32_16x16x32_bf16 v[88:91], v[24:27], v[144:147], v[88:91]
    ds_read_b64_tr_b16 v[16:17], v8 offset:224
    v_mfma_f32_16x16x32_bf16 v[92:95], v[24:27], v[148:151], v[92:95]
    s_waitcnt lgkmcnt(5)
    ds_read_b64_tr_b16 v[18:19], v8 offset:4832
    s_add_u32 m0, s38, 36864
    s_nop 0
    buffer_load_dwordx4 v40, s[16:19], s29 offen lds
    s_add_u32 m0, s38, 40960
    s_nop 0
    buffer_load_dwordx4 v41, s[16:19], s29 offen lds
    v_mfma_f32_16x16x32_bf16 v[96:99], v[28:31], v[144:147], v[96:99]
    ds_read_b64_tr_b16 v[20:21], v8 offset:0
    v_mfma_f32_16x16x32_bf16 v[100:103], v[28:31], v[148:151], v[100:103]
    s_waitcnt lgkmcnt(5)
    ds_read_b64_tr_b16 v[22:23], v8 offset:4608
    v_mfma_f32_16x16x32_bf16 v[104:107], v[32:35], v[144:147], v[104:107]
    ds_read_b64_tr_b16 v[24:25], v8 offset:32
    v_mfma_f32_16x16x32_bf16 v[108:111], v[32:35], v[148:151], v[108:111]
    s_waitcnt lgkmcnt(5)
    ds_read_b64_tr_b16 v[26:27], v8 offset:4640
    v_mfma_f32_16x16x32_bf16 v[112:115], v[36:39], v[144:147], v[112:115]
    s_barrier
    ds_read_b64_tr_b16 v[28:29], v8 offset:9472
    v_mfma_f32_16x16x32_bf16 v[116:119], v[36:39], v[148:151], v[116:119]
    s_waitcnt lgkmcnt(5)
    ds_read_b64_tr_b16 v[30:31], v8 offset:14080
    v_mfma_f32_16x16x32_bf16 v[120:123], v[16:19], v[144:147], v[120:123]
    ds_read_b64_tr_b16 v[32:33], v8 offset:9280
    v_mfma_f32_16x16x32_bf16 v[124:127], v[16:19], v[148:151], v[124:127]
    s_waitcnt lgkmcnt(5)
    ds_read_b64_tr_b16 v[34:35], v8 offset:13888
    s_add_u32 m0, s38, 45056
    s_nop 0
    buffer_load_dwordx4 v42, s[16:19], s29 offen lds
    s_add_u32 m0, s38, 49152
    s_nop 0
    buffer_load_dwordx4 v43, s[16:19], s29 offen lds
    v_mfma_f32_16x16x32_bf16 v[64:67], v[20:23], v[144:147], v[64:67]
    ds_read_b64_tr_b16 v[36:37], v8 offset:9312
    v_mfma_f32_16x16x32_bf16 v[68:71], v[20:23], v[148:151], v[68:71]
    s_waitcnt lgkmcnt(5)
    ds_read_b64_tr_b16 v[38:39], v8 offset:13920
    v_mfma_f32_16x16x32_bf16 v[72:75], v[24:27], v[144:147], v[72:75]
    ds_read_b64_tr_b16 v[16:17], v8 offset:9344
    v_mfma_f32_16x16x32_bf16 v[76:79], v[24:27], v[148:151], v[76:79]
    s_waitcnt lgkmcnt(5)
    ds_read_b64_tr_b16 v[18:19], v8 offset:13952
    v_mfma_f32_16x16x32_bf16 v[128:131], v[28:31], v[152:155], v[128:131]
    ds_read_b64_tr_b16 v[20:21], v8 offset:9376
    v_mfma_f32_16x16x32_bf16 v[132:135], v[28:31], v[156:159], v[132:135]
    s_waitcnt lgkmcnt(5)
    ds_read_b64_tr_b16 v[22:23], v8 offset:13984
    s_add_u32 m0, s40, 36864
    s_nop 0
    buffer_load_dwordx4 v44, s[16:19], s29 offen lds
    s_add_u32 s29, s29, 73728
    s_cmp_eq_u32 s29, s75
    s_cselect_b32 s29, s57, s29
    v_mfma_f32_16x16x32_bf16 v[80:83], v[32:35], v[152:155], v[80:83]
    ds_read_b64_tr_b16 v[24:25], v8 offset:9408
    v_mfma_f32_16x16x32_bf16 v[84:87], v[32:35], v[156:159], v[84:87]
    s_waitcnt lgkmcnt(5)
    ds_read_b64_tr_b16 v[26:27], v8 offset:14016
    v_mfma_f32_16x16x32_bf16 v[88:91], v[36:39], v[152:155], v[88:91]
    ds_read_b64_tr_b16 v[28:29], v8 offset:9440
    v_mfma_f32_16x16x32_bf16 v[92:95], v[36:39], v[156:159], v[92:95]
    s_waitcnt lgkmcnt(5)
    ds_read_b64_tr_b16 v[30:31], v8 offset:14048
    v_mfma_f32_16x16x32_bf16 v[96:99], v[16:19], v[152:155], v[96:99]
    ds_read_b64_tr_b16 v[32:33], v8 offset:9216
    v_mfma_f32_16x16x32_bf16 v[100:103], v[16:19], v[156:159], v[100:103]
    s_waitcnt lgkmcnt(5)
    ds_read_b64_tr_b16 v[34:35], v8 offset:13824
    v_mfma_f32_16x16x32_bf16 v[104:107], v[20:23], v[152:155], v[104:107]
    ds_read_b64_tr_b16 v[36:37], v8 offset:9248
    v_mfma_f32_16x16x32_bf16 v[108:111], v[20:23], v[156:159], v[108:111]
    s_waitcnt lgkmcnt(5)
    ds_read_b64_tr_b16 v[38:39], v8 offset:13856
    v_mfma_f32_16x16x32_bf16 v[112:115], v[24:27], v[152:155], v[112:115]
    s_waitcnt vmcnt(9)
    s_barrier
    ds_read_b64_tr_b16 v[16:17], v8 offset:18688
    v_mfma_f32_16x16x32_bf16 v[116:119], v[24:27], v[156:159], v[116:119]
    s_waitcnt lgkmcnt(5)
    ds_read_b64_tr_b16 v[18:19], v8 offset:23296
    buffer_load_dwordx4 v[192:195], v7, s[20:23], s30 offen offset:0 sc1
    buffer_load_dwordx4 v[196:199], v7, s[20:23], s30 offen offset:1024 sc1
    v_mfma_f32_16x16x32_bf16 v[120:123], v[28:31], v[152:155], v[120:123]
    ds_read_b64_tr_b16 v[20:21], v8 offset:18496
    v_mfma_f32_16x16x32_bf16 v[124:127], v[28:31], v[156:159], v[124:127]
    s_waitcnt lgkmcnt(5)
    ds_read_b64_tr_b16 v[22:23], v8 offset:23104
    v_mfma_f32_16x16x32_bf16 v[64:67], v[32:35], v[152:155], v[64:67]
    ds_read_b64_tr_b16 v[24:25], v8 offset:18528
    v_mfma_f32_16x16x32_bf16 v[68:71], v[32:35], v[156:159], v[68:71]
    s_waitcnt lgkmcnt(5)
    ds_read_b64_tr_b16 v[26:27], v8 offset:23136
    v_mfma_f32_16x16x32_bf16 v[72:75], v[36:39], v[152:155], v[72:75]
    ds_read_b64_tr_b16 v[28:29], v8 offset:18560
    v_mfma_f32_16x16x32_bf16 v[76:79], v[36:39], v[156:159], v[76:79]
    s_waitcnt lgkmcnt(5)
    ds_read_b64_tr_b16 v[30:31], v8 offset:23168
    buffer_load_dwordx4 v[200:203], v7, s[20:23], s30 offen offset:2048 sc1
    buffer_load_dwordx4 v[204:207], v7, s[20:23], s30 offen offset:3072 sc1
    s_add_u32 s30, s30, 4096
    s_cmp_eq_u32 s30, s53
    s_cselect_b32 s30, s46, s30
    v_mfma_f32_16x16x32_bf16 v[128:131], v[16:19], v[160:163], v[128:131]
    ds_read_b64_tr_b16 v[32:33], v8 offset:18592
    v_mfma_f32_16x16x32_bf16 v[132:135], v[16:19], v[164:167], v[132:135]
    s_waitcnt lgkmcnt(5)
    ds_read_b64_tr_b16 v[34:35], v8 offset:23200
    v_mfma_f32_16x16x32_bf16 v[80:83], v[20:23], v[160:163], v[80:83]
    ds_read_b64_tr_b16 v[36:37], v8 offset:18624
    v_mfma_f32_16x16x32_bf16 v[84:87], v[20:23], v[164:167], v[84:87]
    s_waitcnt lgkmcnt(5)
    ds_read_b64_tr_b16 v[38:39], v8 offset:23232
    v_mfma_f32_16x16x32_bf16 v[88:91], v[24:27], v[160:163], v[88:91]
    ds_read_b64_tr_b16 v[16:17], v8 offset:18656
    v_mfma_f32_16x16x32_bf16 v[92:95], v[24:27], v[164:167], v[92:95]
    s_waitcnt lgkmcnt(5)
    ds_read_b64_tr_b16 v[18:19], v8 offset:23264
    s_add_u32 m0, s38, 55296
    s_nop 0
    buffer_load_dwordx4 v40, s[16:19], s29 offen lds
    s_add_u32 m0, s38, 59392
    s_nop 0
    buffer_load_dwordx4 v41, s[16:19], s29 offen lds
    v_mfma_f32_16x16x32_bf16 v[96:99], v[28:31], v[160:163], v[96:99]
    ds_read_b64_tr_b16 v[20:21], v8 offset:18432
    v_mfma_f32_16x16x32_bf16 v[100:103], v[28:31], v[164:167], v[100:103]
    s_waitcnt lgkmcnt(5)
    ds_read_b64_tr_b16 v[22:23], v8 offset:23040
    v_mfma_f32_16x16x32_bf16 v[104:107], v[32:35], v[160:163], v[104:107]
    ds_read_b64_tr_b16 v[24:25], v8 offset:18464
    v_mfma_f32_16x16x32_bf16 v[108:111], v[32:35], v[164:167], v[108:111]
    s_waitcnt lgkmcnt(5)
    ds_read_b64_tr_b16 v[26:27], v8 offset:23072
    v_mfma_f32_16x16x32_bf16 v[112:115], v[36:39], v[160:163], v[112:115]
    s_barrier
    ds_read_b64_tr_b16 v[28:29], v8 offset:27904
    v_mfma_f32_16x16x32_bf16 v[116:119], v[36:39], v[164:167], v[116:119]
    s_waitcnt lgkmcnt(5)
    ds_read_b64_tr_b16 v[30:31], v8 offset:32512
    v_mfma_f32_16x16x32_bf16 v[120:123], v[16:19], v[160:163], v[120:123]
    ds_read_b64_tr_b16 v[32:33], v8 offset:27712
    v_mfma_f32_16x16x32_bf16 v[124:127], v[16:19], v[164:167], v[124:127]
    s_waitcnt lgkmcnt(5)
    ds_read_b64_tr_b16 v[34:35], v8 offset:32320
    s_add_u32 m0, s38, 63488
    s_nop 0
    buffer_load_dwordx4 v42, s[16:19], s29 offen lds
    s_add_u32 m0, s38, 67584
    s_nop 0
    buffer_load_dwordx4 v43, s[16:19], s29 offen lds
    v_mfma_f32_16x16x32_bf16 v[64:67], v[20:23], v[160:163], v[64:67]
    ds_read_b64_tr_b16 v[36:37], v8 offset:27744
    v_mfma_f32_16x16x32_bf16 v[68:71], v[20:23], v[164:167], v[68:71]
    s_waitcnt lgkmcnt(5)
    ds_read_b64_tr_b16 v[38:39], v8 offset:32352
    v_mfma_f32_16x16x32_bf16 v[72:75], v[24:27], v[160:163], v[72:75]
    ds_read_b64_tr_b16 v[16:17], v8 offset:27776
    v_mfma_f32_16x16x32_bf16 v[76:79], v[24:27], v[164:167], v[76:79]
    s_waitcnt lgkmcnt(5)
    ds_read_b64_tr_b16 v[18:19], v8 offset:32384
    v_mfma_f32_16x16x32_bf16 v[128:131], v[28:31], v[168:171], v[128:131]
    ds_read_b64_tr_b16 v[20:21], v8 offset:27808
    v_mfma_f32_16x16x32_bf16 v[132:135], v[28:31], v[172:175], v[132:135]
    s_waitcnt lgkmcnt(5)
    ds_read_b64_tr_b16 v[22:23], v8 offset:32416
    s_add_u32 m0, s40, 55296
    s_nop 0
    buffer_load_dwordx4 v44, s[16:19], s29 offen lds
    s_add_u32 s29, s29, 73728
    s_cmp_eq_u32 s29, s75
    s_cselect_b32 s29, s57, s29
    v_mfma_f32_16x16x32_bf16 v[80:83], v[32:35], v[168:171], v[80:83]
    ds_read_b64_tr_b16 v[24:25], v8 offset:27840
    v_mfma_f32_16x16x32_bf16 v[84:87], v[32:35], v[172:175], v[84:87]
    s_waitcnt lgkmcnt(5)
    ds_read_b64_tr_b16 v[26:27], v8 offset:32448
    v_mfma_f32_16x16x32_bf16 v[88:91], v[36:39], v[168:171], v[88:91]
    ds_read_b64_tr_b16 v[28:29], v8 offset:27872
    v_mfma_f32_16x16x32_bf16 v[92:95], v[36:39], v[172:175], v[92:95]
    s_waitcnt lgkmcnt(5)
    ds_read_b64_tr_b16 v[30:31], v8 offset:32480
    v_mfma_f32_16x16x32_bf16 v[96:99], v[16:19], v[168:171], v[96:99]
    ds_read_b64_tr_b16 v[32:33], v8 offset:27648
    v_mfma_f32_16x16x32_bf16 v[100:103], v[16:19], v[172:175], v[100:103]
    s_waitcnt lgkmcnt(5)
    ds_read_b64_tr_b16 v[34:35], v8 offset:32256
    v_mfma_f32_16x16x32_bf16 v[104:107], v[20:23], v[168:171], v[104:107]
    ds_read_b64_tr_b16 v[36:37], v8 offset:27680
    v_mfma_f32_16x16x32_bf16 v[108:111], v[20:23], v[172:175], v[108:111]
    s_waitcnt lgkmcnt(5)
    ds_read_b64_tr_b16 v[38:39], v8 offset:32288
    v_mfma_f32_16x16x32_bf16 v[112:115], v[24:27], v[168:171], v[112:115]
    s_waitcnt vmcnt(9)
    s_barrier
    ds_read_b64_tr_b16 v[16:17], v10 offset:256
    v_mfma_f32_16x16x32_bf16 v[116:119], v[24:27], v[172:175], v[116:119]
    s_waitcnt lgkmcnt(5)
    ds_read_b64_tr_b16 v[18:19], v10 offset:4864
    buffer_load_dwordx4 v[144:147], v7, s[20:23], s30 offen offset:0 sc1
    buffer_load_dwordx4 v[148:151], v7, s[20:23], s30 offen offset:1024 sc1
    v_mfma_f32_16x16x32_bf16 v[120:123], v[28:31], v[168:171], v[120:123]
    ds_read_b64_tr_b16 v[20:21], v10 offset:64
    v_mfma_f32_16x16x32_bf16 v[124:127], v[28:31], v[172:175], v[124:127]
    s_waitcnt lgkmcnt(5)
    ds_read_b64_tr_b16 v[22:23], v10 offset:4672
    v_mfma_f32_16x16x32_bf16 v[64:67], v[32:35], v[168:171], v[64:67]
    ds_read_b64_tr_b16 v[24:25], v10 offset:96
    v_mfma_f32_16x16x32_bf16 v[68:71], v[32:35], v[172:175], v[68:71]
    s_waitcnt lgkmcnt(5)
    ds_read_b64_tr_b16 v[26:27], v10 offset:4704
    v_mfma_f32_16x16x32_bf16 v[72:75], v[36:39], v[168:171], v[72:75]
    ds_read_b64_tr_b16 v[28:29], v10 offset:128
    v_mfma_f32_16x16x32_bf16 v[76:79], v[36:39], v[172:175], v[76:79]
    s_waitcnt lgkmcnt(5)
    ds_read_b64_tr_b16 v[30:31], v10 offset:4736
    buffer_load_dwordx4 v[152:155], v7, s[20:23], s30 offen offset:2048 sc1
    buffer_load_dwordx4 v[156:159], v7, s[20:23], s30 offen offset:3072 sc1
    s_add_u32 s30, s30, 4096
    s_cmp_eq_u32 s30, s53
    s_cselect_b32 s30, s46, s30
    v_mfma_f32_16x16x32_bf16 v[128:131], v[16:19], v[176:179], v[128:131]
    ds_read_b64_tr_b16 v[32:33], v10 offset:160
    v_mfma_f32_16x16x32_bf16 v[132:135], v[16:19], v[180:183], v[132:135]
    s_waitcnt lgkmcnt(5)
    ds_read_b64_tr_b16 v[34:35], v10 offset:4768
    v_mfma_f32_16x16x32_bf16 v[80:83], v[20:23], v[176:179], v[80:83]
    ds_read_b64_tr_b16 v[36:37], v10 offset:192
    v_mfma_f32_16x16x32_bf16 v[84:87], v[20:23], v[180:183], v[84:87]
    s_waitcnt lgkmcnt(5)
    ds_read_b64_tr_b16 v[38:39], v10 offset:4800
    v_mfma_f32_16x16x32_bf16 v[88:91], v[24:27], v[176:179], v[88:91]
    ds_read_b64_tr_b16 v[16:17], v10 offset:224
    v_mfma_f32_16x16x32_bf16 v[92:95], v[24:27], v[180:183], v[92:95]
    s_waitcnt lgkmcnt(5)
    ds_read_b64_tr_b16 v[18:19], v10 offset:4832
    s_add_u32 m0, s38, 0
    s_nop 0
    buffer_load_dwordx4 v40, s[16:19], s29 offen lds
    s_add_u32 m0, s38, 4096
    s_nop 0
    buffer_load_dwordx4 v41, s[16:19], s29 offen lds
    v_mfma_f32_16x16x32_bf16 v[96:99], v[28:31], v[176:179], v[96:99]
    ds_read_b64_tr_b16 v[20:21], v10 offset:0
    v_mfma_f32_16x16x32_bf16 v[100:103], v[28:31], v[180:183], v[100:103]
    s_waitcnt lgkmcnt(5)
    ds_read_b64_tr_b16 v[22:23], v10 offset:4608
    v_mfma_f32_16x16x32_bf16 v[104:107], v[32:35], v[176:179], v[104:107]
    ds_read_b64_tr_b16 v[24:25], v10 offset:32
    v_mfma_f32_16x16x32_bf16 v[108:111], v[32:35], v[180:183], v[108:111]
    s_waitcnt lgkmcnt(5)
    ds_read_b64_tr_b16 v[26:27], v10 offset:4640
    v_mfma_f32_16x16x32_bf16 v[112:115], v[36:39], v[176:179], v[112:115]
    s_barrier
    ds_read_b64_tr_b16 v[28:29], v10 offset:9472
    v_mfma_f32_16x16x32_bf16 v[116:119], v[36:39], v[180:183], v[116:119]
    s_waitcnt lgkmcnt(5)
    ds_read_b64_tr_b16 v[30:31], v10 offset:14080
    v_mfma_f32_16x16x32_bf16 v[120:123], v[16:19], v[176:179], v[120:123]
    ds_read_b64_tr_b16 v[32:33], v10 offset:9280
    v_mfma_f32_16x16x32_bf16 v[124:127], v[16:19], v[180:183], v[124:127]
    s_waitcnt lgkmcnt(5)
    ds_read_b64_tr_b16 v[34:35], v10 offset:13888
    s_add_u32 m0, s38, 8192
    s_nop 0
    buffer_load_dwordx4 v42, s[16:19], s29 offen lds
    s_add_u32 m0, s38, 12288
    s_nop 0
    buffer_load_dwordx4 v43, s[16:19], s29 offen lds
    v_mfma_f32_16x16x32_bf16 v[64:67], v[20:23], v[176:179], v[64:67]
    ds_read_b64_tr_b16 v[36:37], v10 offset:9312
    v_mfma_f32_16x16x32_bf16 v[68:71], v[20:23], v[180:183], v[68:71]
    s_waitcnt lgkmcnt(5)
    ds_read_b64_tr_b16 v[38:39], v10 offset:13920
    v_mfma_f32_16x16x32_bf16 v[72:75], v[24:27], v[176:179], v[72:75]
    ds_read_b64_tr_b16 v[16:17], v10 offset:9344
    v_mfma_f32_16x16x32_bf16 v[76:79], v[24:27], v[180:183], v[76:79]
    s_waitcnt lgkmcnt(5)
    ds_read_b64_tr_b16 v[18:19], v10 offset:13952
    v_mfma_f32_16x16x32_bf16 v[128:131], v[28:31], v[184:187], v[128:131]
    ds_read_b64_tr_b16 v[20:21], v10 offset:9376
    v_mfma_f32_16x16x32_bf16 v[132:135], v[28:31], v[188:191], v[132:135]
    s_waitcnt lgkmcnt(5)
    ds_read_b64_tr_b16 v[22:23], v10 offset:13984
    s_add_u32 m0, s40, 0
    s_nop 0
    buffer_load_dwordx4 v44, s[16:19], s29 offen lds
    s_add_u32 s29, s29, 73728
    s_cmp_eq_u32 s29, s75
    s_cselect_b32 s29, s57, s29
    v_mfma_f32_16x16x32_bf16 v[80:83], v[32:35], v[184:187], v[80:83]
    ds_read_b64_tr_b16 v[24:25], v10 offset:9408
    v_mfma_f32_16x16x32_bf16 v[84:87], v[32:35], v[188:191], v[84:87]
    s_waitcnt lgkmcnt(5)
    ds_read_b64_tr_b16 v[26:27], v10 offset:14016
    v_mfma_f32_16x16x32_bf16 v[88:91], v[36:39], v[184:187], v[88:91]
    ds_read_b64_tr_b16 v[28:29], v10 offset:9440
    v_mfma_f32_16x16x32_bf16 v[92:95], v[36:39], v[188:191], v[92:95]
    s_waitcnt lgkmcnt(5)
    ds_read_b64_tr_b16 v[30:31], v10 offset:14048
    v_mfma_f32_16x16x32_bf16 v[96:99], v[16:19], v[184:187], v[96:99]
    ds_read_b64_tr_b16 v[32:33], v10 offset:9216
    v_mfma_f32_16x16x32_bf16 v[100:103], v[16:19], v[188:191], v[100:103]
    s_waitcnt lgkmcnt(5)
    ds_read_b64_tr_b16 v[34:35], v10 offset:13824
    v_mfma_f32_16x16x32_bf16 v[104:107], v[20:23], v[184:187], v[104:107]
    ds_read_b64_tr_b16 v[36:37], v10 offset:9248
    v_mfma_f32_16x16x32_bf16 v[108:111], v[20:23], v[188:191], v[108:111]
    s_waitcnt lgkmcnt(5)
    ds_read_b64_tr_b16 v[38:39], v10 offset:13856
    v_mfma_f32_16x16x32_bf16 v[112:115], v[24:27], v[184:187], v[112:115]
    s_waitcnt vmcnt(9)
    s_barrier
    ds_read_b64_tr_b16 v[16:17], v10 offset:18688
    v_mfma_f32_16x16x32_bf16 v[116:119], v[24:27], v[188:191], v[116:119]
    s_waitcnt lgkmcnt(5)
    ds_read_b64_tr_b16 v[18:19], v10 offset:23296
    buffer_load_dwordx4 v[160:163], v7, s[20:23], s30 offen offset:0 sc1
    buffer_load_dwordx4 v[164:167], v7, s[20:23], s30 offen offset:1024 sc1
    v_mfma_f32_16x16x32_bf16 v[120:123], v[28:31], v[184:187], v[120:123]
    ds_read_b64_tr_b16 v[20:21], v10 offset:18496
    v_mfma_f32_16x16x32_bf16 v[124:127], v[28:31], v[188:191], v[124:127]
    s_waitcnt lgkmcnt(5)
    ds_read_b64_tr_b16 v[22:23], v10 offset:23104
    v_mfma_f32_16x16x32_bf16 v[64:67], v[32:35], v[184:187], v[64:67]
    ds_read_b64_tr_b16 v[24:25], v10 offset:18528
    v_mfma_f32_16x16x32_bf16 v[68:71], v[32:35], v[188:191], v[68:71]
    s_waitcnt lgkmcnt(5)
    ds_read_b64_tr_b16 v[26:27], v10 offset:23136
    v_mfma_f32_16x16x32_bf16 v[72:75], v[36:39], v[184:187], v[72:75]
    ds_read_b64_tr_b16 v[28:29], v10 offset:18560
    v_mfma_f32_16x16x32_bf16 v[76:79], v[36:39], v[188:191], v[76:79]
    s_waitcnt lgkmcnt(5)
    ds_read_b64_tr_b16 v[30:31], v10 offset:23168
    buffer_load_dwordx4 v[168:171], v7, s[20:23], s30 offen offset:2048 sc1
    buffer_load_dwordx4 v[172:175], v7, s[20:23], s30 offen offset:3072 sc1
    s_add_u32 s30, s30, 4096
    s_cmp_eq_u32 s30, s53
    s_cselect_b32 s30, s46, s30
    v_mfma_f32_16x16x32_bf16 v[128:131], v[16:19], v[192:195], v[128:131]
    ds_read_b64_tr_b16 v[32:33], v10 offset:18592
    v_mfma_f32_16x16x32_bf16 v[132:135], v[16:19], v[196:199], v[132:135]
    s_waitcnt lgkmcnt(5)
    ds_read_b64_tr_b16 v[34:35], v10 offset:23200
    v_mfma_f32_16x16x32_bf16 v[80:83], v[20:23], v[192:195], v[80:83]
    ds_read_b64_tr_b16 v[36:37], v10 offset:18624
    v_mfma_f32_16x16x32_bf16 v[84:87], v[20:23], v[196:199], v[84:87]
    s_waitcnt lgkmcnt(5)
    ds_read_b64_tr_b16 v[38:39], v10 offset:23232
    v_mfma_f32_16x16x32_bf16 v[88:91], v[24:27], v[192:195], v[88:91]
    ds_read_b64_tr_b16 v[16:17], v10 offset:18656
    v_mfma_f32_16x16x32_bf16 v[92:95], v[24:27], v[196:199], v[92:95]
    s_waitcnt lgkmcnt(5)
    ds_read_b64_tr_b16 v[18:19], v10 offset:23264
    s_add_u32 m0, s38, 18432
    s_nop 0
    buffer_load_dwordx4 v40, s[16:19], s29 offen lds
    s_add_u32 m0, s38, 22528
    s_nop 0
    buffer_load_dwordx4 v41, s[16:19], s29 offen lds
    v_mfma_f32_16x16x32_bf16 v[96:99], v[28:31], v[192:195], v[96:99]
    ds_read_b64_tr_b16 v[20:21], v10 offset:18432
    v_mfma_f32_16x16x32_bf16 v[100:103], v[28:31], v[196:199], v[100:103]
    s_waitcnt lgkmcnt(5)
    ds_read_b64_tr_b16 v[22:23], v10 offset:23040
    v_mfma_f32_16x16x32_bf16 v[104:107], v[32:35], v[192:195], v[104:107]
    ds_read_b64_tr_b16 v[24:25], v10 offset:18464
    v_mfma_f32_16x16x32_bf16 v[108:111], v[32:35], v[196:199], v[108:111]
    s_waitcnt lgkmcnt(5)
    ds_read_b64_tr_b16 v[26:27], v10 offset:23072
    v_mfma_f32_16x16x32_bf16 v[112:115], v[36:39], v[192:195], v[112:115]
    s_barrier
    ds_read_b64_tr_b16 v[28:29], v10 offset:27904
    v_mfma_f32_16x16x32_bf16 v[116:119], v[36:39], v[196:199], v[116:119]
    s_waitcnt lgkmcnt(5)
    ds_read_b64_tr_b16 v[30:31], v10 offset:32512
    v_mfma_f32_16x16x32_bf16 v[120:123], v[16:19], v[192:195], v[120:123]
    ds_read_b64_tr_b16 v[32:33], v10 offset:27712
    v_mfma_f32_16x16x32_bf16 v[124:127], v[16:19], v[196:199], v[124:127]
    s_waitcnt lgkmcnt(5)
    ds_read_b64_tr_b16 v[34:35], v10 offset:32320
    s_add_u32 m0, s38, 26624
    s_nop 0
    buffer_load_dwordx4 v42, s[16:19], s29 offen lds
    s_add_u32 m0, s38, 30720
    s_nop 0
    buffer_load_dwordx4 v43, s[16:19], s29 offen lds
    v_mfma_f32_16x16x32_bf16 v[64:67], v[20:23], v[192:195], v[64:67]
    ds_read_b64_tr_b16 v[36:37], v10 offset:27744
    v_mfma_f32_16x16x32_bf16 v[68:71], v[20:23], v[196:199], v[68:71]
    s_waitcnt lgkmcnt(5)
    ds_read_b64_tr_b16 v[38:39], v10 offset:32352
    v_mfma_f32_16x16x32_bf16 v[72:75], v[24:27], v[192:195], v[72:75]
    ds_read_b64_tr_b16 v[16:17], v10 offset:27776
    v_mfma_f32_16x16x32_bf16 v[76:79], v[24:27], v[196:199], v[76:79]
    s_waitcnt lgkmcnt(5)
    ds_read_b64_tr_b16 v[18:19], v10 offset:32384
    v_mfma_f32_16x16x32_bf16 v[128:131], v[28:31], v[200:203], v[128:131]
    ds_read_b64_tr_b16 v[20:21], v10 offset:27808
    v_mfma_f32_16x16x32_bf16 v[132:135], v[28:31], v[204:207], v[132:135]
    s_waitcnt lgkmcnt(5)
    ds_read_b64_tr_b16 v[22:23], v10 offset:32416
    s_add_u32 m0, s40, 18432
    s_nop 0
    buffer_load_dwordx4 v44, s[16:19], s29 offen lds
    s_add_u32 s29, s29, 73728
    s_cmp_eq_u32 s29, s75
    s_cselect_b32 s29, s57, s29
    v_mfma_f32_16x16x32_bf16 v[80:83], v[32:35], v[200:203], v[80:83]
    ds_read_b64_tr_b16 v[24:25], v10 offset:27840
    v_mfma_f32_16x16x32_bf16 v[84:87], v[32:35], v[204:207], v[84:87]
    s_waitcnt lgkmcnt(5)
    ds_read_b64_tr_b16 v[26:27], v10 offset:32448
    v_mfma_f32_16x16x32_bf16 v[88:91], v[36:39], v[200:203], v[88:91]
    ds_read_b64_tr_b16 v[28:29], v10 offset:27872
    v_mfma_f32_16x16x32_bf16 v[92:95], v[36:39], v[204:207], v[92:95]
    s_waitcnt lgkmcnt(5)
    ds_read_b64_tr_b16 v[30:31], v10 offset:32480
    v_mfma_f32_16x16x32_bf16 v[96:99], v[16:19], v[200:203], v[96:99]
    ds_read_b64_tr_b16 v[32:33], v10 offset:27648
    v_mfma_f32_16x16x32_bf16 v[100:103], v[16:19], v[204:207], v[100:103]
    s_waitcnt lgkmcnt(5)
    ds_read_b64_tr_b16 v[34:35], v10 offset:32256
    v_mfma_f32_16x16x32_bf16 v[104:107], v[20:23], v[200:203], v[104:107]
    ds_read_b64_tr_b16 v[36:37], v10 offset:27680
    v_mfma_f32_16x16x32_bf16 v[108:111], v[20:23], v[204:207], v[108:111]
    s_waitcnt lgkmcnt(5)
    ds_read_b64_tr_b16 v[38:39], v10 offset:32288
    v_mfma_f32_16x16x32_bf16 v[112:115], v[24:27], v[200:203], v[112:115]
    s_waitcnt vmcnt(9)
    s_barrier
    ds_read_b64_tr_b16 v[16:17], v8 offset:256
    v_mfma_f32_16x16x32_bf16 v[116:119], v[24:27], v[204:207], v[116:119]
    s_waitcnt lgkmcnt(5)
    ds_read_b64_tr_b16 v[18:19], v8 offset:4864
    buffer_load_dwordx4 v[176:179], v7, s[20:23], s30 offen offset:0 sc1
    buffer_load_dwordx4 v[180:183], v7, s[20:23], s30 offen offset:1024 sc1
    v_mfma_f32_16x16x32_bf16 v[120:123], v[28:31], v[200:203], v[120:123]
    ds_read_b64_tr_b16 v[20:21], v8 offset:64
    v_mfma_f32_16x16x32_bf16 v[124:127], v[28:31], v[204:207], v[124:127]
    s_waitcnt lgkmcnt(5)
    ds_read_b64_tr_b16 v[22:23], v8 offset:4672
    v_mfma_f32_16x16x32_bf16 v[64:67], v[32:35], v[200:203], v[64:67]
    ds_read_b64_tr_b16 v[24:25], v8 offset:96
    v_mfma_f32_16x16x32_bf16 v[68:71], v[32:35], v[204:207], v[68:71]
    s_waitcnt lgkmcnt(5)
    ds_read_b64_tr_b16 v[26:27], v8 offset:4704
    v_mfma_f32_16x16x32_bf16 v[72:75], v[36:39], v[200:203], v[72:75]
    ds_read_b64_tr_b16 v[28:29], v8 offset:128
    v_mfma_f32_16x16x32_bf16 v[76:79], v[36:39], v[204:207], v[76:79]
    s_waitcnt lgkmcnt(5)
    ds_read_b64_tr_b16 v[30:31], v8 offset:4736
    buffer_load_dwordx4 v[184:187], v7, s[20:23], s30 offen offset:2048 sc1
    buffer_load_dwordx4 v[188:191], v7, s[20:23], s30 offen offset:3072 sc1
    s_add_u32 s30, s30, 4096
    s_cmp_eq_u32 s30, s53
    s_cselect_b32 s30, s46, s30
    s_add_u32 s31, s31, 1
    s_cmp_lt_u32 s31, 3
    s_cbranch_scc1 K2_GLOOP
    v_mfma_f32_16x16x32_bf16 v[128:131], v[16:19], v[144:147], v[128:131]
    ds_read_b64_tr_b16 v[32:33], v8 offset:160
    v_mfma_f32_16x16x32_bf16 v[132:135], v[16:19], v[148:151], v[132:135]
    s_waitcnt lgkmcnt(5)
    ds_read_b64_tr_b16 v[34:35], v8 offset:4768
    v_mfma_f32_16x16x32_bf16 v[80:83], v[20:23], v[144:147], v[80:83]
    ds_read_b64_tr_b16 v[36:37], v8 offset:192
    v_mfma_f32_16x16x32_bf16 v[84:87], v[20:23], v[148:151], v[84:87]
    s_waitcnt lgkmcnt(5)
    ds_read_b64_tr_b16 v[38:39], v8 offset:4800
    v_permlane16_swap_b32 v136, v138
    v_permlane16_swap_b32 v137, v139
    v_permlane16_swap_b32 v140, v142
    v_permlane16_swap_b32 v141, v143
    v_lshlrev_b32 v224, 16, v136
    v_and_b32 v225, 0xffff0000, v136
    v_lshlrev_b32 v226, 16, v137
    v_and_b32 v227, 0xffff0000, v137
    v_lshlrev_b32 v228, 16, v138
    v_and_b32 v229, 0xffff0000, v138
    v_lshlrev_b32 v230, 16, v139
    v_and_b32 v231, 0xffff0000, v139
    v_lshlrev_b32 v232, 16, v140
    v_and_b32 v233, 0xffff0000, v140
    v_lshlrev_b32 v234, 16, v141
    v_and_b32 v235, 0xffff0000, v141
    v_lshlrev_b32 v236, 16, v142
    v_and_b32 v237, 0xffff0000, v142
    v_lshlrev_b32 v238, 16, v143
    v_and_b32 v239, 0xffff0000, v143
    v_lshlrev_b32 v240, 16, v216
    v_and_b32 v241, 0xffff0000, v216
    v_lshlrev_b32 v242, 16, v217
    v_and_b32 v243, 0xffff0000, v217
    v_lshlrev_b32 v244, 16, v218
    v_and_b32 v245, 0xffff0000, v218
    v_lshlrev_b32 v246, 16, v219
    v_and_b32 v247, 0xffff0000, v219
    v_mov_b32 v56, 0x00003f80
    v_mov_b32 v57, 0x3f800000
    v_mfma_f32_16x16x32_bf16 v[88:91], v[24:27], v[144:147], v[88:91]
    ds_read_b64_tr_b16 v[16:17], v8 offset:224
    v_mfma_f32_16x16x32_bf16 v[92:95], v[24:27], v[148:151], v[92:95]
    s_waitcnt lgkmcnt(5)
    ds_read_b64_tr_b16 v[18:19], v8 offset:4832
    s_add_u32 m0, s38, 36864
    s_nop 0
    buffer_load_dwordx4 v40, s[16:19], s29 offen lds
    s_add_u32 m0, s38, 40960
    s_nop 0
    buffer_load_dwordx4 v41, s[16:19], s29 offen lds
    v_mfma_f32_16x16x32_bf16 v[96:99], v[28:31], v[144:147], v[96:99]
    ds_read_b64_tr_b16 v[20:21], v8 offset:0
    v_mfma_f32_16x16x32_bf16 v[100:103], v[28:31], v[148:151], v[100:103]
    s_waitcnt lgkmcnt(5)
    ds_read_b64_tr_b16 v[22:23], v8 offset:4608
    v_lshlrev_b32 v1, 12, v0
    v_cmp_gt_u32 vcc, 7, v0
    s_nop 1
    v_cndmask_b32 v63, v14, v1, vcc
    buffer_load_dword v61, v63, s[20:23], s36 offen sc1
    v_cmp_gt_u32 vcc, 3, v0
    s_nop 1
    v_cndmask_b32 v63, v14, v1, vcc
    buffer_load_dword v61, v63, s[20:23], s73 offen sc1
    buffer_load_dword v61, v58, s[20:23], s37 offen offset:64 sc1
    v_cmp_gt_u32 vcc, 9, v0
    s_nop 1
    v_cndmask_b32 v63, v14, v1, vcc
    buffer_load_dword v61, v63, s[64:67], s54 offen
    v_mfma_f32_16x16x32_bf16 v[104:107], v[32:35], v[144:147], v[104:107]
    ds_read_b64_tr_b16 v[24:25], v8 offset:32
    v_mfma_f32_16x16x32_bf16 v[108:111], v[32:35], v[148:151], v[108:111]
    s_waitcnt lgkmcnt(5)
    ds_read_b64_tr_b16 v[26:27], v8 offset:4640
    v_mfma_f32_16x16x32_bf16 v[112:115], v[36:39], v[144:147], v[112:115]
    s_barrier
    ds_read_b64_tr_b16 v[28:29], v8 offset:9472
    v_mfma_f32_16x16x32_bf16 v[116:119], v[36:39], v[148:151], v[116:119]
    s_waitcnt lgkmcnt(5)
    ds_read_b64_tr_b16 v[30:31], v8 offset:14080
    v_mfma_f32_16x16x32_bf16 v[120:123], v[16:19], v[144:147], v[120:123]
    ds_read_b64_tr_b16 v[32:33], v8 offset:9280
    v_mfma_f32_16x16x32_bf16 v[124:127], v[16:19], v[148:151], v[124:127]
    s_waitcnt lgkmcnt(5)
    ds_read_b64_tr_b16 v[34:35], v8 offset:13888
    s_add_u32 m0, s38, 45056
    s_nop 0
    buffer_load_dwordx4 v42, s[16:19], s29 offen lds
    s_add_u32 m0, s38, 49152
    s_nop 0
    buffer_load_dwordx4 v43, s[16:19], s29 offen lds
    v_mfma_f32_16x16x32_bf16 v[64:67], v[20:23], v[144:147], v[64:67]
    ds_read_b64_tr_b16 v[36:37], v8 offset:9312
    v_mfma_f32_16x16x32_bf16 v[68:71], v[20:23], v[148:151], v[68:71]
    s_waitcnt lgkmcnt(5)
    ds_read_b64_tr_b16 v[38:39], v8 offset:13920
    v_mfma_f32_16x16x32_bf16 v[72:75], v[24:27], v[144:147], v[72:75]
    ds_read_b64_tr_b16 v[16:17], v8 offset:9344
    v_mfma_f32_16x16x32_bf16 v[76:79], v[24:27], v[148:151], v[76:79]
    s_waitcnt lgkmcnt(5)
    ds_read_b64_tr_b16 v[18:19], v8 offset:13952
    v_mfma_f32_16x16x32_bf16 v[128:131], v[28:31], v[152:155], v[128:131]
    ds_read_b64_tr_b16 v[20:21], v8 offset:9376
    v_mfma_f32_16x16x32_bf16 v[132:135], v[28:31], v[156:159], v[132:135]
    s_waitcnt lgkmcnt(5)
    ds_read_b64_tr_b16 v[22:23], v8 offset:13984
    s_add_u32 m0, s40, 36864
    s_nop 0
    buffer_load_dwordx4 v44, s[16:19], s29 offen lds
    s_add_u32 s29, s29, 73728
    s_cmp_eq_u32 s29, s75
    s_cselect_b32 s29, s57, s29
    v_mfma_f32_16x16x32_bf16 v[80:83], v[32:35], v[152:155], v[80:83]
    ds_read_b64_tr_b16 v[24:25], v8 offset:9408
    v_mfma_f32_16x16x32_bf16 v[84:87], v[32:35], v[156:159], v[84:87]
    s_waitcnt lgkmcnt(5)
    ds_read_b64_tr_b16 v[26:27], v8 offset:14016
    v_mfma_f32_16x16x32_bf16 v[88:91], v[36:39], v[152:155], v[88:91]
    ds_read_b64_tr_b16 v[28:29], v8 offset:9440
    v_mfma_f32_16x16x32_bf16 v[92:95], v[36:39], v[156:159], v[92:95]
    s_waitcnt lgkmcnt(5)
    ds_read_b64_tr_b16 v[30:31], v8 offset:14048
    v_mfma_f32_16x16x32_bf16 v[96:99], v[16:19], v[152:155], v[96:99]
    ds_read_b64_tr_b16 v[32:33], v8 offset:9216
    v_mfma_f32_16x16x32_bf16 v[100:103], v[16:19], v[156:159], v[100:103]
    s_waitcnt lgkmcnt(5)
    ds_read_b64_tr_b16 v[34:35], v8 offset:13824
    v_mfma_f32_16x16x32_bf16 v[104:107], v[20:23], v[152:155], v[104:107]
    ds_read_b64_tr_b16 v[36:37], v8 offset:9248
    v_mfma_f32_16x16x32_bf16 v[108:111], v[20:23], v[156:159], v[108:111]
    s_waitcnt lgkmcnt(5)
    ds_read_b64_tr_b16 v[38:39], v8 offset:13856
    v_mfma_f32_16x16x32_bf16 v[112:115], v[24:27], v[152:155], v[112:115]
    s_waitcnt vmcnt(13)
    s_barrier
    ds_read_b64_tr_b16 v[16:17], v8 offset:18688
    v_mfma_f32_16x16x32_bf16 v[116:119], v[24:27], v[156:159], v[116:119]
    s_waitcnt lgkmcnt(5)
    ds_read_b64_tr_b16 v[18:19], v8 offset:23296
    buffer_load_dwordx4 v[192:195], v7, s[20:23], s30 offen offset:0 sc1
    buffer_load_dwordx4 v[196:199], v7, s[20:23], s30 offen offset:1024 sc1
    v_mfma_f32_16x16x32_bf16 v[120:123], v[28:31], v[152:155], v[120:123]
    ds_read_b64_tr_b16 v[20:21], v8 offset:18496
    v_mfma_f32_16x16x32_bf16 v[124:127], v[28:31], v[156:159], v[124:127]
    s_waitcnt lgkmcnt(5)
    ds_read_b64_tr_b16 v[22:23], v8 offset:23104
    v_mfma_f32_16x16x32_bf16 v[64:67], v[32:35], v[152:155], v[64:67]
    ds_read_b64_tr_b16 v[24:25], v8 offset:18528
    v_mfma_f32_16x16x32_bf16 v[68:71], v[32:35], v[156:159], v[68:71]
    s_waitcnt lgkmcnt(5)
    ds_read_b64_tr_b16 v[26:27], v8 offset:23136
    v_mfma_f32_16x16x32_bf16 v[72:75], v[36:39], v[152:155], v[72:75]
    ds_read_b64_tr_b16 v[28:29], v8 offset:18560
    v_mfma_f32_16x16x32_bf16 v[76:79], v[36:39], v[156:159], v[76:79]
    s_waitcnt lgkmcnt(5)
    ds_read_b64_tr_b16 v[30:31], v8 offset:23168
    buffer_load_dwordx4 v[200:203], v7, s[20:23], s30 offen offset:2048 sc1
    buffer_load_dwordx4 v[204:207], v7, s[20:23], s30 offen offset:3072 sc1
    s_add_u32 s30, s30, 4096
    s_cmp_eq_u32 s30, s53
    s_cselect_b32 s30, s46, s30
    v_mfma_f32_16x16x32_bf16 v[128:131], v[16:19], v[160:163], v[128:131]
    ds_read_b64_tr_b16 v[32:33], v8 offset:18592
    v_mfma_f32_16x16x32_bf16 v[132:135], v[16:19], v[164:167], v[132:135]
    s_waitcnt lgkmcnt(5)
    ds_read_b64_tr_b16 v[34:35], v8 offset:23200
    v_mfma_f32_16x16x32_bf16 v[80:83], v[20:23], v[160:163], v[80:83]
    ds_read_b64_tr_b16 v[36:37], v8 offset:18624
    v_mfma_f32_16x16x32_bf16 v[84:87], v[20:23], v[164:167], v[84:87]
    s_waitcnt lgkmcnt(5)
    ds_read_b64_tr_b16 v[38:39], v8 offset:23232
    v_mfma_f32_16x16x32_bf16 v[88:91], v[24:27], v[160:163], v[88:91]
    ds_read_b64_tr_b16 v[16:17], v8 offset:18656
    v_mfma_f32_16x16x32_bf16 v[92:95], v[24:27], v[164:167], v[92:95]
    s_waitcnt lgkmcnt(5)
    ds_read_b64_tr_b16 v[18:19], v8 offset:23264
    s_add_u32 m0, s38, 55296
    s_nop 0
    buffer_load_dwordx4 v40, s[16:19], s29 offen lds
    s_add_u32 m0, s38, 59392
    s_nop 0
    buffer_load_dwordx4 v41, s[16:19], s29 offen lds
    v_mfma_f32_16x16x32_bf16 v[96:99], v[28:31], v[160:163], v[96:99]
    ds_read_b64_tr_b16 v[20:21], v8 offset:18432
    v_mfma_f32_16x16x32_bf16 v[100:103], v[28:31], v[164:167], v[100:103]
    s_waitcnt lgkmcnt(5)
    ds_read_b64_tr_b16 v[22:23], v8 offset:23040
    v_mfma_f32_16x16x32_bf16 v[104:107], v[32:35], v[160:163], v[104:107]
    ds_read_b64_tr_b16 v[24:25], v8 offset:18464
    v_mfma_f32_16x16x32_bf16 v[108:111], v[32:35], v[164:167], v[108:111]
    s_waitcnt lgkmcnt(5)
    ds_read_b64_tr_b16 v[26:27], v8 offset:23072
    v_mfma_f32_16x16x32_bf16 v[112:115], v[36:39], v[160:163], v[112:115]
    s_barrier
    ds_read_b64_tr_b16 v[28:29], v8 offset:27904
    v_mfma_f32_16x16x32_bf16 v[116:119], v[36:39], v[164:167], v[116:119]
    s_waitcnt lgkmcnt(5)
    ds_read_b64_tr_b16 v[30:31], v8 offset:32512
    v_mfma_f32_16x16x32_bf16 v[120:123], v[16:19], v[160:163], v[120:123]
    ds_read_b64_tr_b16 v[32:33], v8 offset:27712
    v_mfma_f32_16x16x32_bf16 v[124:127], v[16:19], v[164:167], v[124:127]
    s_waitcnt lgkmcnt(5)
    ds_read_b64_tr_b16 v[34:35], v8 offset:32320
    s_add_u32 m0, s38, 63488
    s_nop 0
    buffer_load_dwordx4 v42, s[16:19], s29 offen lds
    s_add_u32 m0, s38, 67584
    s_nop 0
    buffer_load_dwordx4 v43, s[16:19], s29 offen lds
    v_mfma_f32_16x16x32_bf16 v[64:67], v[20:23], v[160:163], v[64:67]
    ds_read_b64_tr_b16 v[36:37], v8 offset:27744
    v_mfma_f32_16x16x32_bf16 v[68:71], v[20:23], v[164:167], v[68:71]
    s_waitcnt lgkmcnt(5)
    ds_read_b64_tr_b16 v[38:39], v8 offset:32352
    v_mfma_f32_16x16x32_bf16 v[72:75], v[24:27], v[160:163], v[72:75]
    ds_read_b64_tr_b16 v[16:17], v8 offset:27776
    v_mfma_f32_16x16x32_bf16 v[76:79], v[24:27], v[164:167], v[76:79]
    s_waitcnt lgkmcnt(5)
    ds_read_b64_tr_b16 v[18:19], v8 offset:32384
    v_mfma_f32_16x16x32_bf16 v[128:131], v[28:31], v[168:171], v[128:131]
    ds_read_b64_tr_b16 v[20:21], v8 offset:27808
    v_mfma_f32_16x16x32_bf16 v[132:135], v[28:31], v[172:175], v[132:135]
    s_waitcnt lgkmcnt(5)
    ds_read_b64_tr_b16 v[22:23], v8 offset:32416
    s_add_u32 m0, s40, 55296
    s_nop 0
    buffer_load_dwordx4 v44, s[16:19], s29 offen lds
    s_add_u32 s29, s29, 73728
    s_cmp_eq_u32 s29, s75
    s_cselect_b32 s29, s57, s29
    v_mfma_f32_16x16x32_bf16 v[80:83], v[32:35], v[168:171], v[80:83]
    ds_read_b64_tr_b16 v[24:25], v8 offset:27840
    v_mfma_f32_16x16x32_bf16 v[84:87], v[32:35], v[172:175], v[84:87]
    s_waitcnt lgkmcnt(5)
    ds_read_b64_tr_b16 v[26:27], v8 offset:32448
    v_mfma_f32_16x16x32_bf16 v[88:91], v[36:39], v[168:171], v[88:91]
    ds_read_b64_tr_b16 v[28:29], v8 offset:27872
    v_mfma_f32_16x16x32_bf16 v[92:95], v[36:39], v[172:175], v[92:95]
    s_waitcnt lgkmcnt(5)
    ds_read_b64_tr_b16 v[30:31], v8 offset:32480
    v_mfma_f32_16x16x32_bf16 v[96:99], v[16:19], v[168:171], v[96:99]
    ds_read_b64_tr_b16 v[32:33], v8 offset:27648
    v_mfma_f32_16x16x32_bf16 v[100:103], v[16:19], v[172:175], v[100:103]
    s_waitcnt lgkmcnt(5)
    ds_read_b64_tr_b16 v[34:35], v8 offset:32256
    v_mfma_f32_16x16x32_bf16 v[104:107], v[20:23], v[168:171], v[104:107]
    ds_read_b64_tr_b16 v[36:37], v8 offset:27680
    v_mfma_f32_16x16x32_bf16 v[108:111], v[20:23], v[172:175], v[108:111]
    s_waitcnt lgkmcnt(5)
    ds_read_b64_tr_b16 v[38:39], v8 offset:32288
    v_mfma_f32_16x16x32_bf16 v[112:115], v[24:27], v[168:171], v[112:115]
    s_waitcnt vmcnt(9)
    s_barrier
    ds_read_b64_tr_b16 v[16:17], v10 offset:256
    v_mfma_f32_16x16x32_bf16 v[116:119], v[24:27], v[172:175], v[116:119]
    s_waitcnt lgkmcnt(5)
    ds_read_b64_tr_b16 v[18:19], v10 offset:4864
    buffer_load_dwordx4 v[144:147], v7, s[20:23], s30 offen offset:0 sc1
    buffer_load_dwordx4 v[148:151], v7, s[20:23], s30 offen offset:1024 sc1
    v_mfma_f32_16x16x32_bf16 v[120:123], v[28:31], v[168:171], v[120:123]
    ds_read_b64_tr_b16 v[20:21], v10 offset:64
    v_mfma_f32_16x16x32_bf16 v[124:127], v[28:31], v[172:175], v[124:127]
    s_waitcnt lgkmcnt(5)
    ds_read_b64_tr_b16 v[22:23], v10 offset:4672
    v_mfma_f32_16x16x32_bf16 v[64:67], v[32:35], v[168:171], v[64:67]
    ds_read_b64_tr_b16 v[24:25], v10 offset:96
    v_mfma_f32_16x16x32_bf16 v[68:71], v[32:35], v[172:175], v[68:71]
    s_waitcnt lgkmcnt(5)
    ds_read_b64_tr_b16 v[26:27], v10 offset:4704
    v_mfma_f32_16x16x32_bf16 v[72:75], v[36:39], v[168:171], v[72:75]
    ds_read_b64_tr_b16 v[28:29], v10 offset:128
    v_mfma_f32_16x16x32_bf16 v[76:79], v[36:39], v[172:175], v[76:79]
    s_waitcnt lgkmcnt(5)
    ds_read_b64_tr_b16 v[30:31], v10 offset:4736
    buffer_load_dwordx4 v[152:155], v7, s[20:23], s30 offen offset:2048 sc1
    buffer_load_dwordx4 v[156:159], v7, s[20:23], s30 offen offset:3072 sc1
    s_add_u32 s30, s30, 4096
    s_cmp_eq_u32 s30, s53
    s_cselect_b32 s30, s46, s30
    v_mfma_f32_16x16x32_bf16 v[128:131], v[16:19], v[176:179], v[128:131]
    ds_read_b64_tr_b16 v[32:33], v10 offset:160
    v_mfma_f32_16x16x32_bf16 v[132:135], v[16:19], v[180:183], v[132:135]
    s_waitcnt lgkmcnt(5)
    ds_read_b64_tr_b16 v[34:35], v10 offset:4768
    v_mfma_f32_16x16x32_bf16 v[80:83], v[20:23], v[176:179], v[80:83]
    ds_read_b64_tr_b16 v[36:37], v10 offset:192
    v_mfma_f32_16x16x32_bf16 v[84:87], v[20:23], v[180:183], v[84:87]
    s_waitcnt lgkmcnt(5)
    ds_read_b64_tr_b16 v[38:39], v10 offset:4800
    v_mfma_f32_16x16x32_bf16 v[88:91], v[24:27], v[176:179], v[88:91]
    ds_read_b64_tr_b16 v[16:17], v10 offset:224
    v_mfma_f32_16x16x32_bf16 v[92:95], v[24:27], v[180:183], v[92:95]
    s_waitcnt lgkmcnt(5)
    ds_read_b64_tr_b16 v[18:19], v10 offset:4832
    s_add_u32 m0, s38, 0
    s_nop 0
    buffer_load_dwordx4 v40, s[16:19], s29 offen lds
    s_add_u32 m0, s38, 4096
    s_nop 0
    buffer_load_dwordx4 v41, s[16:19], s29 offen lds
    v_mfma_f32_16x16x32_bf16 v[96:99], v[28:31], v[176:179], v[96:99]
    ds_read_b64_tr_b16 v[20:21], v10 offset:0
    v_mfma_f32_16x16x32_bf16 v[100:103], v[28:31], v[180:183], v[100:103]
    s_waitcnt lgkmcnt(5)
    ds_read_b64_tr_b16 v[22:23], v10 offset:4608
    v_mfma_f32_16x16x32_bf16 v[104:107], v[32:35], v[176:179], v[104:107]
    ds_read_b64_tr_b16 v[24:25], v10 offset:32
    v_mfma_f32_16x16x32_bf16 v[108:111], v[32:35], v[180:183], v[108:111]
    s_waitcnt lgkmcnt(5)
    ds_read_b64_tr_b16 v[26:27], v10 offset:4640
    v_mfma_f32_16x16x32_bf16 v[112:115], v[36:39], v[176:179], v[112:115]
    s_barrier
    ds_read_b64_tr_b16 v[28:29], v10 offset:9472
    v_mfma_f32_16x16x32_bf16 v[116:119], v[36:39], v[180:183], v[116:119]
    s_waitcnt lgkmcnt(5)
    ds_read_b64_tr_b16 v[30:31], v10 offset:14080
    v_mfma_f32_16x16x32_bf16 v[120:123], v[16:19], v[176:179], v[120:123]
    ds_read_b64_tr_b16 v[32:33], v10 offset:9280
    v_mfma_f32_16x16x32_bf16 v[124:127], v[16:19], v[180:183], v[124:127]
    s_waitcnt lgkmcnt(5)
    ds_read_b64_tr_b16 v[34:35], v10 offset:13888
    s_add_u32 m0, s38, 8192
    s_nop 0
    buffer_load_dwordx4 v42, s[16:19], s29 offen lds
    s_add_u32 m0, s38, 12288
    s_nop 0
    buffer_load_dwordx4 v43, s[16:19], s29 offen lds
    v_mfma_f32_16x16x32_bf16 v[64:67], v[20:23], v[176:179], v[64:67]
    ds_read_b64_tr_b16 v[36:37], v10 offset:9312
    v_mfma_f32_16x16x32_bf16 v[68:71], v[20:23], v[180:183], v[68:71]
    s_waitcnt lgkmcnt(5)
    ds_read_b64_tr_b16 v[38:39], v10 offset:13920
    v_mfma_f32_16x16x32_bf16 v[72:75], v[24:27], v[176:179], v[72:75]
    ds_read_b64_tr_b16 v[16:17], v10 offset:9344
    v_mfma_f32_16x16x32_bf16 v[76:79], v[24:27], v[180:183], v[76:79]
    s_waitcnt lgkmcnt(5)
    ds_read_b64_tr_b16 v[18:19], v10 offset:13952
    v_mfma_f32_16x16x32_bf16 v[128:131], v[28:31], v[184:187], v[128:131]
    ds_read_b64_tr_b16 v[20:21], v10 offset:9376
    v_mfma_f32_16x16x32_bf16 v[132:135], v[28:31], v[188:191], v[132:135]
    s_waitcnt lgkmcnt(5)
    ds_read_b64_tr_b16 v[22:23], v10 offset:13984
    s_add_u32 m0, s40, 0
    s_nop 0
    buffer_load_dwordx4 v44, s[16:19], s29 offen lds
    s_add_u32 s29, s29, 73728
    s_cmp_eq_u32 s29, s75
    s_cselect_b32 s29, s57, s29
    v_mfma_f32_16x16x32_bf16 v[80:83], v[32:35], v[184:187], v[80:83]
    ds_read_b64_tr_b16 v[24:25], v10 offset:9408
    v_mfma_f32_16x16x32_bf16 v[84:87], v[32:35], v[188:191], v[84:87]
    s_waitcnt lgkmcnt(5)
    ds_read_b64_tr_b16 v[26:27], v10 offset:14016
    v_mfma_f32_16x16x32_bf16 v[88:91], v[36:39], v[184:187], v[88:91]
    ds_read_b64_tr_b16 v[28:29], v10 offset:9440
    v_mfma_f32_16x16x32_bf16 v[92:95], v[36:39], v[188:191], v[92:95]
    s_waitcnt lgkmcnt(5)
    ds_read_b64_tr_b16 v[30:31], v10 offset:14048
    v_mfma_f32_16x16x32_bf16 v[96:99], v[16:19], v[184:187], v[96:99]
    ds_read_b64_tr_b16 v[32:33], v10 offset:9216
    v_mfma_f32_16x16x32_bf16 v[100:103], v[16:19], v[188:191], v[100:103]
    s_waitcnt lgkmcnt(5)
    ds_read_b64_tr_b16 v[34:35], v10 offset:13824
    v_mfma_f32_16x16x32_bf16 v[104:107], v[20:23], v[184:187], v[104:107]
    ds_read_b64_tr_b16 v[36:37], v10 offset:9248
    v_mfma_f32_16x16x32_bf16 v[108:111], v[20:23], v[188:191], v[108:111]
    s_waitcnt lgkmcnt(5)
    ds_read_b64_tr_b16 v[38:39], v10 offset:13856
    v_mfma_f32_16x16x32_bf16 v[112:115], v[24:27], v[184:187], v[112:115]
    s_waitcnt vmcnt(9)
    s_barrier
    ds_read_b64_tr_b16 v[16:17], v10 offset:18688
    v_mfma_f32_16x16x32_bf16 v[116:119], v[24:27], v[188:191], v[116:119]
    s_waitcnt lgkmcnt(5)
    ds_read_b64_tr_b16 v[18:19], v10 offset:23296
    buffer_load_dwordx4 v[160:163], v7, s[20:23], s30 offen offset:0 sc1
    buffer_load_dwordx4 v[164:167], v7, s[20:23], s30 offen offset:1024 sc1
    v_mfma_f32_16x16x32_bf16 v[120:123], v[28:31], v[184:187], v[120:123]
    ds_read_b64_tr_b16 v[20:21], v10 offset:18496
    v_mfma_f32_16x16x32_bf16 v[124:127], v[28:31], v[188:191], v[124:127]
    s_waitcnt lgkmcnt(5)
    ds_read_b64_tr_b16 v[22:23], v10 offset:23104
    v_mfma_f32_16x16x32_bf16 v[64:67], v[32:35], v[184:187], v[64:67]
    ds_read_b64_tr_b16 v[24:25], v10 offset:18528
    v_mfma_f32_16x16x32_bf16 v[68:71], v[32:35], v[188:191], v[68:71]
    s_waitcnt lgkmcnt(5)
    ds_read_b64_tr_b16 v[26:27], v10 offset:23136
    v_mfma_f32_16x16x32_bf16 v[72:75], v[36:39], v[184:187], v[72:75]
    ds_read_b64_tr_b16 v[28:29], v10 offset:18560
    v_mfma_f32_16x16x32_bf16 v[76:79], v[36:39], v[188:191], v[76:79]
    s_waitcnt lgkmcnt(5)
    ds_read_b64_tr_b16 v[30:31], v10 offset:23168
    buffer_load_dwordx4 v[168:171], v7, s[20:23], s30 offen offset:2048 sc1
    buffer_load_dwordx4 v[172:175], v7, s[20:23], s30 offen offset:3072 sc1
    s_add_u32 s30, s30, 4096
    s_cmp_eq_u32 s30, s53
    s_cselect_b32 s30, s46, s30
    v_mfma_f32_16x16x32_bf16 v[128:131], v[16:19], v[192:195], v[128:131]
    ds_read_b64_tr_b16 v[32:33], v10 offset:18592
    v_mfma_f32_16x16x32_bf16 v[132:135], v[16:19], v[196:199], v[132:135]
    s_waitcnt lgkmcnt(5)
    ds_read_b64_tr_b16 v[34:35], v10 offset:23200
    v_mfma_f32_16x16x32_bf16 v[80:83], v[20:23], v[192:195], v[80:83]
    ds_read_b64_tr_b16 v[36:37], v10 offset:18624
    v_mfma_f32_16x16x32_bf16 v[84:87], v[20:23], v[196:199], v[84:87]
    s_waitcnt lgkmcnt(5)
    ds_read_b64_tr_b16 v[38:39], v10 offset:23232
    v_mfma_f32_16x16x32_bf16 v[88:91], v[24:27], v[192:195], v[88:91]
    ds_read_b64_tr_b16 v[16:17], v10 offset:18656
    v_mfma_f32_16x16x32_bf16 v[92:95], v[24:27], v[196:199], v[92:95]
    s_waitcnt lgkmcnt(5)
    ds_read_b64_tr_b16 v[18:19], v10 offset:23264
    s_add_u32 m0, s38, 18432
    s_nop 0
    buffer_load_dwordx4 v40, s[16:19], s29 offen lds
    s_add_u32 m0, s38, 22528
    s_nop 0
    buffer_load_dwordx4 v41, s[16:19], s29 offen lds
    v_mfma_f32_16x16x32_bf16 v[96:99], v[28:31], v[192:195], v[96:99]
    ds_read_b64_tr_b16 v[20:21], v10 offset:18432
    v_mfma_f32_16x16x32_bf16 v[100:103], v[28:31], v[196:199], v[100:103]
    s_waitcnt lgkmcnt(5)
    ds_read_b64_tr_b16 v[22:23], v10 offset:23040
    v_mfma_f32_16x16x32_bf16 v[104:107], v[32:35], v[192:195], v[104:107]
    ds_read_b64_tr_b16 v[24:25], v10 offset:18464
    v_mfma_f32_16x16x32_bf16 v[108:111], v[32:35], v[196:199], v[108:111]
    s_waitcnt lgkmcnt(5)
    ds_read_b64_tr_b16 v[26:27], v10 offset:23072
    v_mfma_f32_16x16x32_bf16 v[112:115], v[36:39], v[192:195], v[112:115]
    s_barrier
    ds_read_b64_tr_b16 v[28:29], v10 offset:27904
    v_mfma_f32_16x16x32_bf16 v[116:119], v[36:39], v[196:199], v[116:119]
    s_waitcnt lgkmcnt(5)
    ds_read_b64_tr_b16 v[30:31], v10 offset:32512
    v_mfma_f32_16x16x32_bf16 v[120:123], v[16:19], v[192:195], v[120:123]
    ds_read_b64_tr_b16 v[32:33], v10 offset:27712
    v_mfma_f32_16x16x32_bf16 v[124:127], v[16:19], v[196:199], v[124:127]
    s_waitcnt lgkmcnt(5)
    ds_read_b64_tr_b16 v[34:35], v10 offset:32320
    s_add_u32 m0, s38, 26624
    s_nop 0
    buffer_load_dwordx4 v42, s[16:19], s29 offen lds
    s_add_u32 m0, s38, 30720
    s_nop 0
    buffer_load_dwordx4 v43, s[16:19], s29 offen lds
    v_mfma_f32_16x16x32_bf16 v[64:67], v[20:23], v[192:195], v[64:67]
    ds_read_b64_tr_b16 v[36:37], v10 offset:27744
    v_mfma_f32_16x16x32_bf16 v[68:71], v[20:23], v[196:199], v[68:71]
    s_waitcnt lgkmcnt(5)
    ds_read_b64_tr_b16 v[38:39], v10 offset:32352
    v_mfma_f32_16x16x32_bf16 v[72:75], v[24:27], v[192:195], v[72:75]
    ds_read_b64_tr_b16 v[16:17], v10 offset:27776
    v_mfma_f32_16x16x32_bf16 v[76:79], v[24:27], v[196:199], v[76:79]
    s_waitcnt lgkmcnt(5)
    ds_read_b64_tr_b16 v[18:19], v10 offset:32384
    v_mfma_f32_16x16x32_bf16 v[128:131], v[28:31], v[200:203], v[128:131]
    ds_read_b64_tr_b16 v[20:21], v10 offset:27808
    v_mfma_f32_16x16x32_bf16 v[132:135], v[28:31], v[204:207], v[132:135]
    s_waitcnt lgkmcnt(5)
    ds_read_b64_tr_b16 v[22:23], v10 offset:32416
    s_add_u32 m0, s40, 18432
    s_nop 0
    buffer_load_dwordx4 v44, s[16:19], s29 offen lds
    s_add_u32 s29, s29, 73728
    s_cmp_eq_u32 s29, s75
    s_cselect_b32 s29, s57, s29
    v_mfma_f32_16x16x32_bf16 v[80:83], v[32:35], v[200:203], v[80:83]
    ds_read_b64_tr_b16 v[24:25], v10 offset:27840
    v_mfma_f32_16x16x32_bf16 v[84:87], v[32:35], v[204:207], v[84:87]
    s_waitcnt lgkmcnt(5)
    ds_read_b64_tr_b16 v[26:27], v10 offset:32448
    v_mfma_f32_16x16x32_bf16 v[88:91], v[36:39], v[200:203], v[88:91]
    ds_read_b64_tr_b16 v[28:29], v10 offset:27872
    v_mfma_f32_16x16x32_bf16 v[92:95], v[36:39], v[204:207], v[92:95]
    s_waitcnt lgkmcnt(5)
    ds_read_b64_tr_b16 v[30:31], v10 offset:32480
    v_mfma_f32_16x16x32_bf16 v[96:99], v[16:19], v[200:203], v[96:99]
    ds_read_b64_tr_b16 v[32:33], v10 offset:27648
    v_mfma_f32_16x16x32_bf16 v[100:103], v[16:19], v[204:207], v[100:103]
    s_waitcnt lgkmcnt(5)
    ds_read_b64_tr_b16 v[34:35], v10 offset:32256
    v_mfma_f32_16x16x32_bf16 v[104:107], v[20:23], v[200:203], v[104:107]
    ds_read_b64_tr_b16 v[36:37], v10 offset:27680
    v_mfma_f32_16x16x32_bf16 v[108:111], v[20:23], v[204:207], v[108:111]
    s_waitcnt lgkmcnt(5)
    ds_read_b64_tr_b16 v[38:39], v10 offset:32288
    v_mfma_f32_16x16x32_bf16 v[112:115], v[24:27], v[200:203], v[112:115]
    s_waitcnt vmcnt(9)
    s_barrier
    ds_read_b64_tr_b16 v[16:17], v8 offset:256
    v_mfma_f32_16x16x32_bf16 v[116:119], v[24:27], v[204:207], v[116:119]
    s_waitcnt lgkmcnt(5)
    ds_read_b64_tr_b16 v[18:19], v8 offset:4864
    s_add_u32 m0, s38, 36864
    s_nop 0
    buffer_load_dwordx4 v45, s[68:71], s55 offen lds
    s_add_u32 m0, s38, 40960
    s_nop 0
    buffer_load_dwordx4 v46, s[68:71], s55 offen lds
    s_add_u32 m0, s38, 45056
    s_nop 0
    buffer_load_dwordx4 v47, s[68:71], s55 offen lds
    v_mfma_f32_16x16x32_bf16 v[120:123], v[28:31], v[200:203], v[120:123]
    ds_read_b64_tr_b16 v[20:21], v8 offset:64
    v_mfma_f32_16x16x32_bf16 v[124:127], v[28:31], v[204:207], v[124:127]
    s_waitcnt lgkmcnt(5)
    ds_read_b64_tr_b16 v[22:23], v8 offset:4672
    v_mfma_f32_16x16x32_bf16 v[64:67], v[32:35], v[200:203], v[64:67]
    ds_read_b64_tr_b16 v[24:25], v8 offset:96
    v_mfma_f32_16x16x32_bf16 v[68:71], v[32:35], v[204:207], v[68:71]
    s_waitcnt lgkmcnt(5)
    ds_read_b64_tr_b16 v[26:27], v8 offset:4704
    v_mfma_f32_16x16x32_bf16 v[72:75], v[36:39], v[200:203], v[72:75]
    ds_read_b64_tr_b16 v[28:29], v8 offset:128
    v_mfma_f32_16x16x32_bf16 v[76:79], v[36:39], v[204:207], v[76:79]
    s_waitcnt lgkmcnt(5)
    ds_read_b64_tr_b16 v[30:31], v8 offset:4736
    s_add_u32 m0, s38, 49152
    s_nop 0
    buffer_load_dwordx4 v48, s[68:71], s55 offen lds
    s_add_u32 m0, s40, 36864
    s_nop 0
    buffer_load_dwordx4 v49, s[68:71], s55 offen lds
    s_add_u32 s55, s55, 82944
    v_mfma_f32_16x16x32_bf16 v[128:131], v[16:19], v[144:147], v[128:131]
    ds_read_b64_tr_b16 v[32:33], v8 offset:160
    v_mfma_f32_16x16x32_bf16 v[132:135], v[16:19], v[148:151], v[132:135]
    s_waitcnt lgkmcnt(5)
    ds_read_b64_tr_b16 v[34:35], v8 offset:4768
    v_mfma_f32_16x16x32_bf16 v[80:83], v[20:23], v[144:147], v[80:83]
    ds_read_b64_tr_b16 v[36:37], v8 offset:192
    v_mfma_f32_16x16x32_bf16 v[84:87], v[20:23], v[148:151], v[84:87]
    s_waitcnt lgkmcnt(5)
    ds_read_b64_tr_b16 v[38:39], v8 offset:4800
    v_mfma_f32_16x16x32_bf16 v[88:91], v[24:27], v[144:147], v[88:91]
    ds_read_b64_tr_b16 v[16:17], v8 offset:224
    v_mfma_f32_16x16x32_bf16 v[92:95], v[24:27], v[148:151], v[92:95]
    s_waitcnt lgkmcnt(5)
    ds_read_b64_tr_b16 v[18:19], v8 offset:4832
    v_mfma_f32_16x16x32_bf16 v[96:99], v[28:31], v[144:147], v[96:99]
    ds_read_b64_tr_b16 v[20:21], v8 offset:0
    v_mfma_f32_16x16x32_bf16 v[100:103], v[28:31], v[148:151], v[100:103]
    s_waitcnt lgkmcnt(5)
    ds_read_b64_tr_b16 v[22:23], v8 offset:4608
    v_mfma_f32_16x16x32_bf16 v[104:107], v[32:35], v[144:147], v[104:107]
    ds_read_b64_tr_b16 v[24:25], v8 offset:32
    v_mfma_f32_16x16x32_bf16 v[108:111], v[32:35], v[148:151], v[108:111]
    s_waitcnt lgkmcnt(5)
    ds_read_b64_tr_b16 v[26:27], v8 offset:4640
    v_mfma_f32_16x16x32_bf16 v[112:115], v[36:39], v[144:147], v[112:115]
    s_barrier
    ds_read_b64_tr_b16 v[28:29], v8 offset:9472
    v_mfma_f32_16x16x32_bf16 v[116:119], v[36:39], v[148:151], v[116:119]
    s_waitcnt lgkmcnt(5)
    ds_read_b64_tr_b16 v[30:31], v8 offset:14080
    v_mfma_f32_16x16x32_bf16 v[120:123], v[16:19], v[144:147], v[120:123]
    ds_read_b64_tr_b16 v[32:33], v8 offset:9280
    v_mfma_f32_16x16x32_bf16 v[124:127], v[16:19], v[148:151], v[124:127]
    s_waitcnt lgkmcnt(5)
    ds_read_b64_tr_b16 v[34:35], v8 offset:13888
    v_mfma_f32_16x16x32_bf16 v[64:67], v[20:23], v[144:147], v[64:67]
    ds_read_b64_tr_b16 v[36:37], v8 offset:9312
    v_mfma_f32_16x16x32_bf16 v[68:71], v[20:23], v[148:151], v[68:71]
    s_waitcnt lgkmcnt(5)
    ds_read_b64_tr_b16 v[38:39], v8 offset:13920
    v_mfma_f32_16x16x32_bf16 v[72:75], v[24:27], v[144:147], v[72:75]
    ds_read_b64_tr_b16 v[16:17], v8 offset:9344
    v_mfma_f32_16x16x32_bf16 v[76:79], v[24:27], v[148:151], v[76:79]
    s_waitcnt lgkmcnt(5)
    ds_read_b64_tr_b16 v[18:19], v8 offset:13952
    v_mfma_f32_16x16x32_bf16 v[128:131], v[28:31], v[152:155], v[128:131]
    ds_read_b64_tr_b16 v[20:21], v8 offset:9376
    v_mfma_f32_16x16x32_bf16 v[132:135], v[28:31], v[156:159], v[132:135]
    s_waitcnt lgkmcnt(5)
    ds_read_b64_tr_b16 v[22:23], v8 offset:13984
    v_mfma_f32_16x16x32_bf16 v[80:83], v[32:35], v[152:155], v[80:83]
    ds_read_b64_tr_b16 v[24:25], v8 offset:9408
    v_mfma_f32_16x16x32_bf16 v[84:87], v[32:35], v[156:159], v[84:87]
    s_waitcnt lgkmcnt(5)
    ds_read_b64_tr_b16 v[26:27], v8 offset:14016
    buffer_load_dword v60, v13, s[20:23], s72 offen sc1
    v_mfma_f32_16x16x32_bf16 v[88:91], v[36:39], v[152:155], v[88:91]
    ds_read_b64_tr_b16 v[28:29], v8 offset:9440
    v_mfma_f32_16x16x32_bf16 v[92:95], v[36:39], v[156:159], v[92:95]
    s_waitcnt lgkmcnt(5)
    ds_read_b64_tr_b16 v[30:31], v8 offset:14048
    v_mfma_f32_16x16x32_bf16 v[96:99], v[16:19], v[152:155], v[96:99]
    ds_read_b64_tr_b16 v[32:33], v8 offset:9216
    v_mfma_f32_16x16x32_bf16 v[100:103], v[16:19], v[156:159], v[100:103]
    s_waitcnt lgkmcnt(5)
    ds_read_b64_tr_b16 v[34:35], v8 offset:13824
    v_mfma_f32_16x16x32_bf16 v[104:107], v[20:23], v[152:155], v[104:107]
    ds_read_b64_tr_b16 v[36:37], v8 offset:9248
    v_mfma_f32_16x16x32_bf16 v[108:111], v[20:23], v[156:159], v[108:111]
    s_waitcnt lgkmcnt(5)
    ds_read_b64_tr_b16 v[38:39], v8 offset:13856
    v_mfma_f32_16x16x32_bf16 v[112:115], v[24:27], v[152:155], v[112:115]
    s_waitcnt vmcnt(6)
    s_barrier
    ds_read_b64_tr_b16 v[16:17], v8 offset:18688
    v_mfma_f32_16x16x32_bf16 v[116:119], v[24:27], v[156:159], v[116:119]
    s_waitcnt lgkmcnt(5)
    ds_read_b64_tr_b16 v[18:19], v8 offset:23296
    s_add_u32 m0, s38, 55296
    s_nop 0
    buffer_load_dwordx4 v45, s[68:71], s55 offen lds
    s_add_u32 m0, s38, 59392
    s_nop 0
    buffer_load_dwordx4 v46, s[68:71], s55 offen lds
    s_add_u32 m0, s38, 63488
    s_nop 0
    buffer_load_dwordx4 v47, s[68:71], s55 offen lds
    v_mfma_f32_16x16x32_bf16 v[120:123], v[28:31], v[152:155], v[120:123]
    ds_read_b64_tr_b16 v[20:21], v8 offset:18496
    v_mfma_f32_16x16x32_bf16 v[124:127], v[28:31], v[156:159], v[124:127]
    s_waitcnt lgkmcnt(5)
    ds_read_b64_tr_b16 v[22:23], v8 offset:23104
    v_mfma_f32_16x16x32_bf16 v[64:67], v[32:35], v[152:155], v[64:67]
    ds_read_b64_tr_b16 v[24:25], v8 offset:18528
    v_mfma_f32_16x16x32_bf16 v[68:71], v[32:35], v[156:159], v[68:71]
    s_waitcnt lgkmcnt(5)
    ds_read_b64_tr_b16 v[26:27], v8 offset:23136
    v_mfma_f32_16x16x32_bf16 v[72:75], v[36:39], v[152:155], v[72:75]
    ds_read_b64_tr_b16 v[28:29], v8 offset:18560
    v_mfma_f32_16x16x32_bf16 v[76:79], v[36:39], v[156:159], v[76:79]
    s_waitcnt lgkmcnt(5)
    ds_read_b64_tr_b16 v[30:31], v8 offset:23168
    s_add_u32 m0, s38, 67584
    s_nop 0
    buffer_load_dwordx4 v48, s[68:71], s55 offen lds
    s_add_u32 m0, s40, 55296
    s_nop 0
    buffer_load_dwordx4 v49, s[68:71], s55 offen lds
    s_add_u32 s55, s55, 82944
    v_mfma_f32_16x16x32_bf16 v[128:131], v[16:19], v[160:163], v[128:131]
    ds_read_b64_tr_b16 v[32:33], v8 offset:18592
    v_mfma_f32_16x16x32_bf16 v[132:135], v[16:19], v[164:167], v[132:135]
    s_waitcnt lgkmcnt(5)
    ds_read_b64_tr_b16 v[34:35], v8 offset:23200
    v_mfma_f32_16x16x32_bf16 v[80:83], v[20:23], v[160:163], v[80:83]
    ds_read_b64_tr_b16 v[36:37], v8 offset:18624
    v_mfma_f32_16x16x32_bf16 v[84:87], v[20:23], v[164:167], v[84:87]
    s_waitcnt lgkmcnt(5)
    ds_read_b64_tr_b16 v[38:39], v8 offset:23232
    s_waitcnt vmcnt(5)
    v_cmp_ne_u32 vcc, s101, v60
    s_nop 0
    s_and_b64 vcc, vcc, s[44:45]
    s_cbranch_scc0 K2_GP1_D
    s_mov_b32 s47, 0
K2_GP1:
    buffer_load_dword v60, v13, s[20:23], s72 offen sc1
    s_add_u32 s47, s47, 1
    s_waitcnt vmcnt(0)
    v_cmp_ne_u32 vcc, s101, v60
    s_cmp_ge_u32 s47, 0x40000
    s_cbranch_scc1 K2_GP1_D
    s_and_b64 vcc, vcc, s[44:45]
    s_cbranch_scc0 K2_GP1_D
    s_sleep 2
    s_branch K2_GP1
K2_GP1_D:
    buffer_load_dwordx4 v[176:179], v11, s[20:23], s73 offen offset:0 sc1
    buffer_load_dwordx4 v[180:183], v11, s[20:23], s73 offen offset:256 sc1
    buffer_load_dwordx4 v[184:187], v11, s[20:23], s73 offen offset:2048 sc1
    buffer_load_dwordx4 v[188:191], v11, s[20:23], s73 offen offset:2304 sc1
    s_add_u32 s73, s73, 4096
    buffer_load_dwordx4 v[192:195], v11, s[20:23], s73 offen offset:0 sc1
    buffer_load_dwordx4 v[196:199], v11, s[20:23], s73 offen offset:256 sc1
    buffer_load_dwordx4 v[200:203], v11, s[20:23], s73 offen offset:2048 sc1
    buffer_load_dwordx4 v[204:207], v11, s[20:23], s73 offen offset:2304 sc1
    s_add_u32 s73, s73, 4096
    buffer_load_dword v208, v223, s[20:23], s73 offen offset:0 sc1
    buffer_load_dword v209, v223, s[20:23], s73 offen offset:128 sc1
    buffer_load_dword v210, v223, s[20:23], s73 offen offset:64 sc1
    buffer_load_dword v211, v223, s[20:23], s73 offen offset:192 sc1
    v_mfma_f32_16x16x32_bf16 v[88:91], v[24:27], v[160:163], v[88:91]
    ds_read_b64_tr_b16 v[16:17], v8 offset:18656
    v_mfma_f32_16x16x32_bf16 v[92:95], v[24:27], v[164:167], v[92:95]
    s_waitcnt lgkmcnt(5)
    ds_read_b64_tr_b16 v[18:19], v8 offset:23264
    v_mfma_f32_16x16x32_bf16 v[96:99], v[28:31], v[160:163], v[96:99]
    ds_read_b64_tr_b16 v[20:21], v8 offset:18432
    v_mfma_f32_16x16x32_bf16 v[100:103], v[28:31], v[164:167], v[100:103]
    s_waitcnt lgkmcnt(5)
    ds_read_b64_tr_b16 v[22:23], v8 offset:23040
    v_mfma_f32_16x16x32_bf16 v[104:107], v[32:35], v[160:163], v[104:107]
    ds_read_b64_tr_b16 v[24:25], v8 offset:18464
    v_mfma_f32_16x16x32_bf16 v[108:111], v[32:35], v[164:167], v[108:111]
    s_waitcnt lgkmcnt(5)
    ds_read_b64_tr_b16 v[26:27], v8 offset:23072
    v_mfma_f32_16x16x32_bf16 v[112:115], v[36:39], v[160:163], v[112:115]
    ds_read_b64_tr_b16 v[28:29], v8 offset:27904
    v_mfma_f32_16x16x32_bf16 v[116:119], v[36:39], v[164:167], v[116:119]
    s_waitcnt lgkmcnt(5)
    ds_read_b64_tr_b16 v[30:31], v8 offset:32512
    v_mfma_f32_16x16x32_bf16 v[120:123], v[16:19], v[160:163], v[120:123]
    ds_read_b64_tr_b16 v[32:33], v8 offset:27712
    v_mfma_f32_16x16x32_bf16 v[124:127], v[16:19], v[164:167], v[124:127]
    s_waitcnt lgkmcnt(5)
    ds_read_b64_tr_b16 v[34:35], v8 offset:32320
    v_mfma_f32_16x16x32_bf16 v[64:67], v[20:23], v[160:163], v[64:67]
    ds_read_b64_tr_b16 v[36:37], v8 offset:27744
    v_mfma_f32_16x16x32_bf16 v[68:71], v[20:23], v[164:167], v[68:71]
    s_waitcnt lgkmcnt(5)
    ds_read_b64_tr_b16 v[38:39], v8 offset:32352
    v_mfma_f32_16x16x32_bf16 v[72:75], v[24:27], v[160:163], v[72:75]
    ds_read_b64_tr_b16 v[16:17], v8 offset:27776
    v_mfma_f32_16x16x32_bf16 v[76:79], v[24:27], v[164:167], v[76:79]
    s_waitcnt lgkmcnt(5)
    ds_read_b64_tr_b16 v[18:19], v8 offset:32384
    v_mfma_f32_16x16x32_bf16 v[128:131], v[28:31], v[168:171], v[128:131]
    ds_read_b64_tr_b16 v[20:21], v8 offset:27808
    v_mfma_f32_16x16x32_bf16 v[132:135], v[28:31], v[172:175], v[132:135]
    s_waitcnt lgkmcnt(5)
    ds_read_b64_tr_b16 v[22:23], v8 offset:32416
    v_mfma_f32_16x16x32_bf16 v[80:83], v[32:35], v[168:171], v[80:83]
    ds_read_b64_tr_b16 v[24:25], v8 offset:27840
    v_mfma_f32_16x16x32_bf16 v[84:87], v[32:35], v[172:175], v[84:87]
    s_waitcnt lgkmcnt(5)
    ds_read_b64_tr_b16 v[26:27], v8 offset:32448
    v_mfma_f32_16x16x32_bf16 v[88:91], v[36:39], v[168:171], v[88:91]
    ds_read_b64_tr_b16 v[28:29], v8 offset:27872
    v_mfma_f32_16x16x32_bf16 v[92:95], v[36:39], v[172:175], v[92:95]
    s_waitcnt lgkmcnt(5)
    ds_read_b64_tr_b16 v[30:31], v8 offset:32480
    v_mfma_f32_16x16x32_bf16 v[96:99], v[16:19], v[168:171], v[96:99]
    ds_read_b64_tr_b16 v[32:33], v8 offset:27648
    v_mfma_f32_16x16x32_bf16 v[100:103], v[16:19], v[172:175], v[100:103]
    s_waitcnt lgkmcnt(5)
    ds_read_b64_tr_b16 v[34:35], v8 offset:32256
    v_mfma_f32_16x16x32_bf16 v[104:107], v[20:23], v[168:171], v[104:107]
    ds_read_b64_tr_b16 v[36:37], v8 offset:27680
    v_mfma_f32_16x16x32_bf16 v[108:111], v[20:23], v[172:175], v[108:111]
    s_waitcnt lgkmcnt(5)
    ds_read_b64_tr_b16 v[38:39], v8 offset:32288
    v_mfma_f32_16x16x32_bf16 v[112:115], v[24:27], v[168:171], v[112:115]
    s_waitcnt vmcnt(12)
    s_barrier
    ds_read_b64_tr_b16 v[16:17], v9 offset:256
    v_mfma_f32_16x16x32_bf16 v[116:119], v[24:27], v[172:175], v[116:119]
    s_waitcnt lgkmcnt(5)
    ds_read_b64_tr_b16 v[18:19], v9 offset:2560
    v_mfma_f32_16x16x32_bf16 v[120:123], v[28:31], v[168:171], v[120:123]
    ds_read_b64_tr_b16 v[20:21], v9 offset:9472
    v_mfma_f32_16x16x32_bf16 v[124:127], v[28:31], v[172:175], v[124:127]
    s_waitcnt lgkmcnt(5)
    ds_read_b64_tr_b16 v[22:23], v9 offset:11776
    v_mfma_f32_16x16x32_bf16 v[64:67], v[32:35], v[168:171], v[64:67]
    ds_read_b64_tr_b16 v[24:25], v9 offset:18688
    v_mfma_f32_16x16x32_bf16 v[68:71], v[32:35], v[172:175], v[68:71]
    s_waitcnt lgkmcnt(5)
    ds_read_b64_tr_b16 v[26:27], v9 offset:20992
    v_mfma_f32_16x16x32_bf16 v[72:75], v[36:39], v[168:171], v[72:75]
    ds_read_b64_tr_b16 v[28:29], v9 offset:27904
    v_mfma_f32_16x16x32_bf16 v[76:79], v[36:39], v[172:175], v[76:79]
    s_waitcnt lgkmcnt(5)
    ds_read_b64_tr_b16 v[30:31], v9 offset:30208
    s_waitcnt vmcnt(10)
    v_mfma_f32_16x16x32_bf16 v[128:131], v[16:19], v[176:179], v[128:131]
    ds_read_b64_tr_b16 v[32:33], v15 offset:256
    v_mfma_f32_16x16x32_bf16 v[132:135], v[16:19], v[180:183], v[132:135]
    s_waitcnt lgkmcnt(5)
    s_waitcnt vmcnt(8)
    v_mfma_f32_16x16x32_bf16 v[128:131], v[20:23], v[184:187], v[128:131]
    ds_read_b64_tr_b16 v[36:37], v9 offset:64
    v_mfma_f32_16x16x32_bf16 v[132:135], v[20:23], v[188:191], v[132:135]
    s_waitcnt lgkmcnt(4)
    ds_read_b64_tr_b16 v[38:39], v9 offset:2368
    s_waitcnt vmcnt(6)
    v_mfma_f32_16x16x32_bf16 v[128:131], v[24:27], v[192:195], v[128:131]
    ds_read_b64_tr_b16 v[16:17], v9 offset:9280
    v_mfma_f32_16x16x32_bf16 v[132:135], v[24:27], v[196:199], v[132:135]
    s_waitcnt lgkmcnt(4)
    ds_read_b64_tr_b16 v[18:19], v9 offset:11584
    s_waitcnt vmcnt(4)
    v_mfma_f32_16x16x32_bf16 v[128:131], v[28:31], v[200:203], v[128:131]
    ds_read_b64_tr_b16 v[20:21], v9 offset:18496
    v_mfma_f32_16x16x32_bf16 v[132:135], v[28:31], v[204:207], v[132:135]
    s_waitcnt lgkmcnt(5)
    ds_read_b64_tr_b16 v[22:23], v9 offset:20800
    s_waitcnt vmcnt(0)
    v_mfma_f32_16x16x16_bf16 v[128:131], v[32:33], v[208:209], v[128:131]
    ds_read_b64_tr_b16 v[24:25], v9 offset:27712
    v_mfma_f32_16x16x16_bf16 v[132:135], v[32:33], v[210:211], v[132:135]
    s_waitcnt lgkmcnt(5)
    ds_read_b64_tr_b16 v[26:27], v9 offset:30016
    v_mfma_f32_16x16x32_bf16 v[80:83], v[36:39], v[176:179], v[80:83]
    ds_read_b64_tr_b16 v[28:29], v15 offset:64
    v_mfma_f32_16x16x32_bf16 v[84:87], v[36:39], v[180:183], v[84:87]
    s_waitcnt lgkmcnt(5)
    v_mfma_f32_16x16x32_bf16 v[80:83], v[16:19], v[184:187], v[80:83]
    ds_read_b64_tr_b16 v[32:33], v9 offset:96
    v_mfma_f32_16x16x32_bf16 v[84:87], v[16:19], v[188:191], v[84:87]
    s_waitcnt lgkmcnt(4)
    ds_read_b64_tr_b16 v[34:35], v9 offset:2400
    v_cvt_pk_bf16_f32 v52, v128, v129
    v_cvt_pk_bf16_f32 v53, v130, v131
    v_mfma_f32_16x16x32_bf16 v[80:83], v[20:23], v[192:195], v[80:83]
    ds_read_b64_tr_b16 v[36:37], v9 offset:9312
    v_mfma_f32_16x16x32_bf16 v[84:87], v[20:23], v[196:199], v[84:87]
    s_waitcnt lgkmcnt(4)
    ds_read_b64_tr_b16 v[38:39], v9 offset:11616
    v_cvt_pk_bf16_f32 v54, v132, v133
    v_cvt_pk_bf16_f32 v55, v134, v135
    v_mfma_f32_16x16x32_bf16 v[80:83], v[24:27], v[200:203], v[80:83]
    ds_read_b64_tr_b16 v[16:17], v9 offset:18528
    v_mfma_f32_16x16x32_bf16 v[84:87], v[24:27], v[204:207], v[84:87]
    s_waitcnt lgkmcnt(5)
    ds_read_b64_tr_b16 v[18:19], v9 offset:20832
    buffer_store_dwordx4 v[52:55], v59, s[20:23], s36 offen sc1
    v_mfma_f32_16x16x16_bf16 v[80:83], v[28:29], v[208:209], v[80:83]
    ds_read_b64_tr_b16 v[20:21], v9 offset:27744
    v_mfma_f32_16x16x16_bf16 v[84:87], v[28:29], v[210:211], v[84:87]
    s_waitcnt lgkmcnt(5)
    ds_read_b64_tr_b16 v[22:23], v9 offset:30048
    v_mfma_f32_16x16x32_bf16 v[88:91], v[32:35], v[176:179], v[88:91]
    ds_read_b64_tr_b16 v[24:25], v15 offset:96
    v_mfma_f32_16x16x32_bf16 v[92:95], v[32:35], v[180:183], v[92:95]
    s_waitcnt lgkmcnt(5)
    v_mfma_f32_16x16x32_bf16 v[88:91], v[36:39], v[184:187], v[88:91]
    ds_read_b64_tr_b16 v[28:29], v9 offset:128
    v_mfma_f32_16x16x32_bf16 v[92:95], v[36:39], v[188:191], v[92:95]
    s_waitcnt lgkmcnt(4)
    ds_read_b64_tr_b16 v[30:31], v9 offset:2432
    v_cvt_pk_bf16_f32 v80, v80, v81
    v_cvt_pk_bf16_f32 v81, v82, v83
    v_mfma_f32_16x16x32_bf16 v[88:91], v[16:19], v[192:195], v[88:91]
    ds_read_b64_tr_b16 v[32:33], v9 offset:9344
    v_mfma_f32_16x16x32_bf16 v[92:95], v[16:19], v[196:199], v[92:95]
    s_waitcnt lgkmcnt(4)
    ds_read_b64_tr_b16 v[34:35], v9 offset:11648
    v_cvt_pk_bf16_f32 v82, v84, v85
    v_cvt_pk_bf16_f32 v83, v86, v87
    v_mfma_f32_16x16x32_bf16 v[88:91], v[20:23], v[200:203], v[88:91]
    ds_read_b64_tr_b16 v[36:37], v9 offset:18560
    v_mfma_f32_16x16x32_bf16 v[92:95], v[20:23], v[204:207], v[92:95]
    s_waitcnt lgkmcnt(5)
    ds_read_b64_tr_b16 v[38:39], v9 offset:20864
    buffer_store_dwordx4 v[80:83], v7, s[20:23], s49 offen offset:0 sc1
    v_mfma_f32_16x16x16_bf16 v[88:91], v[24:25], v[208:209], v[88:91]
    ds_read_b64_tr_b16 v[16:17], v9 offset:27776
    v_mfma_f32_16x16x16_bf16 v[92:95], v[24:25], v[210:211], v[92:95]
    s_waitcnt lgkmcnt(5)
    ds_read_b64_tr_b16 v[18:19], v9 offset:30080
    v_mfma_f32_16x16x32_bf16 v[96:99], v[28:31], v[176:179], v[96:99]
    ds_read_b64_tr_b16 v[20:21], v15 offset:128
    v_mfma_f32_16x16x32_bf16 v[100:103], v[28:31], v[180:183], v[100:103]
    s_waitcnt lgkmcnt(5)
    v_mfma_f32_16x16x32_bf16 v[96:99], v[32:35], v[184:187], v[96:99]
    ds_read_b64_tr_b16 v[24:25], v9 offset:160
    v_mfma_f32_16x16x32_bf16 v[100:103], v[32:35], v[188:191], v[100:103]
    s_waitcnt lgkmcnt(4)
    ds_read_b64_tr_b16 v[26:27], v9 offset:2464
    v_cvt_pk_bf16_f32 v84, v88, v89
    v_cvt_pk_bf16_f32 v85, v90, v91
    v_mfma_f32_16x16x32_bf16 v[96:99], v[36:39], v[192:195], v[96:99]
    ds_read_b64_tr_b16 v[28:29], v9 offset:9376
    v_mfma_f32_16x16x32_bf16 v[100:103], v[36:39], v[196:199], v[100:103]
    s_waitcnt lgkmcnt(4)
    ds_read_b64_tr_b16 v[30:31], v9 offset:11680
    v_cvt_pk_bf16_f32 v86, v92, v93
    v_cvt_pk_bf16_f32 v87, v94, v95
    v_mfma_f32_16x16x32_bf16 v[96:99], v[16:19], v[200:203], v[96:99]
    ds_read_b64_tr_b16 v[32:33], v9 offset:18592
    v_mfma_f32_16x16x32_bf16 v[100:103], v[16:19], v[204:207], v[100:103]
    s_waitcnt lgkmcnt(5)
    ds_read_b64_tr_b16 v[34:35], v9 offset:20896
    buffer_store_dwordx4 v[84:87], v7, s[20:23], s49 offen offset:1024 sc1
    v_mfma_f32_16x16x16_bf16 v[96:99], v[20:21], v[208:209], v[96:99]
    ds_read_b64_tr_b16 v[36:37], v9 offset:27808
    v_mfma_f32_16x16x16_bf16 v[100:103], v[20:21], v[210:211], v[100:103]
    s_waitcnt lgkmcnt(5)
    ds_read_b64_tr_b16 v[38:39], v9 offset:30112
    v_mfma_f32_16x16x32_bf16 v[104:107], v[24:27], v[176:179], v[104:107]
    ds_read_b64_tr_b16 v[16:17], v15 offset:160
    v_mfma_f32_16x16x32_bf16 v[108:111], v[24:27], v[180:183], v[108:111]
    s_waitcnt lgkmcnt(5)
    v_mfma_f32_16x16x32_bf16 v[104:107], v[28:31], v[184:187], v[104:107]
    ds_read_b64_tr_b16 v[20:21], v9 offset:192
    v_mfma_f32_16x16x32_bf16 v[108:111], v[28:31], v[188:191], v[108:111]
    s_waitcnt lgkmcnt(4)
    ds_read_b64_tr_b16 v[22:23], v9 offset:2496
    v_cvt_pk_bf16_f32 v96, v96, v97
    v_cvt_pk_bf16_f32 v97, v98, v99
    v_mfma_f32_16x16x32_bf16 v[104:107], v[32:35], v[192:195], v[104:107]
    ds_read_b64_tr_b16 v[24:25], v9 offset:9408
    v_mfma_f32_16x16x32_bf16 v[108:111], v[32:35], v[196:199], v[108:111]
    s_waitcnt lgkmcnt(4)
    ds_read_b64_tr_b16 v[26:27], v9 offset:11712
    v_cvt_pk_bf16_f32 v98, v100, v101
    v_cvt_pk_bf16_f32 v99, v102, v103
    v_mfma_f32_16x16x32_bf16 v[104:107], v[36:39], v[200:203], v[104:107]
    ds_read_b64_tr_b16 v[28:29], v9 offset:18624
    v_mfma_f32_16x16x32_bf16 v[108:111], v[36:39], v[204:207], v[108:111]
    s_waitcnt lgkmcnt(5)
    ds_read_b64_tr_b16 v[30:31], v9 offset:20928
    buffer_store_dwordx4 v[96:99], v7, s[20:23], s50 offen offset:0 sc1
    v_mfma_f32_16x16x16_bf16 v[104:107], v[16:17], v[208:209], v[104:107]
    ds_read_b64_tr_b16 v[32:33], v9 offset:27840
    v_mfma_f32_16x16x16_bf16 v[108:111], v[16:17], v[210:211], v[108:111]
    s_waitcnt lgkmcnt(5)
    ds_read_b64_tr_b16 v[34:35], v9 offset:30144
    v_mfma_f32_16x16x32_bf16 v[112:115], v[20:23], v[176:179], v[112:115]
    ds_read_b64_tr_b16 v[36:37], v15 offset:192
    v_mfma_f32_16x16x32_bf16 v[116:119], v[20:23], v[180:183], v[116:119]
    s_waitcnt lgkmcnt(5)
    v_mfma_f32_16x16x32_bf16 v[112:115], v[24:27], v[184:187], v[112:115]
    ds_read_b64_tr_b16 v[16:17], v9 offset:224
    v_mfma_f32_16x16x32_bf16 v[116:119], v[24:27], v[188:191], v[116:119]
    s_waitcnt lgkmcnt(4)
    ds_read_b64_tr_b16 v[18:19], v9 offset:2528
    v_cvt_pk_bf16_f32 v100, v104, v105
    v_cvt_pk_bf16_f32 v101, v106, v107
    v_mfma_f32_16x16x32_bf16 v[112:115], v[28:31], v[192:195], v[112:115]
    ds_read_b64_tr_b16 v[20:21], v9 offset:9440
    v_mfma_f32_16x16x32_bf16 v[116:119], v[28:31], v[196:199], v[116:119]
    s_waitcnt lgkmcnt(4)
    ds_read_b64_tr_b16 v[22:23], v9 offset:11744
    v_cvt_pk_bf16_f32 v102, v108, v109
    v_cvt_pk_bf16_f32 v103, v110, v111
    v_mfma_f32_16x16x32_bf16 v[112:115], v[32:35], v[200:203], v[112:115]
    ds_read_b64_tr_b16 v[24:25], v9 offset:18656
    v_mfma_f32_16x16x32_bf16 v[116:119], v[32:35], v[204:207], v[116:119]
    s_waitcnt lgkmcnt(5)
    ds_read_b64_tr_b16 v[26:27], v9 offset:20960
    buffer_store_dwordx4 v[100:103], v7, s[20:23], s50 offen offset:1024 sc1
    v_mfma_f32_16x16x16_bf16 v[112:115], v[36:37], v[208:209], v[112:115]
    ds_read_b64_tr_b16 v[28:29], v9 offset:27872
    v_mfma_f32_16x16x16_bf16 v[116:119], v[36:37], v[210:211], v[116:119]
    s_waitcnt lgkmcnt(5)
    ds_read_b64_tr_b16 v[30:31], v9 offset:30176
    v_mfma_f32_16x16x32_bf16 v[120:123], v[16:19], v[176:179], v[120:123]
    ds_read_b64_tr_b16 v[32:33], v15 offset:224
    v_mfma_f32_16x16x32_bf16 v[124:127], v[16:19], v[180:183], v[124:127]
    s_waitcnt lgkmcnt(5)
    v_mfma_f32_16x16x32_bf16 v[120:123], v[20:23], v[184:187], v[120:123]
    ds_read_b64_tr_b16 v[36:37], v9 offset:0
    v_mfma_f32_16x16x32_bf16 v[124:127], v[20:23], v[188:191], v[124:127]
    s_waitcnt lgkmcnt(4)
    ds_read_b64_tr_b16 v[38:39], v9 offset:2304
    v_cvt_pk_bf16_f32 v112, v112, v113
    v_cvt_pk_bf16_f32 v113, v114, v115
    v_mfma_f32_16x16x32_bf16 v[120:123], v[24:27], v[192:195], v[120:123]
    ds_read_b64_tr_b16 v[16:17], v9 offset:32
    v_mfma_f32_16x16x32_bf16 v[124:127], v[24:27], v[196:199], v[124:127]
    s_waitcnt lgkmcnt(4)
    ds_read_b64_tr_b16 v[18:19], v9 offset:2336
    v_cvt_pk_bf16_f32 v114, v116, v117
    v_cvt_pk_bf16_f32 v115, v118, v119
    v_mfma_f32_16x16x32_bf16 v[120:123], v[28:31], v[200:203], v[120:123]
    ds_read_b64_tr_b16 v[20:21], v9 offset:9216
    v_mfma_f32_16x16x32_bf16 v[124:127], v[28:31], v[204:207], v[124:127]
    s_waitcnt lgkmcnt(5)
    ds_read_b64_tr_b16 v[22:23], v9 offset:11520
    buffer_store_dwordx4 v[112:115], v7, s[20:23], s51 offen offset:0 sc1
    v_mfma_f32_16x16x16_bf16 v[120:123], v[32:33], v[208:209], v[120:123]
    ds_read_b64_tr_b16 v[24:25], v9 offset:9248
    v_mfma_f32_16x16x16_bf16 v[124:127], v[32:33], v[210:211], v[124:127]
    s_waitcnt lgkmcnt(5)
    ds_read_b64_tr_b16 v[26:27], v9 offset:11552
    v_mfma_f32_16x16x32_bf16 v[64:67], v[36:39], v[176:179], v[64:67]
    ds_read_b64_tr_b16 v[28:29], v9 offset:18432
    v_mfma_f32_16x16x32_bf16 v[68:71], v[36:39], v[180:183], v[68:71]
    s_waitcnt lgkmcnt(5)
    ds_read_b64_tr_b16 v[30:31], v9 offset:20736
    v_mfma_f32_16x16x32_bf16 v[72:75], v[16:19], v[176:179], v[72:75]
    ds_read_b64_tr_b16 v[32:33], v9 offset:18464
    v_mfma_f32_16x16x32_bf16 v[76:79], v[16:19], v[180:183], v[76:79]
    s_waitcnt lgkmcnt(5)
    ds_read_b64_tr_b16 v[34:35], v9 offset:20768
    v_cvt_pk_bf16_f32 v116, v120, v121
    v_cvt_pk_bf16_f32 v117, v122, v123
    v_mfma_f32_16x16x32_bf16 v[64:67], v[20:23], v[184:187], v[64:67]
    ds_read_b64_tr_b16 v[36:37], v9 offset:27648
    v_mfma_f32_16x16x32_bf16 v[68:71], v[20:23], v[188:191], v[68:71]
    s_waitcnt lgkmcnt(5)
    ds_read_b64_tr_b16 v[38:39], v9 offset:29952
    v_cvt_pk_bf16_f32 v118, v124, v125
    v_cvt_pk_bf16_f32 v119, v126, v127
    v_mfma_f32_16x16x32_bf16 v[72:75], v[24:27], v[184:187], v[72:75]
    ds_read_b64_tr_b16 v[16:17], v9 offset:27680
    v_mfma_f32_16x16x32_bf16 v[76:79], v[24:27], v[188:191], v[76:79]
    s_waitcnt lgkmcnt(5)
    ds_read_b64_tr_b16 v[18:19], v9 offset:29984
    buffer_store_dwordx4 v[116:119], v7, s[20:23], s51 offen offset:1024 sc1
    v_mfma_f32_16x16x32_bf16 v[64:67], v[28:31], v[192:195], v[64:67]
    ds_read_b64_tr_b16 v[20:21], v15 offset:0
    v_mfma_f32_16x16x32_bf16 v[68:71], v[28:31], v[196:199], v[68:71]
    s_waitcnt lgkmcnt(5)
    v_mfma_f32_16x16x32_bf16 v[72:75], v[32:35], v[192:195], v[72:75]
    ds_read_b64_tr_b16 v[24:25], v15 offset:32
    v_mfma_f32_16x16x32_bf16 v[76:79], v[32:35], v[196:199], v[76:79]
    s_waitcnt lgkmcnt(4)
    v_mfma_f32_16x16x32_bf16 v[64:67], v[36:39], v[200:203], v[64:67]
    v_mfma_f32_16x16x32_bf16 v[68:71], v[36:39], v[204:207], v[68:71]
    s_waitcnt lgkmcnt(2)
    v_mfma_f32_16x16x32_bf16 v[72:75], v[16:19], v[200:203], v[72:75]
    v_mfma_f32_16x16x32_bf16 v[76:79], v[16:19], v[204:207], v[76:79]
    s_waitcnt lgkmcnt(1)
    v_mfma_f32_16x16x16_bf16 v[64:67], v[20:21], v[208:209], v[64:67]
    v_mfma_f32_16x16x16_bf16 v[68:71], v[20:21], v[210:211], v[68:71]
    s_waitcnt lgkmcnt(0)
    v_mfma_f32_16x16x16_bf16 v[72:75], v[24:25], v[208:209], v[72:75]
    v_mfma_f32_16x16x16_bf16 v[76:79], v[24:25], v[210:211], v[76:79]
    s_mov_b64 s[44:45], 14
    s_waitcnt vmcnt(0)
    buffer_store_dword v62, v58, s[20:23], s37 offen sc1
    s_mov_b32 s47, 0
K2_GP2:
    buffer_load_dword v60, v13, s[20:23], s39 offen sc1
    s_add_u32 s47, s47, 1
    s_waitcnt vmcnt(0)
    v_cmp_ne_u32 vcc, s101, v60
    s_cmp_ge_u32 s47, 0x40000
    s_cbranch_scc1 K2_GP2_D
    s_and_b64 vcc, vcc, s[44:45]
    s_cbranch_scc0 K2_GP2_D
    s_sleep 2
    s_branch K2_GP2
K2_GP2_D:
    buffer_load_dwordx4 v[80:83], v7, s[20:23], s48 offen sc1
    buffer_load_dwordx4 v[84:87], v7, s[20:23], s48 offen offset:1024 sc1
    buffer_load_dwordx4 v[88:91], v248, s[20:23], s48 offen offset:2048 sc1
    s_add_u32 s48, s48, 2304
    buffer_load_dwordx4 v[92:95], v7, s[20:23], s48 offen sc1
    buffer_load_dwordx4 v[96:99], v7, s[20:23], s48 offen offset:1024 sc1
    buffer_load_dwordx4 v[100:103], v248, s[20:23], s48 offen offset:2048 sc1
    s_add_u32 s48, s48, 2304
    buffer_load_dwordx4 v[104:107], v7, s[20:23], s48 offen sc1
    buffer_load_dwordx4 v[108:111], v7, s[20:23], s48 offen offset:1024 sc1
    buffer_load_dwordx4 v[112:115], v248, s[20:23], s48 offen offset:2048 sc1
    s_waitcnt vmcnt(6)
    s_nop 0
    v_dot2_f32_bf16 v64, v80, v56, v64
    v_dot2_f32_bf16 v65, v80, v57, v65
    v_dot2_f32_bf16 v66, v81, v56, v66
    v_dot2_f32_bf16 v67, v81, v57, v67
    v_dot2_f32_bf16 v68, v82, v56, v68
    v_dot2_f32_bf16 v69, v82, v57, v69
    v_dot2_f32_bf16 v70, v83, v56, v70
    v_dot2_f32_bf16 v71, v83, v57, v71
    v_dot2_f32_bf16 v72, v84, v56, v72
    v_dot2_f32_bf16 v73, v84, v57, v73
    v_dot2_f32_bf16 v74, v85, v56, v74
    v_dot2_f32_bf16 v75, v85, v57, v75
    v_dot2_f32_bf16 v76, v86, v56, v76
    v_dot2_f32_bf16 v77, v86, v57, v77
    v_dot2_f32_bf16 v78, v87, v56, v78
    v_dot2_f32_bf16 v79, v87, v57, v79
    v_dot2_f32_bf16 v128, v88, v56, v128
    v_dot2_f32_bf16 v129, v88, v57, v129
    v_dot2_f32_bf16 v130, v89, v56, v130
    v_dot2_f32_bf16 v131, v89, v57, v131
    v_dot2_f32_bf16 v132, v90, v56, v132
    v_dot2_f32_bf16 v133, v90, v57, v133
    v_dot2_f32_bf16 v134, v91, v56, v134
    v_dot2_f32_bf16 v135, v91, v57, v135
    s_waitcnt vmcnt(3)
    s_nop 0
    v_dot2_f32_bf16 v64, v92, v56, v64
    v_dot2_f32_bf16 v65, v92, v57, v65
    v_dot2_f32_bf16 v66, v93, v56, v66
    v_dot2_f32_bf16 v67, v93, v57, v67
    v_dot2_f32_bf16 v68, v94, v56, v68
    v_dot2_f32_bf16 v69, v94, v57, v69
    v_dot2_f32_bf16 v70, v95, v56, v70
    v_dot2_f32_bf16 v71, v95, v57, v71
    v_dot2_f32_bf16 v72, v96, v56, v72
    v_dot2_f32_bf16 v73, v96, v57, v73
    v_dot2_f32_bf16 v74, v97, v56, v74
    v_dot2_f32_bf16 v75, v97, v57, v75
    v_dot2_f32_bf16 v76, v98, v56, v76
    v_dot2_f32_bf16 v77, v98, v57, v77
    v_dot2_f32_bf16 v78, v99, v56, v78
    v_dot2_f32_bf16 v79, v99, v57, v79
    v_dot2_f32_bf16 v128, v100, v56, v128
    v_dot2_f32_bf16 v129, v100, v57, v129
    v_dot2_f32_bf16 v130, v101, v56, v130
    v_dot2_f32_bf16 v131, v101, v57, v131
    v_dot2_f32_bf16 v132, v102, v56, v132
    v_dot2_f32_bf16 v133, v102, v57, v133
    v_dot2_f32_bf16 v134, v103, v56, v134
    v_dot2_f32_bf16 v135, v103, v57, v135
    s_waitcnt vmcnt(0)
    s_nop 0
    v_dot2_f32_bf16 v64, v104, v56, v64
    v_dot2_f32_bf16 v65, v104, v57, v65
    v_dot2_f32_bf16 v66, v105, v56, v66
    v_dot2_f32_bf16 v67, v105, v57, v67
    v_dot2_f32_bf16 v68, v106, v56, v68
    v_dot2_f32_bf16 v69, v106, v57, v69
    v_dot2_f32_bf16 v70, v107, v56, v70
    v_dot2_f32_bf16 v71, v107, v57, v71
    v_dot2_f32_bf16 v72, v108, v56, v72
    v_dot2_f32_bf16 v73, v108, v57, v73
    v_dot2_f32_bf16 v74, v109, v56, v74
    v_dot2_f32_bf16 v75, v109, v57, v75
    v_dot2_f32_bf16 v76, v110, v56, v76
    v_dot2_f32_bf16 v77, v110, v57, v77
    v_dot2_f32_bf16 v78, v111, v56, v78
    v_dot2_f32_bf16 v79, v111, v57, v79
    v_dot2_f32_bf16 v128, v112, v56, v128
    v_dot2_f32_bf16 v129, v112, v57, v129
    v_dot2_f32_bf16 v130, v113, v56, v130
    v_dot2_f32_bf16 v131, v113, v57, v131
    v_dot2_f32_bf16 v132, v114, v56, v132
    v_dot2_f32_bf16 v133, v114, v57, v133
    v_dot2_f32_bf16 v134, v115, v56, v134
    v_dot2_f32_bf16 v135, v115, v57, v135
    s_nop 0
    s_nop 0
    v_fma_f32 v64, v64, v252, v224
    v_fma_f32 v65, v65, v252, v225
    v_fma_f32 v66, v66, v252, v226
    v_fma_f32 v67, v67, v252, v227
    v_fma_f32 v68, v68, v253, v228
    v_fma_f32 v69, v69, v253, v229
    v_fma_f32 v70, v70, v253, v230
    v_fma_f32 v71, v71, v253, v231
    v_fma_f32 v72, v72, v252, v232
    v_fma_f32 v73, v73, v252, v233
    v_fma_f32 v74, v74, v252, v234
    v_fma_f32 v75, v75, v252, v235
    v_fma_f32 v76, v76, v253, v236
    v_fma_f32 v77, v77, v253, v237
    v_fma_f32 v78, v78, v253, v238
    v_fma_f32 v79, v79, v253, v239
    v_fma_f32 v128, v128, v252, v240
    v_fma_f32 v129, v129, v252, v241
    v_fma_f32 v130, v130, v252, v242
    v_fma_f32 v131, v131, v252, v243
    v_fma_f32 v132, v132, v253, v244
    v_fma_f32 v133, v133, v253, v245
    v_fma_f32 v134, v134, v253, v246
    v_fma_f32 v135, v135, v253, v247
    v_cvt_pk_bf16_f32 v64, v64, v65
    v_cvt_pk_bf16_f32 v65, v66, v67
    v_cvt_pk_bf16_f32 v66, v68, v69
    v_cvt_pk_bf16_f32 v67, v70, v71
    v_cvt_pk_bf16_f32 v68, v72, v73
    v_cvt_pk_bf16_f32 v69, v74, v75
    v_cvt_pk_bf16_f32 v70, v76, v77
    v_cvt_pk_bf16_f32 v71, v78, v79
    v_cvt_pk_bf16_f32 v128, v128, v129
    v_cvt_pk_bf16_f32 v129, v130, v131
    v_cvt_pk_bf16_f32 v130, v132, v133
    v_cvt_pk_bf16_f32 v131, v134, v135
    v_permlane16_swap_b32 v64, v66
    v_permlane16_swap_b32 v65, v67
    v_permlane16_swap_b32 v68, v70
    v_permlane16_swap_b32 v69, v71
    buffer_store_dwordx4 v[64:67], v220, s[64:67], s54 offen offset:0
    buffer_store_dwordx4 v[68:71], v220, s[64:67], s54 offen offset:32
    buffer_store_dwordx2 v[128:129], v249, s[64:67], s56 offen
    buffer_store_dwordx2 v[130:131], v249, s[64:67], s35 offen
    s_endpgm
K_LOAD:
    s_load_dwordx2 s[44:45], s[0:1], 48
    s_sub_u32 s24, s24, 4
    s_mov_b32 s46, 5308416
    s_mov_b32 s47, 0x00020000
    v_mov_b32 v24, 0x7ffffff0
    s_mov_b32 s101, 0
    s_mov_b32 s70, s31
    s_lshr_b32 s32, s26, 1
    s_and_b32 s33, s26, 1
    s_mul_i32 s29, s32, 9
    s_mul_i32 s34, s33, 5
    s_add_u32 s29, s29, s34
    s_sub_u32 s30, 5, s33
    s_min_u32 s34, s32, 3
    s_mul_i32 s28, s32, 3
    s_add_u32 s28, s28, s34
    s_add_u32 s28, s28, s33
    s_cmp_lt_u32 s32, 3
    s_cselect_b32 s34, 3, 2
    s_cmp_eq_u32 s33, 1
    s_cselect_b32 s27, s34, 1
    v_lshrrev_b32 v8, 3, v0
    s_lshl_b32 s33, s24, 3
    v_add_u32 v8, s33, v8
    s_and_b32 s33, s24, 1
    s_lshl_b32 s33, s33, 2
    v_bfe_u32 v9, v0, 4, 1
    v_lshl_or_b32 v9, v9, 1, s33
    v_and_b32 v10, 7, v0
    v_xor_b32 v10, v10, v9
    v_mul_u32_u24 v224, 3456, v8
    v_lshl_add_u32 v224, v10, 4, v224
    v_mul_u32_u24 v225, 9216, v8
    v_lshl_add_u32 v225, v10, 4, v225
    s_and_b32 s32, s27, 1
    s_mul_i32 s71, s32, 73728
    s_lshl_b32 s33, s24, 10
    s_add_u32 s71, s71, s33
    s_add_u32 s75, s33, 147456
    s_mov_b32 s66, 1
    s_mov_b32 s67, 1
    s_mov_b32 s43, 1
    s_lshl_b32 s42, s30, 1
    s_add_u32 s42, s42, s27
    s_mul_i32 s73, s42, 3
    s_sub_u32 s73, s73, 6
    s_mul_i32 s57, s27, 3
    s_add_u32 s57, s57, 10
    s_mov_b32 s19, 0x00020000
    s_mov_b32 s63, 0x00020000
    s_lshl_b32 s64, s28, 7
    s_mov_b32 s65, 110592
    s_mov_b32 s62, 1990656
    s_waitcnt lgkmcnt(0)
    s_mov_b32 s12, s50
    s_mov_b32 s13, s51
    s_mov_b32 s50, s27
    s_mov_b32 s51, s29
    s_mov_b32 s60, s6
    s_mov_b32 s61, s7
    s_mov_b32 s20, s12
    s_mov_b32 s21, s13
    s_mov_b32 s22, 58720256
    s_mov_b32 s23, 0x00020000
    s_or_b32 s33, s15, s24
    s_cmp_lg_u32 s33, 0
    s_cbranch_scc1 KA_NE
    v_mov_b32 v8, 55844864
    buffer_load_dword v230, v8, s[20:23], 0 offen sc1
KA_NE:
    s_mov_b32 s16, s60
    s_mov_b32 s17, s61
    s_mov_b32 s18, s62
    s_mov_b32 s72, s64
    s_mov_b32 s69, s65
    s_lshl_b32 s74, s69, 1
    v_mov_b32 v226, v224
    s_add_u32 s64, s64, 128
    s_cmp_gt_u32 s50, 1
    s_cbranch_scc1 KL_F1
    s_mov_b32 s60, s8
    s_mov_b32 s61, s9
    s_lshl_b32 s64, s51, 7
    s_mov_b32 s65, 294912
    v_mov_b32 v227, v228
    s_mov_b32 s62, 5308416
KL_F1:
    s_load_dwordx2 s[4:5], s[0:1], 16
    v_and_b32 v2, 31, v0
    v_lshrrev_b32 v3, 5, v0
    v_bfe_u32 v4, v0, 2, 2
    v_and_b32 v5, 3, v0
    v_bfe_u32 v6, v0, 4, 1
    s_and_b32 s25, s3, 3
    s_and_b32 s26, s14, 3
    s_lshl_b32 s33, s24, 6
    s_lshl_b32 s34, s26, 4
    s_lshl_b32 s35, s25, 2
    s_lshl_b32 s32, s26, 1
    s_add_u32 s32, s32, 48
    v_add_u32 v8, s33, v0
    v_mul_u32_u24 v9, 3641, v8
    v_lshrrev_b32 v9, 16, v9
    v_mul_u32_u24 v10, 18, v9
    v_sub_u32 v10, v8, v10
    v_cmp_lt_u32 vcc, 15, v10
    v_add_u32 v12, s32, v10
    v_add_u32 v13, s35, v10
    v_and_or_b32 v13, v13, 15, s34
    v_cndmask_b32 v13, v13, v12, vcc
    v_mul_u32_u24 v11, 1152, v9
    v_lshl_add_u32 v232, v13, 4, v11
    v_add_u32 v11, 16, v9
    v_lshrrev_b32 v11, 5, v11
    v_mul_u32_u24 v11, 4608, v11
    v_add_u32 v237, v232, v11
    v_cmp_gt_u32 vcc, 16, v9
    v_lshrrev_b32 v11, 2, v9
    v_mul_u32_u24 v11, 36864, v11
    v_add_u32 v11, v232, v11
    v_mov_b32 v12, 0x7ffffff0
    v_cndmask_b32 v242, v12, v11, vcc
    v_add_u32 v8, s33, v0
    v_add_u32 v8, 256, v8
    v_mul_u32_u24 v9, 3641, v8
    v_lshrrev_b32 v9, 16, v9
    v_mul_u32_u24 v10, 18, v9
    v_sub_u32 v10, v8, v10
    v_cmp_lt_u32 vcc, 15, v10
    v_add_u32 v12, s32, v10
    v_add_u32 v13, s35, v10
    v_and_or_b32 v13, v13, 15, s34
    v_cndmask_b32 v13, v13, v12, vcc
    v_mul_u32_u24 v11, 1152, v9
    v_lshl_add_u32 v233, v13, 4, v11
    v_add_u32 v11, 16, v9
    v_lshrrev_b32 v11, 5, v11
    v_mul_u32_u24 v11, 4608, v11
    v_add_u32 v238, v233, v11
    v_cmp_gt_u32 vcc, 16, v9
    v_lshrrev_b32 v11, 2, v9
    v_mul_u32_u24 v11, 36864, v11
    v_add_u32 v11, v233, v11
    v_mov_b32 v12, 0x7ffffff0
    v_cndmask_b32 v243, v12, v11, vcc
    v_add_u32 v8, s33, v0
    v_add_u32 v8, 512, v8
    v_mul_u32_u24 v9, 3641, v8
    v_lshrrev_b32 v9, 16, v9
    v_mul_u32_u24 v10, 18, v9
    v_sub_u32 v10, v8, v10
    v_cmp_lt_u32 vcc, 15, v10
    v_add_u32 v12, s32, v10
    v_add_u32 v13, s35, v10
    v_and_or_b32 v13, v13, 15, s34
    v_cndmask_b32 v13, v13, v12, vcc
    v_mul_u32_u24 v11, 1152, v9
    v_lshl_add_u32 v234, v13, 4, v11
    v_add_u32 v11, 16, v9
    v_lshrrev_b32 v11, 5, v11
    v_mul_u32_u24 v11, 4608, v11
    v_add_u32 v239, v234, v11
    v_add_u32 v8, s33, v0
    v_add_u32 v8, 768, v8
    v_mul_u32_u24 v9, 3641, v8
    v_lshrrev_b32 v9, 16, v9
    v_mul_u32_u24 v10, 18, v9
    v_sub_u32 v10, v8, v10
    v_cmp_lt_u32 vcc, 15, v10
    v_add_u32 v12, s32, v10
    v_add_u32 v13, s35, v10
    v_and_or_b32 v13, v13, 15, s34
    v_cndmask_b32 v13, v13, v12, vcc
    v_mul_u32_u24 v11, 1152, v9
    v_lshl_add_u32 v235, v13, 4, v11
    v_add_u32 v11, 16, v9
    v_lshrrev_b32 v11, 5, v11
    v_mul_u32_u24 v11, 4608, v11
    v_add_u32 v240, v235, v11
    v_add_u32 v8, s33, v0
    v_add_u32 v8, 1024, v8
    v_mul_u32_u24 v9, 3641, v8
    v_lshrrev_b32 v9, 16, v9
    v_mul_u32_u24 v10, 18, v9
    v_sub_u32 v10, v8, v10
    v_cmp_lt_u32 vcc, 15, v10
    v_add_u32 v12, s32, v10
    v_add_u32 v13, s35, v10
    v_and_or_b32 v13, v13, 15, s34
    v_cndmask_b32 v13, v13, v12, vcc
    v_mul_u32_u24 v11, 1152, v9
    v_lshl_add_u32 v236, v13, 4, v11
    v_add_u32 v11, 16, v9
    v_lshrrev_b32 v11, 5, v11
    v_mul_u32_u24 v11, 4608, v11
    v_add_u32 v241, v236, v11
    v_mov_b32 v9, 0x7ffffff0
    s_cmp_lt_u32 s24, 2
    s_cselect_b64 vcc, -1, 0
    v_cndmask_b32 v236, v9, v236, vcc
    v_cndmask_b32 v241, v9, v241, vcc
    s_mul_i32 s33, s24, 3072
    s_add_u32 s33, s33, 150016
    v_lshl_add_u32 v8, v0, 4, s33
    ds_write_b128 v8, v[232:235] offset:0
    ds_write_b128 v8, v[236:239] offset:1024
    ds_write_b128 v8, v[240:243] offset:2048
    s_lshl_b32 s53, s3, 2
    s_and_b32 s33, s14, 3
    s_add_u32 s53, s53, s33
    s_and_b32 s25, s53, 1
    s_lshr_b32 s33, s53, 1
    s_mul_i32 s27, s33, 9
    s_lshl_b32 s33, s25, 2
    s_add_u32 s27, s27, s33
    s_lshr_b32 s54, s14, 2
    s_lshl_b32 s26, s54, 3
    s_and_b32 s33, s24, 1
    s_lshl_b32 s33, s33, 2
    s_add_u32 s26, s26, s33
    s_lshr_b32 s52, s24, 1
    s_and_b32 s33, s27, 1
    s_add_u32 s59, s33, s25
    s_xor_b32 s34, s25, 1
    s_lshl_b32 s34, s34, 10
    s_lshl_b32 s33, s33, 3
    s_add_u32 s34, s34, s33
    s_lshr_b32 s27, s27, 1
    s_lshl_b32 s27, s27, 9
    s_lshl_b32 s33, s24, 6
    s_mov_b32 s35, 110592
    v_add_u32 v14, s33, v0
    v_lshrrev_b32 v15, 5, v14
    v_mul_u32_u24 v15, 43, v15
    v_lshrrev_b32 v15, 7, v15
    v_mul_u32_u24 v56, 96, v15
    v_sub_u32 v56, v14, v56
    v_lshrrev_b32 v57, 1, v15
    v_mul_lo_u32 v57, v57, s35
    v_and_b32 v15, 1, v15
    v_mul_u32_u24 v15, 36864, v15
    v_lshl_add_u32 v16, v56, 4, v57
    v_add_u32 v16, v16, v15
    v_add_u32 v14, s33, v0
    v_add_u32 v14, 256, v14
    v_lshrrev_b32 v15, 5, v14
    v_mul_u32_u24 v15, 43, v15
    v_lshrrev_b32 v15, 7, v15
    v_mul_u32_u24 v56, 96, v15
    v_sub_u32 v56, v14, v56
    v_lshrrev_b32 v57, 1, v15
    v_mul_lo_u32 v57, v57, s35
    v_and_b32 v15, 1, v15
    v_mul_u32_u24 v15, 36864, v15
    v_lshl_add_u32 v17, v56, 4, v57
    v_add_u32 v17, v17, v15
    v_add_u32 v14, s33, v0
    v_add_u32 v14, 512, v14
    v_lshrrev_b32 v15, 5, v14
    v_mul_u32_u24 v15, 43, v15
    v_lshrrev_b32 v15, 7, v15
    v_mul_u32_u24 v56, 96, v15
    v_sub_u32 v56, v14, v56
    v_lshrrev_b32 v57, 1, v15
    v_mul_lo_u32 v57, v57, s35
    v_and_b32 v15, 1, v15
    v_mul_u32_u24 v15, 36864, v15
    v_lshl_add_u32 v18, v56, 4, v57
    v_add_u32 v18, v18, v15
    v_add_u32 v14, s33, v0
    v_add_u32 v14, 768, v14
    v_lshrrev_b32 v15, 5, v14
    v_mul_u32_u24 v15, 43, v15
    v_lshrrev_b32 v15, 7, v15
    v_mul_u32_u24 v56, 96, v15
    v_sub_u32 v56, v14, v56
    v_lshrrev_b32 v57, 1, v15
    v_mul_lo_u32 v57, v57, s35
    v_and_b32 v15, 1, v15
    v_mul_u32_u24 v15, 36864, v15
    v_lshl_add_u32 v19, v56, 4, v57
    v_add_u32 v19, v19, v15
    v_add_u32 v14, s33, v0
    v_add_u32 v14, 1024, v14
    v_lshrrev_b32 v15, 5, v14
    v_mul_u32_u24 v15, 43, v15
    v_lshrrev_b32 v15, 7, v15
    v_mul_u32_u24 v56, 96, v15
    v_sub_u32 v56, v14, v56
    v_lshrrev_b32 v57, 1, v15
    v_mul_lo_u32 v57, v57, s35
    v_and_b32 v15, 1, v15
    v_mul_u32_u24 v15, 36864, v15
    v_lshl_add_u32 v20, v56, 4, v57
    v_add_u32 v20, v20, v15
    v_add_u32 v14, s33, v0
    v_add_u32 v14, 1280, v14
    v_lshrrev_b32 v15, 5, v14
    v_mul_u32_u24 v15, 43, v15
    v_lshrrev_b32 v15, 7, v15
    v_mul_u32_u24 v56, 96, v15
    v_sub_u32 v56, v14, v56
    v_lshrrev_b32 v57, 1, v15
    v_mul_lo_u32 v57, v57, s35
    v_and_b32 v15, 1, v15
    v_mul_u32_u24 v15, 36864, v15
    v_lshl_add_u32 v21, v56, 4, v57
    v_add_u32 v21, v21, v15
    s_mov_b32 s28, s27
    s_lshl_b32 s33, s52, 1
    s_add_u32 s32, s26, s33
    s_xor_b32 s33, s33, 2
    s_add_u32 s33, s26, s33
    s_mov_b32 s26, s32
    s_mul_i32 s36, s32, 110592
    s_add_u32 s36, s36, s28
    s_add_u32 s37, s36, 110592
    s_mul_i32 s38, s33, 110592
    s_add_u32 s38, s38, s28
    s_add_u32 s39, s38, 110592
    s_add_u32 s28, s28, 36864
    s_lshl_b32 s55, s24, 10
    s_add_u32 s55, s55, 73728
    v_add_u32 v14, s59, v3
    v_and_b32 v15, 1, v14
    v_lshrrev_b32 v14, 1, v14
    v_lshlrev_b32 v14, 9, v14
    v_lshl_add_u32 v14, v15, 3, v14
    v_lshl_add_u32 v8, v2, 4, v14
    s_lshl_b32 s33, s25, 2
    s_add_u32 s33, s33, s34
    v_lshl_add_u32 v9, v2, 4, s33
    v_add_u32 v14, s59, v5
    v_and_b32 v15, 1, v14
    v_lshrrev_b32 v14, 1, v14
    v_lshlrev_b32 v14, 9, v14
    v_lshl_add_u32 v14, v15, 3, v14
    v_mov_b32 v15, s34
    v_cmp_eq_u32 vcc, 0, v6
    s_mul_i32 s32, s52, 3072
    s_add_u32 s33, s32, 75264
    v_cndmask_b32 v14, v15, v14, vcc
    v_lshl_add_u32 v15, v3, 3, v4
    v_lshl_add_u32 v14, v15, 4, v14
    v_add_u32 v14, s33, v14
    v_mul_u32_u24 v15, v5, v6
    v_cmp_eq_u32 vcc, 0, v15
    v_mov_b32 v56, 149504
    v_mov_b32 v57, 6144
    v_bfe_u32 v10, v5, 1, 1
    v_xor_b32 v10, 1, v10
    v_lshl_add_u32 v56, v10, 3, v56
    v_cndmask_b32 v10, v56, v14, vcc
    v_cndmask_b32 v11, 0, v57, vcc
    v_cndmask_b32 v12, 0, -1, vcc
    v_mov_b32 v14, 0x3f803f80
    v_lshlrev_b32 v15, 2, v0
    v_add_u32 v15, 149504, v15
    v_cmp_eq_u32 vcc, 0, v5
    v_mov_b32 v14, 0x3f80
    s_nop 0
    v_cndmask_b32 v14, 0, v14, vcc
    ds_write_b32 v15, v14
    ds_write_b32 v15, v14 offset:256
    v_mov_b32 v13, 0xdddddddd
    v_mov_b32 v37, 0x3f803f80
    v_mov_b32 v39, 0x3f803f80
    v_mov_b32 v209, 0
    v_mov_b32 v128, 0
    v_mov_b32 v129, 0
    v_mov_b32 v130, 0
    v_mov_b32 v131, 0
    v_mov_b32 v132, 0
    v_mov_b32 v133, 0
    v_mov_b32 v134, 0
    v_mov_b32 v135, 0
    v_mov_b32 v136, 0
    v_mov_b32 v137, 0
    v_mov_b32 v138, 0
    v_mov_b32 v139, 0
    v_mov_b32 v140, 0
    v_mov_b32 v141, 0
    v_mov_b32 v142, 0
    v_mov_b32 v143, 0
    v_mov_b32 v211, 0
    v_mov_b32 v144, 0
    v_mov_b32 v145, 0
    v_mov_b32 v146, 0
    v_mov_b32 v147, 0
    v_mov_b32 v148, 0
    v_mov_b32 v149, 0
    v_mov_b32 v150, 0
    v_mov_b32 v151, 0
    v_mov_b32 v152, 0
    v_mov_b32 v153, 0
    v_mov_b32 v154, 0
    v_mov_b32 v155, 0
    v_mov_b32 v156, 0
    v_mov_b32 v157, 0
    v_mov_b32 v158, 0
    v_mov_b32 v159, 0
    v_mov_b32 v213, 0
    v_mov_b32 v160, 0
    v_mov_b32 v161, 0
    v_mov_b32 v162, 0
    v_mov_b32 v163, 0
    v_mov_b32 v164, 0
    v_mov_b32 v165, 0
    v_mov_b32 v166, 0
    v_mov_b32 v167, 0
    v_mov_b32 v168, 0
    v_mov_b32 v169, 0
    v_mov_b32 v170, 0
    v_mov_b32 v171, 0
    v_mov_b32 v172, 0
    v_mov_b32 v173, 0
    v_mov_b32 v174, 0
    v_mov_b32 v175, 0
    v_mov_b32 v215, 0
    v_mov_b32 v176, 0
    v_mov_b32 v177, 0
    v_mov_b32 v178, 0
    v_mov_b32 v179, 0
    v_mov_b32 v180, 0
    v_mov_b32 v181, 0
    v_mov_b32 v182, 0
    v_mov_b32 v183, 0
    v_mov_b32 v184, 0
    v_mov_b32 v185, 0
    v_mov_b32 v186, 0
    v_mov_b32 v187, 0
    v_mov_b32 v188, 0
    v_mov_b32 v189, 0
    v_mov_b32 v190, 0
    v_mov_b32 v191, 0
    v_mov_b32 v48, 0
    v_mov_b32 v49, 0
    v_mov_b32 v50, 0
    v_mov_b32 v51, 0
    v_mov_b32 v52, 0
    v_mov_b32 v53, 0
    v_mov_b32 v54, 0
    v_mov_b32 v55, 0
    v_cmp_eq_u32 s[40:41], 0, v3
    v_mov_b32 v65, 0
    v_mov_b32 v64, 0
    s_waitcnt lgkmcnt(0)
    s_mov_b32 s46, 5308416
    s_mov_b32 s47, 0x00020000
    s_lshr_b32 s29, s14, 2
    s_lshl_b32 s29, s29, 2
    s_add_u32 s29, s29, s24
    s_mul_i32 s29, s29, 18
    v_lshlrev_b32 v24, 7, v0
    v_mov_b32 v27, 0x7ffffff0
    v_cmp_gt_u32 vcc, 12, v0
    s_and_b32 s32, s3, 3
    s_mul_i32 s58, s32, 1327104
    s_mul_i32 s35, s14, 41472
    s_add_u32 s58, s58, s35
    v_cndmask_b32 v24, v27, v24, vcc
    s_mul_i32 s35, s24, 10368
    s_add_u32 s58, s58, s35
    s_or_b32 s33, s15, s24
    s_cmp_lg_u32 s33, 0
    s_cbranch_scc1 KA_NT
    v_mov_b32 v14, 0
    s_mov_b32 s33, 55844864
    s_mov_b32 s35, 1664525
    s_mov_b64 exec, 1
    s_waitcnt vmcnt(0)
    v_mul_lo_u32 v15, v230, s35
    v_add_u32 v15, 1013904223, v15
    v_max_u32 v15, 1, v15
    global_store_dword v14, v15, s[48:49] sc1
    buffer_store_dword v15, v14, s[20:23], s33 offen sc1
    s_mov_b64 exec, -1
KA_NT:
    s_mul_i32 s68, s70, s74
    s_add_u32 s68, s68, s72
    s_add_u32 m0, s71, 0
    s_add_u32 s70, s70, 1
    buffer_load_dwordx4 v226, s[16:19], s68 offen lds
    s_add_u32 m0, s71, 4096
    s_add_u32 s68, s68, s69
    buffer_load_dwordx4 v226, s[16:19], s68 offen lds
    s_cmp_eq_u32 s70, 9
    s_cselect_b32 s70, 0, s70
    s_mul_i32 s68, s70, s74
    s_add_u32 s68, s68, s72
    s_add_u32 m0, s71, 8192
    s_add_u32 s70, s70, 1
    buffer_load_dwordx4 v226, s[16:19], s68 offen lds
    s_add_u32 m0, s71, 12288
    s_add_u32 s68, s68, s69
    buffer_load_dwordx4 v226, s[16:19], s68 offen lds
    s_cmp_eq_u32 s70, 9
    s_cselect_b32 s70, 0, s70
    s_mul_i32 s68, s70, s74
    s_add_u32 s68, s68, s72
    s_add_u32 m0, s71, 16384
    s_add_u32 s70, s70, 1
    buffer_load_dwordx4 v226, s[16:19], s68 offen lds
    s_add_u32 m0, s71, 20480
    s_add_u32 s68, s68, s69
    buffer_load_dwordx4 v226, s[16:19], s68 offen lds
    s_cmp_eq_u32 s70, 9
    s_cselect_b32 s70, 0, s70
    s_add_u32 s71, s71, 24576
KL_LOOP:
    s_cmp_gt_u32 s43, 3
    s_cbranch_scc1 KL_W18
    s_cmp_eq_u32 s43, 1
    s_cbranch_scc1 KL_BAR
    s_branch KL_GO
KL_W18:
    s_waitcnt vmcnt(18)
KL_BAR:
    s_barrier
KL_GO:
    s_cmp_lg_u32 s67, 0
    s_cbranch_scc1 KL_I
    s_mov_b32 s16, s60
    s_mov_b32 s17, s61
    s_mov_b32 s18, s62
    s_mov_b32 s72, s64
    s_mov_b32 s69, s65
    s_cmp_lt_u32 s66, s50
    s_cselect_b64 vcc, -1, 0
    s_lshl_b32 s74, s69, 1
    v_cndmask_b32 v226, v225, v224, vcc
    s_add_u32 s66, s66, 1
    s_add_u32 s64, s64, 128
    s_cmp_lt_u32 s66, s50
    s_cbranch_scc1 KL_I
    s_sub_u32 s33, s66, s50
    s_bitcmp1_b32 s33, 0
    s_cselect_b32 s60, s10, s8
    s_cselect_b32 s61, s11, s9
    s_lshr_b32 s33, s33, 1
    s_add_u32 s64, s51, s33
    s_lshl_b32 s64, s64, 7
    s_mov_b32 s65, 294912
    v_mov_b32 v227, v228
    s_mov_b32 s62, 5308416
KL_I:
    s_mul_i32 s68, s70, s74
    s_add_u32 s68, s68, s72
    s_add_u32 m0, s71, 0
    s_add_u32 s70, s70, 1
    buffer_load_dwordx4 v226, s[16:19], s68 offen lds
    s_add_u32 m0, s71, 4096
    s_add_u32 s68, s68, s69
    buffer_load_dwordx4 v226, s[16:19], s68 offen lds
    s_cmp_eq_u32 s70, 9
    s_cselect_b32 s70, 0, s70
    s_mul_i32 s68, s70, s74
    s_add_u32 s68, s68, s72
    s_add_u32 m0, s71, 8192
    s_add_u32 s70, s70, 1
    buffer_load_dwordx4 v226, s[16:19], s68 offen lds
    s_add_u32 m0, s71, 12288
    s_add_u32 s68, s68, s69
    buffer_load_dwordx4 v226, s[16:19], s68 offen lds
    s_cmp_eq_u32 s70, 9
    s_cselect_b32 s70, 0, s70
    s_mul_i32 s68, s70, s74
    s_add_u32 s68, s68, s72
    s_add_u32 m0, s71, 16384
    s_add_u32 s70, s70, 1
    buffer_load_dwordx4 v226, s[16:19], s68 offen lds
    s_add_u32 m0, s71, 20480
    s_add_u32 s68, s68, s69
    buffer_load_dwordx4 v226, s[16:19], s68 offen lds
    s_cmp_eq_u32 s70, 9
    s_cselect_b32 s70, 0, s70
    s_cmp_lg_u32 s43, 6
    s_cbranch_scc1 KA_T5
    global_load_dword v64, v65, s[48:49] sc1
KA_T5:
    s_cmp_lg_u32 s43, 10
    s_cbranch_scc1 KA_T9
    v_readfirstlane_b32 s101, v64
    s_nop 0
    s_cmp_lg_u32 s101, 0
    s_cbranch_scc1 KA_TG_D
    s_mov_b32 s35, 0
    v_mov_b32 v65, 0
KA_TG:
    global_load_dword v64, v65, s[48:49] sc1
    s_add_u32 s35, s35, 1
    s_waitcnt vmcnt(0)
    v_readfirstlane_b32 s101, v64
    s_cmp_ge_u32 s35, 0x40000
    s_cbranch_scc1 KA_TG_D
    s_cmp_lg_u32 s101, 0
    s_cbranch_scc1 KA_TG_D
    s_sleep 8
    s_branch KA_TG
KA_TG_D:
    v_mov_b32 v65, 150008
    ds_write_b32 v65, v64
    s_waitcnt lgkmcnt(0)
KA_T9:
    s_lshl_b32 s33, s24, 8
    s_add_u32 s33, s33, s43
    s_cmp_lg_u32 s33, s57
    s_cbranch_scc1 KL_NF
    s_lshl_b32 s33, s15, 2
    s_add_u32 s33, s33, 55836672
    v_lshlrev_b32 v14, 10, v0
    v_mov_b32 v15, s101
    s_mov_b64 exec, 0xff
    buffer_store_dword v15, v14, s[20:23], s33 offen sc1
    s_mov_b64 exec, -1
KL_NF:
    s_add_u32 s71, s71, 24576
    s_cmp_ge_u32 s71, s75
    s_cselect_b32 s33, 147456, 0
    s_sub_u32 s71, s71, s33
    s_add_u32 s67, s67, 1
    s_cmp_eq_u32 s67, 3
    s_cselect_b32 s67, 0, s67
    s_add_u32 s43, s43, 1
    s_cmp_lt_u32 s43, s73
    s_cbranch_scc1 KL_LOOP
    s_setprio 0
    s_mov_b32 s16, s60
    s_mov_b32 s17, s61
    s_mov_b32 s18, s62
    s_mov_b32 s72, s64
    s_mov_b32 s69, s65
    v_lshlrev_b32 v7, 4, v0
    s_lshl_b32 s66, s3, 10
    s_add_u32 s66, s66, 55836672
    s_and_b32 s67, s3, 3
    s_and_b32 s35, s14, 3
    s_mul_i32 s67, s67, 1327104
    s_and_b32 s32, s3, 3
    s_mul_i32 s50, s32, 165888
    s_mul_i32 s35, s14, 5248
    s_add_u32 s50, s50, s35
    s_mul_i32 s35, s24, 1408
    s_add_u32 s50, s50, s35
    s_and_b32 s35, s14, 3
    s_mul_i32 s35, s35, 9
    s_add_u32 s35, s35, 1
    s_lshr_b32 s35, s35, 1
    s_mul_i32 s35, s35, 73728
    s_add_u32 s67, s67, s35
    s_mov_b32 s60, s44
    s_mov_b32 s61, s45
    s_mov_b32 s62, 5308416
    s_mov_b32 s63, 0x00020000
    s_mov_b32 s6, 663552
    s_mov_b32 s7, 0x00020000
    s_lshl_b32 s42, s24, 10
    s_add_u32 s43, s42, 16384
    s_cmp_lt_u32 s24, 2
    s_cselect_b32 s43, s43, 0x30000
    s_waitcnt vmcnt(18)
    s_barrier
    s_mul_i32 s68, s70, s74
    s_add_u32 s68, s68, s72
    s_add_u32 m0, s71, 0
    s_add_u32 s70, s70, 1
    buffer_load_dwordx4 v226, s[16:19], s68 offen lds
    s_add_u32 m0, s71, 4096
    s_add_u32 s68, s68, s69
    buffer_load_dwordx4 v226, s[16:19], s68 offen lds
    s_cmp_eq_u32 s70, 9
    s_cselect_b32 s70, 0, s70
    s_mul_i32 s68, s70, s74
    s_add_u32 s68, s68, s72
    s_add_u32 m0, s71, 8192
    s_add_u32 s70, s70, 1
    buffer_load_dwordx4 v226, s[16:19], s68 offen lds
    s_add_u32 m0, s71, 12288
    s_add_u32 s68, s68, s69
    buffer_load_dwordx4 v226, s[16:19], s68 offen lds
    s_cmp_eq_u32 s70, 9
    s_cselect_b32 s70, 0, s70
    s_mul_i32 s68, s70, s74
    s_add_u32 s68, s68, s72
    s_add_u32 m0, s71, 16384
    s_add_u32 s70, s70, 1
    buffer_load_dwordx4 v226, s[16:19], s68 offen lds
    s_add_u32 m0, s71, 20480
    s_add_u32 s68, s68, s69
    buffer_load_dwordx4 v226, s[16:19], s68 offen lds
    s_cmp_eq_u32 s70, 9
    s_cselect_b32 s70, 0, s70
    s_add_u32 s71, s71, 24576
    s_and_b32 s32, s3, 3
    s_mul_i32 s51, s32, 1327104
    buffer_load_dwordx4 v[64:67], v7, s[20:23], s66 offen sc1
    buffer_load_dword v229, v24, s[4:7], s50 offen
    s_waitcnt vmcnt(20)
    s_barrier
    s_mul_i32 s68, s70, s74
    s_add_u32 s68, s68, s72
    s_add_u32 m0, s71, 0
    s_add_u32 s70, s70, 1
    buffer_load_dwordx4 v226, s[16:19], s68 offen lds
    s_add_u32 m0, s71, 4096
    s_add_u32 s68, s68, s69
    buffer_load_dwordx4 v226, s[16:19], s68 offen lds
    s_cmp_eq_u32 s70, 9
    s_cselect_b32 s70, 0, s70
    s_mul_i32 s68, s70, s74
    s_add_u32 s68, s68, s72
    s_add_u32 m0, s71, 8192
    s_add_u32 s70, s70, 1
    buffer_load_dwordx4 v226, s[16:19], s68 offen lds
    s_add_u32 m0, s71, 12288
    s_add_u32 s68, s68, s69
    buffer_load_dwordx4 v226, s[16:19], s68 offen lds
    s_cmp_eq_u32 s70, 9
    s_cselect_b32 s70, 0, s70
    s_mul_i32 s68, s70, s74
    s_add_u32 s68, s68, s72
    s_add_u32 m0, s71, 16384
    s_add_u32 s70, s70, 1
    buffer_load_dwordx4 v226, s[16:19], s68 offen lds
    s_add_u32 m0, s71, 20480
    s_add_u32 s68, s68, s69
    buffer_load_dwordx4 v226, s[16:19], s68 offen lds
    s_cmp_eq_u32 s70, 9
    s_cselect_b32 s70, 0, s70
    s_add_u32 s71, s71, 24576
    s_waitcnt vmcnt(20)
    s_barrier
    s_mul_i32 s68, s70, s74
    s_add_u32 s68, s68, s72
    s_add_u32 m0, s71, 0
    s_add_u32 s70, s70, 1
    buffer_load_dwordx4 v226, s[16:19], s68 offen lds
    s_add_u32 m0, s71, 4096
    s_add_u32 s68, s68, s69
    buffer_load_dwordx4 v226, s[16:19], s68 offen lds
    s_cmp_eq_u32 s70, 9
    s_cselect_b32 s70, 0, s70
    s_mul_i32 s68, s70, s74
    s_add_u32 s68, s68, s72
    s_add_u32 m0, s71, 8192
    s_add_u32 s70, s70, 1
    buffer_load_dwordx4 v226, s[16:19], s68 offen lds
    s_add_u32 m0, s71, 12288
    s_add_u32 s68, s68, s69
    buffer_load_dwordx4 v226, s[16:19], s68 offen lds
    s_cmp_eq_u32 s70, 9
    s_cselect_b32 s70, 0, s70
    s_mul_i32 s68, s70, s74
    s_add_u32 s68, s68, s72
    s_add_u32 m0, s71, 16384
    s_add_u32 s70, s70, 1
    buffer_load_dwordx4 v226, s[16:19], s68 offen lds
    s_add_u32 m0, s71, 20480
    s_add_u32 s68, s68, s69
    buffer_load_dwordx4 v226, s[16:19], s68 offen lds
    s_cmp_eq_u32 s70, 9
    s_cselect_b32 s70, 0, s70
    s_add_u32 s71, s71, 24576
    s_waitcnt lgkmcnt(0)
    s_mov_b32 s16, s10
    s_mov_b32 s17, s11
    s_waitcnt vmcnt(13)
    s_mov_b32 s47, 0
KA_W:
    v_xor_b32 v64, s101, v64
    v_xor_b32 v65, s101, v65
    v_xor_b32 v66, s101, v66
    v_xor_b32 v67, s101, v67
    v_or3_b32 v64, v64, v65, v66
    v_or_b32 v64, v64, v67
    v_cmp_ne_u32 vcc, 0, v64
    s_cmp_ge_u32 s47, 0x20000
    s_cbranch_scc1 KA_WD
    s_cmp_eq_u64 vcc, 0
    s_cbranch_scc1 KA_WD
    s_sleep 16
    buffer_load_dwordx4 v[64:67], v7, s[20:23], s66 offen sc1
    s_add_u32 s47, s47, 1
    s_waitcnt vmcnt(0)
    s_branch KA_W
KA_WD:
    s_mul_i32 s32, s52, 110592
    s_add_u32 s32, s32, s28
    s_xor_b32 s35, s52, 1
    s_mul_i32 s35, s35, 110592
    s_add_u32 s35, s35, s28
    buffer_load_dwordx2 v[32:33], v8, s[20:23], s35 offen sc1
    buffer_load_dwordx2 v[34:35], v8, s[20:23], s35 offen offset:512 sc1
    buffer_load_dword v38, v9, s[20:23], s35 offen sc1
    buffer_load_dwordx2 v[28:29], v8, s[20:23], s32 offen sc1
    buffer_load_dwordx2 v[30:31], v8, s[20:23], s32 offen offset:512 sc1
    buffer_load_dword v36, v9, s[20:23], s32 offen sc1
    s_barrier
    s_mul_i32 s68, s70, s74
    s_add_u32 s68, s68, s72
    s_add_u32 m0, s71, 0
    s_add_u32 s70, s70, 1
    buffer_load_dwordx4 v226, s[16:19], s68 offen lds
    s_add_u32 m0, s71, 4096
    s_add_u32 s68, s68, s69
    buffer_load_dwordx4 v226, s[16:19], s68 offen lds
    s_cmp_eq_u32 s70, 9
    s_cselect_b32 s70, 0, s70
    s_mul_i32 s68, s70, s74
    s_add_u32 s68, s68, s72
    s_add_u32 m0, s71, 8192
    s_add_u32 s70, s70, 1
    buffer_load_dwordx4 v226, s[16:19], s68 offen lds
    s_add_u32 m0, s71, 12288
    s_add_u32 s68, s68, s69
    buffer_load_dwordx4 v226, s[16:19], s68 offen lds
    s_cmp_eq_u32 s70, 9
    s_cselect_b32 s70, 0, s70
    s_mul_i32 s68, s70, s74
    s_add_u32 s68, s68, s72
    s_add_u32 m0, s71, 16384
    s_add_u32 s70, s70, 1
    buffer_load_dwordx4 v226, s[16:19], s68 offen lds
    s_add_u32 m0, s71, 20480
    s_add_u32 s68, s68, s69
    buffer_load_dwordx4 v226, s[16:19], s68 offen lds
    s_cmp_eq_u32 s70, 9
    s_cselect_b32 s70, 0, s70
    s_add_u32 s71, s71, 24576
    buffer_load_dwordx2 v[192:193], v8, s[20:23], s36 offen sc1
    buffer_load_dwordx2 v[194:195], v8, s[20:23], s36 offen offset:512 sc1
    buffer_load_dword v208, v9, s[20:23], s36 offen sc1
    buffer_load_dwordx2 v[196:197], v8, s[20:23], s37 offen sc1
    buffer_load_dwordx2 v[198:199], v8, s[20:23], s37 offen offset:512 sc1
    buffer_load_dword v210, v9, s[20:23], s37 offen sc1
    s_barrier
    s_mul_i32 s68, s70, s74
    s_add_u32 s68, s68, s72
    s_add_u32 m0, s71, 0
    s_add_u32 s70, s70, 1
    buffer_load_dwordx4 v226, s[16:19], s68 offen lds
    s_add_u32 m0, s71, 4096
    s_add_u32 s68, s68, s69
    buffer_load_dwordx4 v226, s[16:19], s68 offen lds
    s_cmp_eq_u32 s70, 9
    s_cselect_b32 s70, 0, s70
    s_mul_i32 s68, s70, s74
    s_add_u32 s68, s68, s72
    s_add_u32 m0, s71, 8192
    s_add_u32 s70, s70, 1
    buffer_load_dwordx4 v226, s[16:19], s68 offen lds
    s_add_u32 m0, s71, 12288
    s_add_u32 s68, s68, s69
    buffer_load_dwordx4 v226, s[16:19], s68 offen lds
    s_cmp_eq_u32 s70, 9
    s_cselect_b32 s70, 0, s70
    s_mul_i32 s68, s70, s74
    s_add_u32 s68, s68, s72
    s_add_u32 m0, s71, 16384
    s_add_u32 s70, s70, 1
    buffer_load_dwordx4 v226, s[16:19], s68 offen lds
    s_add_u32 m0, s71, 20480
    s_add_u32 s68, s68, s69
    buffer_load_dwordx4 v226, s[16:19], s68 offen lds
    s_cmp_eq_u32 s70, 9
    s_cselect_b32 s70, 0, s70
    s_add_u32 s71, s71, 24576
    buffer_load_dwordx2 v[200:201], v8, s[20:23], s38 offen sc1
    buffer_load_dwordx2 v[202:203], v8, s[20:23], s38 offen offset:512 sc1
    buffer_load_dword v212, v9, s[20:23], s38 offen sc1
    buffer_load_dwordx2 v[204:205], v8, s[20:23], s39 offen sc1
    buffer_load_dwordx2 v[206:207], v8, s[20:23], s39 offen offset:512 sc1
    buffer_load_dword v214, v9, s[20:23], s39 offen sc1
    s_waitcnt vmcnt(36)
    s_barrier
    s_mul_i32 s68, s70, s74
    s_add_u32 s68, s68, s72
    s_add_u32 m0, s71, 0
    s_add_u32 s70, s70, 1
    buffer_load_dwordx4 v226, s[16:19], s68 offen lds
    s_add_u32 m0, s71, 4096
    s_add_u32 s68, s68, s69
    buffer_load_dwordx4 v226, s[16:19], s68 offen lds
    s_cmp_eq_u32 s70, 9
    s_cselect_b32 s70, 0, s70
    s_mul_i32 s68, s70, s74
    s_add_u32 s68, s68, s72
    s_add_u32 m0, s71, 8192
    s_add_u32 s70, s70, 1
    buffer_load_dwordx4 v226, s[16:19], s68 offen lds
    s_add_u32 m0, s71, 12288
    s_add_u32 s68, s68, s69
    buffer_load_dwordx4 v226, s[16:19], s68 offen lds
    s_cmp_eq_u32 s70, 9
    s_cselect_b32 s70, 0, s70
    s_mul_i32 s68, s70, s74
    s_add_u32 s68, s68, s72
    s_add_u32 m0, s71, 16384
    s_add_u32 s70, s70, 1
    buffer_load_dwordx4 v226, s[16:19], s68 offen lds
    s_add_u32 m0, s71, 20480
    s_add_u32 s68, s68, s69
    buffer_load_dwordx4 v226, s[16:19], s68 offen lds
    s_cmp_eq_u32 s70, 9
    s_cselect_b32 s70, 0, s70
    s_add_u32 s71, s71, 24576
    v_lshlrev_b32 v14, 2, v2
    s_lshl_b32 s33, s26, 7
    s_add_u32 s33, s33, 54525952
    buffer_load_dword v22, v14, s[20:23], s33 offen sc1
    buffer_load_dword v23, v14, s[20:23], s33 offen offset:128 sc1
    s_mul_i32 s32, s52, 3072
    s_add_u32 s32, s32, 73728
    v_add_u32 v8, s32, v8
    v_add_u32 v9, s32, v9
    s_mov_b32 s16, s12
    s_mov_b32 s17, s13
    s_mov_b32 s18, 58720256
    s_mov_b32 s19, 0x00020000
    s_waitcnt vmcnt(23)
    v_cndmask_b32 v208, 0, v208, s[40:41]
    s_nop 1
    v_mfma_f32_32x32x8_bf16 v[64:79], v[36:37], v[208:209], 0
    v_mfma_f32_32x32x16_bf16 v[64:79], v[28:31], v[192:195], v[64:79]
    v_mfma_f32_32x32x8_bf16 v[80:95], v[38:39], v[208:209], 0
    v_mfma_f32_32x32x16_bf16 v[80:95], v[32:35], v[192:195], v[80:95]
    s_waitcnt vmcnt(20)
    v_cndmask_b32 v210, 0, v210, s[40:41]
    s_nop 1
    v_mfma_f32_32x32x8_bf16 v[96:111], v[36:37], v[210:211], 0
    v_mfma_f32_32x32x16_bf16 v[96:111], v[28:31], v[196:199], v[96:111]
    v_mfma_f32_32x32x8_bf16 v[112:127], v[38:39], v[210:211], 0
    v_mfma_f32_32x32x16_bf16 v[112:127], v[32:35], v[196:199], v[112:127]
    s_barrier
    s_add_u32 m0, s42, 0
    s_nop 0
    buffer_load_dwordx4 v232, s[60:63], s67 offen lds
    s_add_u32 m0, s42, 4096
    s_nop 0
    buffer_load_dwordx4 v233, s[60:63], s67 offen lds
    s_add_u32 m0, s42, 8192
    s_nop 0
    buffer_load_dwordx4 v234, s[60:63], s67 offen lds
    s_add_u32 m0, s42, 12288
    s_nop 0
    buffer_load_dwordx4 v235, s[60:63], s67 offen lds
    s_add_u32 m0, s43, 0
    s_nop 0
    buffer_load_dwordx4 v236, s[60:63], s67 offen lds
    s_add_u32 s67, s67, 73728
    v_max3_f32 v57, v64, v65, v66
    v_max3_f32 v57, v57, v67, v68
    v_max3_f32 v57, v57, v69, v70
    v_max3_f32 v57, v57, v71, v72
    v_max3_f32 v57, v57, v73, v74
    v_max3_f32 v57, v57, v75, v76
    v_max3_f32 v57, v57, v77, v78
    v_max3_f32 v57, v57, v79, v80
    v_max3_f32 v57, v57, v81, v82
    v_max3_f32 v57, v57, v83, v84
    v_max3_f32 v57, v57, v85, v86
    v_max3_f32 v57, v57, v87, v88
    v_max3_f32 v57, v57, v89, v90
    v_max3_f32 v57, v57, v91, v92
    v_max3_f32 v57, v57, v93, v94
    v_max_f32 v57, v57, v95
    v_mov_b32 v14, v57
    s_nop 1
    v_permlane32_swap_b32 v57, v14
    s_nop 1
    v_max_f32 v57, v57, v14
    v_add_f32 v57, 0x42b80000, v57
    v_xor_b32 v14, 0x80000000, v57
    v_and_b32 v15, 0xffff0000, v14
    v_sub_f32 v14, v14, v15
    v_and_b32 v56, 0xffff0000, v14
    v_sub_f32 v14, v14, v56
    v_lshrrev_b32 v15, 16, v15
    v_or_b32 v15, v15, v56
    v_lshrrev_b32 v14, 16, v14
    v_cndmask_b32 v209, v14, v15, s[40:41]
    s_lshl_b32 s32, s24, 9
    s_add_u32 s32, s32, 147456
    v_lshl_add_u32 v26, v0, 2, s32
    v_xor_b32 v27, 1024, v26
    s_barrier
    s_add_u32 m0, s42, 18432
    s_nop 0
    buffer_load_dwordx4 v232, s[60:63], s67 offen lds
    s_add_u32 m0, s42, 22528
    s_nop 0
    buffer_load_dwordx4 v233, s[60:63], s67 offen lds
    s_add_u32 m0, s42, 26624
    s_nop 0
    buffer_load_dwordx4 v234, s[60:63], s67 offen lds
    s_add_u32 m0, s42, 30720
    s_nop 0
    buffer_load_dwordx4 v235, s[60:63], s67 offen lds
    s_add_u32 m0, s43, 18432
    s_nop 0
    buffer_load_dwordx4 v236, s[60:63], s67 offen lds
    s_add_u32 s67, s67, 73728
    v_max3_f32 v57, v96, v97, v98
    v_max3_f32 v57, v57, v99, v100
    v_max3_f32 v57, v57, v101, v102
    v_max3_f32 v57, v57, v103, v104
    v_max3_f32 v57, v57, v105, v106
    v_max3_f32 v57, v57, v107, v108
    v_max3_f32 v57, v57, v109, v110
    v_max3_f32 v57, v57, v111, v112
    v_max3_f32 v57, v57, v113, v114
    v_max3_f32 v57, v57, v115, v116
    v_max3_f32 v57, v57, v117, v118
    v_max3_f32 v57, v57, v119, v120
    v_max3_f32 v57, v57, v121, v122
    v_max3_f32 v57, v57, v123, v124
    v_max3_f32 v57, v57, v125, v126
    v_max_f32 v57, v57, v127
    v_mov_b32 v14, v57
    s_nop 1
    v_permlane32_swap_b32 v57, v14
    s_nop 1
    v_max_f32 v57, v57, v14
    v_add_f32 v57, 0x42b80000, v57
    v_xor_b32 v14, 0x80000000, v57
    v_and_b32 v15, 0xffff0000, v14
    v_sub_f32 v14, v14, v15
    v_and_b32 v56, 0xffff0000, v14
    v_sub_f32 v14, v14, v56
    v_lshrrev_b32 v15, 16, v15
    v_or_b32 v15, v15, v56
    v_lshrrev_b32 v14, 16, v14
    v_cndmask_b32 v211, v14, v15, s[40:41]
    ds_write_b32 v26, v209
    ds_write_b32 v26, v211 offset:256
    v_mfma_f32_32x32x8_bf16 v[64:79], v[36:37], v[208:209], 0
    v_mfma_f32_32x32x16_bf16 v[64:79], v[28:31], v[192:195], v[64:79]
    v_mfma_f32_32x32x8_bf16 v[80:95], v[36:37], v[210:211], 0
    v_mfma_f32_32x32x16_bf16 v[80:95], v[28:31], v[196:199], v[80:95]
    s_waitcnt lgkmcnt(0)
    s_waitcnt vmcnt(24)
    s_barrier
    ds_read_b32 v213, v27
    ds_read_b32 v215, v27 offset:256
    s_add_u32 m0, s42, 36864
    s_nop 0
    buffer_load_dwordx4 v232, s[60:63], s67 offen lds
    s_add_u32 m0, s42, 40960
    s_nop 0
    buffer_load_dwordx4 v233, s[60:63], s67 offen lds
    s_add_u32 m0, s42, 45056
    s_nop 0
    buffer_load_dwordx4 v234, s[60:63], s67 offen lds
    s_add_u32 m0, s42, 49152
    s_nop 0
    buffer_load_dwordx4 v235, s[60:63], s67 offen lds
    s_add_u32 m0, s43, 36864
    s_nop 0
    buffer_load_dwordx4 v236, s[60:63], s67 offen lds
    s_add_u32 s67, s67, 73728
    s_waitcnt vmcnt(23)
    v_cndmask_b32 v212, 0, v212, s[40:41]
    v_cndmask_b32 v214, 0, v214, s[40:41]
    s_waitcnt lgkmcnt(0)
    v_mov_b32 v112, 0
    v_mov_b32 v113, 0
    v_mov_b32 v114, 0
    v_mov_b32 v115, 0
    v_mov_b32 v116, 0
    v_mov_b32 v117, 0
    v_mov_b32 v118, 0
    v_mov_b32 v119, 0
    v_mov_b32 v120, 0
    v_mov_b32 v121, 0
    v_mov_b32 v122, 0
    v_mov_b32 v123, 0
    v_mov_b32 v124, 0
    v_mov_b32 v125, 0
    v_mov_b32 v126, 0
    v_mov_b32 v127, 0
    s_waitcnt vmcnt(15)
    s_barrier
    s_mov_b32 s29, s55
    s_add_u32 m0, s29, 0
    s_nop 0
    buffer_load_dwordx4 v16, s[16:19], s28 offen sc1 lds
    s_add_u32 m0, s29, 4096
    s_nop 0
    buffer_load_dwordx4 v17, s[16:19], s28 offen sc1 lds
    s_add_u32 m0, s29, 8192
    s_nop 0
    buffer_load_dwordx4 v18, s[16:19], s28 offen sc1 lds
    s_add_u32 m0, s29, 12288
    s_nop 0
    buffer_load_dwordx4 v19, s[16:19], s28 offen sc1 lds
    s_add_u32 m0, s29, 16384
    s_nop 0
    buffer_load_dwordx4 v20, s[16:19], s28 offen sc1 lds
    s_add_u32 m0, s29, 20480
    s_nop 0
    buffer_load_dwordx4 v21, s[16:19], s28 offen sc1 lds
    s_add_u32 s28, s28, 884736
    s_mul_i32 s32, s24, 6144
    s_add_u32 s32, s32, 73728
    v_add_u32 v24, s32, v7
    s_xor_b32 s32, s24, 2
    s_mul_i32 s32, s32, 6144
    s_add_u32 s32, s32, 73728
    v_add_u32 v25, s32, v7
    v_rcp_f32 v22, v22
    v_rcp_f32 v23, v23
    s_cmp_eq_u32 s25, 0
    s_cselect_b64 s[42:43], -1, 0
    v_lshlrev_b32 v26, 2, v2
    v_mov_b32 v14, 0x7ffffff0
    v_cndmask_b32 v26, v14, v26, s[40:41]
    s_mul_i32 s36, s26, 36864
    s_lshr_b32 s32, s53, 3
    s_mul_i32 s33, s32, 9216
    s_add_u32 s36, s36, s33
    s_add_u32 s36, s36, 29360128
    s_and_b32 s33, s53, 7
    s_and_b32 s58, s26, 28
    s_lshl_b32 s58, s58, 3
    s_add_u32 s58, s58, s32
    s_lshr_b32 s32, s26, 5
    s_lshl_b32 s32, s32, 2
    s_add_u32 s58, s58, s32
    s_mul_i32 s58, s58, 768
    s_lshl_b32 s32, s33, 2
    s_add_u32 s58, s58, s32
    s_and_b32 s32, s26, 2
    s_lshl_b32 s32, s32, 4
    s_add_u32 s58, s58, s32
    s_add_u32 s58, s58, 55574528
    s_lshl_b32 s38, s33, 7
    s_add_u32 s38, s38, s36
    s_add_u32 s38, s38, 8192
    s_add_u32 s39, s38, 36864
    s_lshl_b32 s33, s33, 10
    s_add_u32 s36, s36, s33
    s_add_u32 s37, s36, 36864
    v_cmp_gt_u32 vcc, 4, v0
    v_mul_u32_u24 v27, 6144, v0
    v_mov_b32 v61, s101
    v_cndmask_b32 v27, v14, v27, vcc
    s_mov_b32 s30, 0
    s_mov_b32 s56, 0
    s_mov_b32 s46, 4294918144
    s_barrier
    s_add_u32 s29, s55, 24576
    s_add_u32 m0, s29, 0
    s_nop 0
    buffer_load_dwordx4 v16, s[16:19], s28 offen sc1 lds
    s_add_u32 m0, s29, 4096
    s_nop 0
    buffer_load_dwordx4 v17, s[16:19], s28 offen sc1 lds
    s_add_u32 m0, s29, 8192
    s_nop 0
    buffer_load_dwordx4 v18, s[16:19], s28 offen sc1 lds
    s_add_u32 m0, s29, 12288
    s_nop 0
    buffer_load_dwordx4 v19, s[16:19], s28 offen sc1 lds
    s_add_u32 m0, s29, 16384
    s_nop 0
    buffer_load_dwordx4 v20, s[16:19], s28 offen sc1 lds
    s_add_u32 m0, s29, 20480
    s_nop 0
    buffer_load_dwordx4 v21, s[16:19], s28 offen sc1 lds
    s_add_u32 s28, s28, 884736
    s_add_u32 s29, s55, 49152
    s_setprio 1
    s_waitcnt vmcnt(6)
    s_barrier
    ds_read_b64_tr_b16 v[40:41], v10 offset:0
    ds_read_b64_tr_b16 v[42:43], v10 offset:64
    ds_read_b64_tr_b16 v[44:45], v10 offset:256
    ds_read_b64_tr_b16 v[46:47], v10 offset:320
    ds_read_b64 v[32:33], v8 offset:6144
    v_add_u32 v10, v10, v11
    s_mov_b32 s57, s46
    s_sub_u32 s32, s38, s36
    v_and_b32 v62, 1, v0
    v_mul_u32_u24 v62, s32, v62
    v_bfe_u32 v15, v0, 1, 1
    v_mul_u32_u24 v15, 36864, v15
    v_cmp_gt_u32 vcc, 4, v0
    v_add_u32 v62, v62, v15
    v_mov_b32 v15, 0x7ffffff0
    v_cndmask_b32 v62, v15, v62, vcc
    s_mov_b32 s51, 884736
K2_ALOOP:
    v_mfma_f32_32x32x8_bf16 v[96:111], v[36:37], v[212:213], 0
    s_add_u32 s56, s56, 1
    ds_read_b64 v[34:35], v8 offset:6656
    v_exp_f32 v64, v64
    v_exp_f32 v65, v65
    v_exp_f32 v66, v66
    v_smfmac_f32_32x32x32_bf16 v[176:191], v[48:51], v[112:119], v13
    s_cmp_eq_u32 s56, 3
    ds_read_b32 v38, v9 offset:6144
    v_exp_f32 v67, v67
    v_exp_f32 v68, v68
    v_exp_f32 v69, v69
    v_exp_f32 v70, v70
    v_exp_f32 v71, v71
    v_mfma_f32_32x32x16_bf16 v[96:111], v[28:31], v[200:203], v[96:111]
    s_cselect_b32 s31, s46, 24576
    v_exp_f32 v72, v72
    v_exp_f32 v73, v73
    v_exp_f32 v74, v74
    v_smfmac_f32_32x32x32_bf16 v[176:191], v[52:55], v[120:127], v13
    s_cselect_b32 s56, 0, s56
    v_exp_f32 v75, v75
    v_exp_f32 v76, v76
    v_exp_f32 v77, v77
    v_exp_f32 v78, v78
    v_exp_f32 v79, v79
    v_mfma_f32_32x32x8_bf16 v[112:127], v[36:37], v[214:215], 0
    s_waitcnt lgkmcnt(3)
    ds_read_b64_tr_b16 v[48:49], v10 offset:0
    v_exp_f32 v80, v80
    v_exp_f32 v81, v81
    v_exp_f32 v82, v82
    v_smfmac_f32_32x32x32_bf16 v[128:143], v[40:43], v[64:71], v13
    ds_read_b64_tr_b16 v[50:51], v10 offset:64
    v_exp_f32 v83, v83
    v_exp_f32 v84, v84
    v_exp_f32 v85, v85
    v_exp_f32 v86, v86
    v_exp_f32 v87, v87
    v_mfma_f32_32x32x16_bf16 v[112:127], v[28:31], v[204:207], v[112:127]
    v_exp_f32 v88, v88
    v_exp_f32 v89, v89
    v_exp_f32 v90, v90
    v_smfmac_f32_32x32x32_bf16 v[128:143], v[44:47], v[72:79], v13
    s_barrier
    s_waitcnt lgkmcnt(2)
    v_exp_f32 v91, v91
    v_exp_f32 v92, v92
    v_exp_f32 v93, v93
    v_exp_f32 v94, v94
    v_exp_f32 v95, v95
    v_mfma_f32_32x32x8_bf16 v[64:79], v[38:39], v[208:209], 0
    ds_read_b64_tr_b16 v[52:53], v10 offset:256
    v_exp_f32 v96, v96
    v_exp_f32 v97, v97
    v_exp_f32 v98, v98
    v_smfmac_f32_32x32x32_bf16 v[144:159], v[40:43], v[80:87], v13
    ds_read_b64_tr_b16 v[54:55], v10 offset:320
    v_exp_f32 v99, v99
    v_exp_f32 v100, v100
    v_exp_f32 v101, v101
    v_exp_f32 v102, v102
    v_exp_f32 v103, v103
    v_mfma_f32_32x32x16_bf16 v[64:79], v[32:35], v[192:195], v[64:79]
    v_exp_f32 v104, v104
    v_exp_f32 v105, v105
    v_exp_f32 v106, v106
    v_smfmac_f32_32x32x32_bf16 v[144:159], v[44:47], v[88:95], v13
    v_exp_f32 v107, v107
    v_exp_f32 v108, v108
    v_exp_f32 v109, v109
    v_exp_f32 v110, v110
    v_exp_f32 v111, v111
    v_mfma_f32_32x32x8_bf16 v[80:95], v[38:39], v[210:211], 0
    s_sub_u32 s33, s31, 18432
    v_add_u32 v10, v10, v11
    v_exp_f32 v112, v112
    v_exp_f32 v113, v113
    v_exp_f32 v114, v114
    v_smfmac_f32_32x32x32_bf16 v[160:175], v[40:43], v[96:103], v13
    s_cmp_ge_u32 s30, 6
    ds_read_b64 v[28:29], v8 offset:12288
    v_exp_f32 v115, v115
    v_exp_f32 v116, v116
    v_exp_f32 v117, v117
    v_exp_f32 v118, v118
    v_exp_f32 v119, v119
    v_mfma_f32_32x32x16_bf16 v[80:95], v[32:35], v[196:199], v[80:95]
    s_cselect_b32 s18, 0, s18
    v_exp_f32 v120, v120
    v_exp_f32 v121, v121
    v_exp_f32 v122, v122
    v_smfmac_f32_32x32x32_bf16 v[160:175], v[44:47], v[104:111], v13
    s_cselect_b32 s29, 0x30000, s29
    v_exp_f32 v123, v123
    v_exp_f32 v124, v124
    v_exp_f32 v125, v125
    v_exp_f32 v126, v126
    v_exp_f32 v127, v127
    v_mfma_f32_32x32x8_bf16 v[96:111], v[38:39], v[212:213], 0
    s_add_u32 s30, s30, 1
    ds_read_b64 v[30:31], v8 offset:12800
    v_exp_f32 v64, v64
    v_exp_f32 v65, v65
    v_exp_f32 v66, v66
    v_smfmac_f32_32x32x32_bf16 v[176:191], v[40:43], v[112:119], v13
    ds_read_b32 v36, v9 offset:12288
    v_exp_f32 v67, v67
    v_exp_f32 v68, v68
    v_exp_f32 v69, v69
    v_exp_f32 v70, v70
    v_exp_f32 v71, v71
    v_mfma_f32_32x32x16_bf16 v[96:111], v[32:35], v[200:203], v[96:111]
    s_add_u32 m0, s29, 0
    v_exp_f32 v72, v72
    v_exp_f32 v73, v73
    v_exp_f32 v74, v74
    v_smfmac_f32_32x32x32_bf16 v[176:191], v[44:47], v[120:127], v13
    buffer_load_dwordx4 v16, s[16:19], s28 offen sc1 lds
    v_exp_f32 v75, v75
    v_exp_f32 v76, v76
    v_exp_f32 v77, v77
    v_exp_f32 v78, v78
    v_exp_f32 v79, v79
    v_mfma_f32_32x32x8_bf16 v[112:127], v[38:39], v[214:215], 0
    s_waitcnt lgkmcnt(3)
    ds_read_b64_tr_b16 v[40:41], v10 offset:0
    v_exp_f32 v80, v80
    v_exp_f32 v81, v81
    v_exp_f32 v82, v82
    v_smfmac_f32_32x32x32_bf16 v[128:143], v[48:51], v[64:71], v13
    ds_read_b64_tr_b16 v[42:43], v10 offset:64
    v_exp_f32 v83, v83
    v_exp_f32 v84, v84
    v_exp_f32 v85, v85
    v_exp_f32 v86, v86
    v_exp_f32 v87, v87
    v_mfma_f32_32x32x16_bf16 v[112:127], v[32:35], v[204:207], v[112:127]
    s_add_u32 m0, s29, 4096
    v_exp_f32 v88, v88
    v_exp_f32 v89, v89
    v_exp_f32 v90, v90
    v_smfmac_f32_32x32x32_bf16 v[128:143], v[52:55], v[72:79], v13
    s_waitcnt lgkmcnt(2)
    buffer_load_dwordx4 v17, s[16:19], s28 offen sc1 lds
    v_exp_f32 v91, v91
    v_exp_f32 v92, v92
    v_exp_f32 v93, v93
    v_exp_f32 v94, v94
    v_exp_f32 v95, v95
    v_mfma_f32_32x32x8_bf16 v[64:79], v[36:37], v[208:209], 0
    ds_read_b64_tr_b16 v[44:45], v10 offset:256
    v_exp_f32 v96, v96
    v_exp_f32 v97, v97
    v_exp_f32 v98, v98
    v_smfmac_f32_32x32x32_bf16 v[144:159], v[48:51], v[80:87], v13
    ds_read_b64_tr_b16 v[46:47], v10 offset:320
    v_exp_f32 v99, v99
    v_exp_f32 v100, v100
    v_exp_f32 v101, v101
    v_exp_f32 v102, v102
    v_exp_f32 v103, v103
    v_mfma_f32_32x32x16_bf16 v[64:79], v[28:31], v[192:195], v[64:79]
    v_exp_f32 v104, v104
    v_exp_f32 v105, v105
    v_exp_f32 v106, v106
    v_smfmac_f32_32x32x32_bf16 v[144:159], v[52:55], v[88:95], v13
    s_barrier
    v_exp_f32 v107, v107
    v_exp_f32 v108, v108
    v_exp_f32 v109, v109
    v_exp_f32 v110, v110
    v_exp_f32 v111, v111
    v_mfma_f32_32x32x8_bf16 v[80:95], v[36:37], v[210:211], 0
    v_add_u32 v10, v10, v11
    v_exp_f32 v112, v112
    v_exp_f32 v113, v113
    v_exp_f32 v114, v114
    v_smfmac_f32_32x32x32_bf16 v[160:175], v[48:51], v[96:103], v13
    ds_read_b64 v[32:33], v8 offset:18432
    v_exp_f32 v115, v115
    v_exp_f32 v116, v116
    v_exp_f32 v117, v117
    v_exp_f32 v118, v118
    v_exp_f32 v119, v119
    v_mfma_f32_32x32x16_bf16 v[80:95], v[28:31], v[196:199], v[80:95]
    s_add_u32 m0, s29, 8192
    v_exp_f32 v120, v120
    v_exp_f32 v121, v121
    v_exp_f32 v122, v122
    v_smfmac_f32_32x32x32_bf16 v[160:175], v[52:55], v[104:111], v13
    v_and_b32 v14, s33, v12
    buffer_load_dwordx4 v18, s[16:19], s28 offen sc1 lds
    v_exp_f32 v123, v123
    v_exp_f32 v124, v124
    v_exp_f32 v125, v125
    v_exp_f32 v126, v126
    v_exp_f32 v127, v127
    v_mfma_f32_32x32x8_bf16 v[96:111], v[36:37], v[212:213], 0
    ds_read_b64 v[34:35], v8 offset:18944
    v_exp_f32 v64, v64
    v_exp_f32 v65, v65
    v_exp_f32 v66, v66
    v_smfmac_f32_32x32x32_bf16 v[176:191], v[48:51], v[112:119], v13
    ds_read_b32 v38, v9 offset:18432
    v_exp_f32 v67, v67
    v_exp_f32 v68, v68
    v_exp_f32 v69, v69
    v_exp_f32 v70, v70
    v_exp_f32 v71, v71
    v_mfma_f32_32x32x16_bf16 v[96:111], v[28:31], v[200:203], v[96:111]
    s_add_u32 m0, s29, 12288
    v_exp_f32 v72, v72
    v_exp_f32 v73, v73
    v_exp_f32 v74, v74
    v_smfmac_f32_32x32x32_bf16 v[176:191], v[52:55], v[120:127], v13
    buffer_load_dwordx4 v19, s[16:19], s28 offen sc1 lds
    v_exp_f32 v75, v75
    v_exp_f32 v76, v76
    v_exp_f32 v77, v77
    v_exp_f32 v78, v78
    v_exp_f32 v79, v79
    v_mfma_f32_32x32x8_bf16 v[112:127], v[36:37], v[214:215], 0
    s_waitcnt lgkmcnt(3)
    ds_read_b64_tr_b16 v[48:49], v10 offset:0
    v_exp_f32 v80, v80
    v_exp_f32 v81, v81
    v_exp_f32 v82, v82
    v_smfmac_f32_32x32x32_bf16 v[128:143], v[40:43], v[64:71], v13
    ds_read_b64_tr_b16 v[50:51], v10 offset:64
    v_exp_f32 v83, v83
    v_exp_f32 v84, v84
    v_exp_f32 v85, v85
    v_exp_f32 v86, v86
    v_exp_f32 v87, v87
    v_mfma_f32_32x32x16_bf16 v[112:127], v[28:31], v[204:207], v[112:127]
    s_add_u32 m0, s29, 16384
    v_exp_f32 v88, v88
    v_exp_f32 v89, v89
    v_exp_f32 v90, v90
    v_smfmac_f32_32x32x32_bf16 v[128:143], v[44:47], v[72:79], v13
    s_waitcnt lgkmcnt(2)
    buffer_load_dwordx4 v20, s[16:19], s28 offen sc1 lds
    v_exp_f32 v91, v91
    v_exp_f32 v92, v92
    v_exp_f32 v93, v93
    v_exp_f32 v94, v94
    v_exp_f32 v95, v95
    v_mfma_f32_32x32x8_bf16 v[64:79], v[38:39], v[208:209], 0
    ds_read_b64_tr_b16 v[52:53], v10 offset:256
    v_exp_f32 v96, v96
    v_exp_f32 v97, v97
    v_exp_f32 v98, v98
    v_smfmac_f32_32x32x32_bf16 v[144:159], v[40:43], v[80:87], v13
    ds_read_b64_tr_b16 v[54:55], v10 offset:320
    v_exp_f32 v99, v99
    v_exp_f32 v100, v100
    v_exp_f32 v101, v101
    v_exp_f32 v102, v102
    v_exp_f32 v103, v103
    v_mfma_f32_32x32x16_bf16 v[64:79], v[32:35], v[192:195], v[64:79]
    s_waitcnt vmcnt(5)
    v_exp_f32 v104, v104
    v_exp_f32 v105, v105
    v_exp_f32 v106, v106
    v_smfmac_f32_32x32x32_bf16 v[144:159], v[44:47], v[88:95], v13
    s_barrier
    v_exp_f32 v107, v107
    v_exp_f32 v108, v108
    v_exp_f32 v109, v109
    v_exp_f32 v110, v110
    v_exp_f32 v111, v111
    v_mfma_f32_32x32x8_bf16 v[80:95], v[38:39], v[210:211], 0
    v_add_u32 v10, v10, v14
    v_add_u32 v8, s31, v8
    v_exp_f32 v112, v112
    v_exp_f32 v113, v113
    v_exp_f32 v114, v114
    v_smfmac_f32_32x32x32_bf16 v[160:175], v[40:43], v[96:103], v13
    ds_read_b64 v[28:29], v8 offset:0
    v_exp_f32 v115, v115
    v_exp_f32 v116, v116
    v_exp_f32 v117, v117
    v_exp_f32 v118, v118
    v_exp_f32 v119, v119
    v_mfma_f32_32x32x16_bf16 v[80:95], v[32:35], v[196:199], v[80:95]
    s_add_u32 m0, s29, 20480
    v_exp_f32 v120, v120
    v_exp_f32 v121, v121
    v_exp_f32 v122, v122
    v_smfmac_f32_32x32x32_bf16 v[160:175], v[44:47], v[104:111], v13
    v_add_u32 v9, s31, v9
    buffer_load_dwordx4 v21, s[16:19], s28 offen sc1 lds
    v_exp_f32 v123, v123
    v_exp_f32 v124, v124
    v_exp_f32 v125, v125
    v_exp_f32 v126, v126
    v_exp_f32 v127, v127
    v_mfma_f32_32x32x8_bf16 v[96:111], v[38:39], v[212:213], 0
    ds_read_b64 v[30:31], v8 offset:512
    v_exp_f32 v64, v64
    v_exp_f32 v65, v65
    v_exp_f32 v66, v66
    v_smfmac_f32_32x32x32_bf16 v[176:191], v[40:43], v[112:119], v13
    ds_read_b32 v36, v9 offset:0
    v_exp_f32 v67, v67
    v_exp_f32 v68, v68
    v_exp_f32 v69, v69
    v_exp_f32 v70, v70
    v_exp_f32 v71, v71
    v_mfma_f32_32x32x16_bf16 v[96:111], v[32:35], v[200:203], v[96:111]
    v_exp_f32 v72, v72
    v_exp_f32 v73, v73
    v_exp_f32 v74, v74
    v_smfmac_f32_32x32x32_bf16 v[176:191], v[44:47], v[120:127], v13
    buffer_load_dword v229, v27, s[20:23], s58 offen sc1
    v_exp_f32 v75, v75
    v_exp_f32 v76, v76
    v_exp_f32 v77, v77
    v_exp_f32 v78, v78
    v_exp_f32 v79, v79
    v_mfma_f32_32x32x8_bf16 v[112:127], v[38:39], v[214:215], 0
    s_waitcnt lgkmcnt(3)
    ds_read_b64_tr_b16 v[40:41], v10 offset:0
    v_exp_f32 v80, v80
    v_exp_f32 v81, v81
    v_exp_f32 v82, v82
    v_smfmac_f32_32x32x32_bf16 v[128:143], v[48:51], v[64:71], v13
    ds_read_b64_tr_b16 v[42:43], v10 offset:64
    v_exp_f32 v83, v83
    v_exp_f32 v84, v84
    v_exp_f32 v85, v85
    v_exp_f32 v86, v86
    v_exp_f32 v87, v87
    v_mfma_f32_32x32x16_bf16 v[112:127], v[32:35], v[204:207], v[112:127]
    v_exp_f32 v88, v88
    v_exp_f32 v89, v89
    v_exp_f32 v90, v90
    v_smfmac_f32_32x32x32_bf16 v[128:143], v[52:55], v[72:79], v13
    s_waitcnt lgkmcnt(2)
    buffer_load_dword v229, v62, s[20:23], s36 offen sc1
    v_exp_f32 v91, v91
    v_exp_f32 v92, v92
    v_exp_f32 v93, v93
    v_exp_f32 v94, v94
    v_exp_f32 v95, v95
    v_mfma_f32_32x32x8_bf16 v[64:79], v[36:37], v[208:209], 0
    ds_read_b64_tr_b16 v[44:45], v10 offset:256
    v_exp_f32 v96, v96
    v_exp_f32 v97, v97
    v_exp_f32 v98, v98
    v_smfmac_f32_32x32x32_bf16 v[144:159], v[48:51], v[80:87], v13
    ds_read_b64_tr_b16 v[46:47], v10 offset:320
    v_exp_f32 v99, v99
    v_exp_f32 v100, v100
    v_exp_f32 v101, v101
    v_exp_f32 v102, v102
    v_exp_f32 v103, v103
    v_mfma_f32_32x32x16_bf16 v[64:79], v[28:31], v[192:195], v[64:79]
    v_exp_f32 v104, v104
    v_exp_f32 v105, v105
    v_exp_f32 v106, v106
    v_smfmac_f32_32x32x32_bf16 v[144:159], v[52:55], v[88:95], v13
    v_exp_f32 v107, v107
    v_exp_f32 v108, v108
    v_exp_f32 v109, v109
    v_exp_f32 v110, v110
    v_exp_f32 v111, v111
    v_mfma_f32_32x32x8_bf16 v[80:95], v[36:37], v[210:211], 0
    s_add_u32 s28, s28, s51
    v_add_u32 v10, v10, v11
    v_exp_f32 v112, v112
    v_exp_f32 v113, v113
    v_exp_f32 v114, v114
    v_smfmac_f32_32x32x32_bf16 v[160:175], v[48:51], v[96:103], v13
    s_add_u32 s29, s29, s57
    ds_read_b64 v[32:33], v8 offset:6144
    v_exp_f32 v115, v115
    v_exp_f32 v116, v116
    v_exp_f32 v117, v117
    v_exp_f32 v118, v118
    v_exp_f32 v119, v119
    v_mfma_f32_32x32x16_bf16 v[80:95], v[28:31], v[196:199], v[80:95]
    s_mov_b32 s57, s31
    v_exp_f32 v120, v120
    v_exp_f32 v121, v121
    v_exp_f32 v122, v122
    v_smfmac_f32_32x32x32_bf16 v[160:175], v[52:55], v[104:111], v13
    s_cmp_lt_u32 s30, 8
    s_barrier
    v_exp_f32 v123, v123
    v_exp_f32 v124, v124
    v_exp_f32 v125, v125
    v_exp_f32 v126, v126
    v_exp_f32 v127, v127
    v_mfma_f32_32x32x8_bf16 v[96:111], v[36:37], v[212:213], 0
    s_add_u32 s56, s56, 1
    ds_read_b64 v[34:35], v8 offset:6656
    v_exp_f32 v64, v64
    v_exp_f32 v65, v65
    v_exp_f32 v66, v66
    v_smfmac_f32_32x32x32_bf16 v[176:191], v[48:51], v[112:119], v13
    s_cmp_eq_u32 s56, 3
    ds_read_b32 v38, v9 offset:6144
    v_exp_f32 v67, v67
    v_exp_f32 v68, v68
    v_exp_f32 v69, v69
    v_exp_f32 v70, v70
    v_exp_f32 v71, v71
    v_mfma_f32_32x32x16_bf16 v[96:111], v[28:31], v[200:203], v[96:111]
    s_cselect_b32 s31, s46, 24576
    v_exp_f32 v72, v72
    v_exp_f32 v73, v73
    v_exp_f32 v74, v74
    v_smfmac_f32_32x32x32_bf16 v[176:191], v[52:55], v[120:127], v13
    s_cselect_b32 s56, 0, s56
    v_exp_f32 v75, v75
    v_exp_f32 v76, v76
    v_exp_f32 v77, v77
    v_exp_f32 v78, v78
    v_exp_f32 v79, v79
    v_mfma_f32_32x32x8_bf16 v[112:127], v[36:37], v[214:215], 0
    s_waitcnt lgkmcnt(3)
    ds_read_b64_tr_b16 v[48:49], v10 offset:0
    v_exp_f32 v80, v80
    v_exp_f32 v81, v81
    v_exp_f32 v82, v82
    v_smfmac_f32_32x32x32_bf16 v[128:143], v[40:43], v[64:71], v13
    ds_read_b64_tr_b16 v[50:51], v10 offset:64
    v_exp_f32 v83, v83
    v_exp_f32 v84, v84
    v_exp_f32 v85, v85
    v_exp_f32 v86, v86
    v_exp_f32 v87, v87
    v_mfma_f32_32x32x16_bf16 v[112:127], v[28:31], v[204:207], v[112:127]
    v_exp_f32 v88, v88
    v_exp_f32 v89, v89
    v_exp_f32 v90, v90
    v_smfmac_f32_32x32x32_bf16 v[128:143], v[44:47], v[72:79], v13
    s_waitcnt lgkmcnt(2)
    v_exp_f32 v91, v91
    v_exp_f32 v92, v92
    v_exp_f32 v93, v93
    v_exp_f32 v94, v94
    v_exp_f32 v95, v95
    v_mfma_f32_32x32x8_bf16 v[64:79], v[38:39], v[208:209], 0
    ds_read_b64_tr_b16 v[52:53], v10 offset:256
    v_exp_f32 v96, v96
    v_exp_f32 v97, v97
    v_exp_f32 v98, v98
    v_smfmac_f32_32x32x32_bf16 v[144:159], v[40:43], v[80:87], v13
    ds_read_b64_tr_b16 v[54:55], v10 offset:320
    v_exp_f32 v99, v99
    v_exp_f32 v100, v100
    v_exp_f32 v101, v101
    v_exp_f32 v102, v102
    v_exp_f32 v103, v103
    v_mfma_f32_32x32x16_bf16 v[64:79], v[32:35], v[192:195], v[64:79]
    v_exp_f32 v104, v104
    v_exp_f32 v105, v105
    v_exp_f32 v106, v106
    v_smfmac_f32_32x32x32_bf16 v[144:159], v[44:47], v[88:95], v13
    v_exp_f32 v107, v107
    v_exp_f32 v108, v108
    v_exp_f32 v109, v109
    v_exp_f32 v110, v110
    v_exp_f32 v111, v111
    v_mfma_f32_32x32x8_bf16 v[80:95], v[38:39], v[210:211], 0
    s_sub_u32 s33, s31, 18432
    v_add_u32 v10, v10, v11
    v_exp_f32 v112, v112
    v_exp_f32 v113, v113
    v_exp_f32 v114, v114
    v_smfmac_f32_32x32x32_bf16 v[160:175], v[40:43], v[96:103], v13
    s_cmp_ge_u32 s30, 6
    ds_read_b64 v[28:29], v8 offset:12288
    v_exp_f32 v115, v115
    v_exp_f32 v116, v116
    v_exp_f32 v117, v117
    v_exp_f32 v118, v118
    v_exp_f32 v119, v119
    v_mfma_f32_32x32x16_bf16 v[80:95], v[32:35], v[196:199], v[80:95]
    s_cselect_b32 s18, 0, s18
    v_exp_f32 v120, v120
    v_exp_f32 v121, v121
    v_exp_f32 v122, v122
    v_smfmac_f32_32x32x32_bf16 v[160:175], v[44:47], v[104:111], v13
    s_cselect_b32 s29, 0x30000, s29
    s_barrier
    v_exp_f32 v123, v123
    v_exp_f32 v124, v124
    v_exp_f32 v125, v125
    v_exp_f32 v126, v126
    v_exp_f32 v127, v127
    v_mfma_f32_32x32x8_bf16 v[96:111], v[38:39], v[212:213], 0
    s_add_u32 s30, s30, 1
    ds_read_b64 v[30:31], v8 offset:12800
    v_exp_f32 v64, v64
    v_exp_f32 v65, v65
    v_exp_f32 v66, v66
    v_smfmac_f32_32x32x32_bf16 v[176:191], v[40:43], v[112:119], v13
    ds_read_b32 v36, v9 offset:12288
    v_exp_f32 v67, v67
    v_exp_f32 v68, v68
    v_exp_f32 v69, v69
    v_exp_f32 v70, v70
    v_exp_f32 v71, v71
    v_mfma_f32_32x32x16_bf16 v[96:111], v[32:35], v[200:203], v[96:111]
    s_add_u32 m0, s29, 0
    v_exp_f32 v72, v72
    v_exp_f32 v73, v73
    v_exp_f32 v74, v74
    v_smfmac_f32_32x32x32_bf16 v[176:191], v[44:47], v[120:127], v13
    buffer_load_dwordx4 v16, s[16:19], s28 offen sc1 lds
    v_exp_f32 v75, v75
    v_exp_f32 v76, v76
    v_exp_f32 v77, v77
    v_exp_f32 v78, v78
    v_exp_f32 v79, v79
    v_mfma_f32_32x32x8_bf16 v[112:127], v[38:39], v[214:215], 0
    s_waitcnt lgkmcnt(3)
    ds_read_b64_tr_b16 v[40:41], v10 offset:0
    v_exp_f32 v80, v80
    v_exp_f32 v81, v81
    v_exp_f32 v82, v82
    v_smfmac_f32_32x32x32_bf16 v[128:143], v[48:51], v[64:71], v13
    ds_read_b64_tr_b16 v[42:43], v10 offset:64
    v_exp_f32 v83, v83
    v_exp_f32 v84, v84
    v_exp_f32 v85, v85
    v_exp_f32 v86, v86
    v_exp_f32 v87, v87
    v_mfma_f32_32x32x16_bf16 v[112:127], v[32:35], v[204:207], v[112:127]
    s_add_u32 m0, s29, 4096
    v_exp_f32 v88, v88
    v_exp_f32 v89, v89
    v_exp_f32 v90, v90
    v_smfmac_f32_32x32x32_bf16 v[128:143], v[52:55], v[72:79], v13
    s_waitcnt lgkmcnt(2)
    buffer_load_dwordx4 v17, s[16:19], s28 offen sc1 lds
    v_exp_f32 v91, v91
    v_exp_f32 v92, v92
    v_exp_f32 v93, v93
    v_exp_f32 v94, v94
    v_exp_f32 v95, v95
    v_mfma_f32_32x32x8_bf16 v[64:79], v[36:37], v[208:209], 0
    ds_read_b64_tr_b16 v[44:45], v10 offset:256
    v_exp_f32 v96, v96
    v_exp_f32 v97, v97
    v_exp_f32 v98, v98
    v_smfmac_f32_32x32x32_bf16 v[144:159], v[48:51], v[80:87], v13
    ds_read_b64_tr_b16 v[46:47], v10 offset:320
    v_exp_f32 v99, v99
    v_exp_f32 v100, v100
    v_exp_f32 v101, v101
    v_exp_f32 v102, v102
    v_exp_f32 v103, v103
    v_mfma_f32_32x32x16_bf16 v[64:79], v[28:31], v[192:195], v[64:79]
    v_exp_f32 v104, v104
    v_exp_f32 v105, v105
    v_exp_f32 v106, v106
    v_smfmac_f32_32x32x32_bf16 v[144:159], v[52:55], v[88:95], v13
    v_exp_f32 v107, v107
    v_exp_f32 v108, v108
    v_exp_f32 v109, v109
    v_exp_f32 v110, v110
    v_exp_f32 v111, v111
    v_mfma_f32_32x32x8_bf16 v[80:95], v[36:37], v[210:211], 0
    v_add_u32 v10, v10, v11
    v_exp_f32 v112, v112
    v_exp_f32 v113, v113
    v_exp_f32 v114, v114
    v_smfmac_f32_32x32x32_bf16 v[160:175], v[48:51], v[96:103], v13
    ds_read_b64 v[32:33], v8 offset:18432
    v_exp_f32 v115, v115
    v_exp_f32 v116, v116
    v_exp_f32 v117, v117
    v_exp_f32 v118, v118
    v_exp_f32 v119, v119
    v_mfma_f32_32x32x16_bf16 v[80:95], v[28:31], v[196:199], v[80:95]
    s_add_u32 m0, s29, 8192
    v_exp_f32 v120, v120
    v_exp_f32 v121, v121
    v_exp_f32 v122, v122
    v_smfmac_f32_32x32x32_bf16 v[160:175], v[52:55], v[104:111], v13
    v_and_b32 v14, s33, v12
    buffer_load_dwordx4 v18, s[16:19], s28 offen sc1 lds
    v_exp_f32 v123, v123
    v_exp_f32 v124, v124
    v_exp_f32 v125, v125
    v_exp_f32 v126, v126
    v_exp_f32 v127, v127
    v_mfma_f32_32x32x8_bf16 v[96:111], v[36:37], v[212:213], 0
    ds_read_b64 v[34:35], v8 offset:18944
    v_exp_f32 v64, v64
    v_exp_f32 v65, v65
    v_exp_f32 v66, v66
    v_smfmac_f32_32x32x32_bf16 v[176:191], v[48:51], v[112:119], v13
    ds_read_b32 v38, v9 offset:18432
    v_exp_f32 v67, v67
    v_exp_f32 v68, v68
    v_exp_f32 v69, v69
    v_exp_f32 v70, v70
    v_exp_f32 v71, v71
    v_mfma_f32_32x32x16_bf16 v[96:111], v[28:31], v[200:203], v[96:111]
    s_add_u32 m0, s29, 12288
    s_waitcnt vmcnt(3)
    v_exp_f32 v72, v72
    v_exp_f32 v73, v73
    v_exp_f32 v74, v74
    v_smfmac_f32_32x32x32_bf16 v[176:191], v[52:55], v[120:127], v13
    s_barrier
    buffer_load_dwordx4 v19, s[16:19], s28 offen sc1 lds
    v_exp_f32 v75, v75
    v_exp_f32 v76, v76
    v_exp_f32 v77, v77
    v_exp_f32 v78, v78
    v_exp_f32 v79, v79
    v_mfma_f32_32x32x8_bf16 v[112:127], v[36:37], v[214:215], 0
    s_waitcnt lgkmcnt(3)
    ds_read_b64_tr_b16 v[48:49], v10 offset:0
    v_exp_f32 v80, v80
    v_exp_f32 v81, v81
    v_exp_f32 v82, v82
    v_smfmac_f32_32x32x32_bf16 v[128:143], v[40:43], v[64:71], v13
    ds_read_b64_tr_b16 v[50:51], v10 offset:64
    v_exp_f32 v83, v83
    v_exp_f32 v84, v84
    v_exp_f32 v85, v85
    v_exp_f32 v86, v86
    v_exp_f32 v87, v87
    v_mfma_f32_32x32x16_bf16 v[112:127], v[28:31], v[204:207], v[112:127]
    s_add_u32 m0, s29, 16384
    v_exp_f32 v88, v88
    v_exp_f32 v89, v89
    v_exp_f32 v90, v90
    v_smfmac_f32_32x32x32_bf16 v[128:143], v[44:47], v[72:79], v13
    s_waitcnt lgkmcnt(2)
    buffer_load_dwordx4 v20, s[16:19], s28 offen sc1 lds
    v_exp_f32 v91, v91
    v_exp_f32 v92, v92
    v_exp_f32 v93, v93
    v_exp_f32 v94, v94
    v_exp_f32 v95, v95
    v_mfma_f32_32x32x8_bf16 v[64:79], v[38:39], v[208:209], 0
    ds_read_b64_tr_b16 v[52:53], v10 offset:256
    v_exp_f32 v96, v96
    v_exp_f32 v97, v97
    v_exp_f32 v98, v98
    v_smfmac_f32_32x32x32_bf16 v[144:159], v[40:43], v[80:87], v13
    ds_read_b64_tr_b16 v[54:55], v10 offset:320
    v_exp_f32 v99, v99
    v_exp_f32 v100, v100
    v_exp_f32 v101, v101
    v_exp_f32 v102, v102
    v_exp_f32 v103, v103
    v_mfma_f32_32x32x16_bf16 v[64:79], v[32:35], v[192:195], v[64:79]
    v_exp_f32 v104, v104
    v_exp_f32 v105, v105
    v_exp_f32 v106, v106
    v_smfmac_f32_32x32x32_bf16 v[144:159], v[44:47], v[88:95], v13
    v_exp_f32 v107, v107
    v_exp_f32 v108, v108
    v_exp_f32 v109, v109
    v_exp_f32 v110, v110
    v_exp_f32 v111, v111
    v_mfma_f32_32x32x8_bf16 v[80:95], v[38:39], v[210:211], 0
    v_add_u32 v10, v10, v14
    v_add_u32 v8, s31, v8
    v_exp_f32 v112, v112
    v_exp_f32 v113, v113
    v_exp_f32 v114, v114
    v_smfmac_f32_32x32x32_bf16 v[160:175], v[40:43], v[96:103], v13
    ds_read_b64 v[28:29], v8 offset:0
    v_exp_f32 v115, v115
    v_exp_f32 v116, v116
    v_exp_f32 v117, v117
    v_exp_f32 v118, v118
    v_exp_f32 v119, v119
    v_mfma_f32_32x32x16_bf16 v[80:95], v[32:35], v[196:199], v[80:95]
    s_add_u32 m0, s29, 20480
    v_exp_f32 v120, v120
    v_exp_f32 v121, v121
    v_exp_f32 v122, v122
    v_smfmac_f32_32x32x32_bf16 v[160:175], v[44:47], v[104:111], v13
    v_add_u32 v9, s31, v9
    buffer_load_dwordx4 v21, s[16:19], s28 offen sc1 lds
    v_exp_f32 v123, v123
    v_exp_f32 v124, v124
    v_exp_f32 v125, v125
    v_exp_f32 v126, v126
    v_exp_f32 v127, v127
    v_mfma_f32_32x32x8_bf16 v[96:111], v[38:39], v[212:213], 0
    ds_read_b64 v[30:31], v8 offset:512
    v_exp_f32 v64, v64
    v_exp_f32 v65, v65
    v_exp_f32 v66, v66
    v_smfmac_f32_32x32x32_bf16 v[176:191], v[40:43], v[112:119], v13
    ds_read_b32 v36, v9 offset:0
    v_exp_f32 v67, v67
    v_exp_f32 v68, v68
    v_exp_f32 v69, v69
    v_exp_f32 v70, v70
    v_exp_f32 v71, v71
    v_mfma_f32_32x32x16_bf16 v[96:111], v[32:35], v[200:203], v[96:111]
    v_exp_f32 v72, v72
    v_exp_f32 v73, v73
    v_exp_f32 v74, v74
    v_smfmac_f32_32x32x32_bf16 v[176:191], v[44:47], v[120:127], v13
    s_barrier
    v_exp_f32 v75, v75
    v_exp_f32 v76, v76
    v_exp_f32 v77, v77
    v_exp_f32 v78, v78
    v_exp_f32 v79, v79
    v_mfma_f32_32x32x8_bf16 v[112:127], v[38:39], v[214:215], 0
    s_waitcnt lgkmcnt(3)
    ds_read_b64_tr_b16 v[40:41], v10 offset:0
    v_exp_f32 v80, v80
    v_exp_f32 v81, v81
    v_exp_f32 v82, v82
    v_smfmac_f32_32x32x32_bf16 v[128:143], v[48:51], v[64:71], v13
    ds_read_b64_tr_b16 v[42:43], v10 offset:64
    v_exp_f32 v83, v83
    v_exp_f32 v84, v84
    v_exp_f32 v85, v85
    v_exp_f32 v86, v86
    v_exp_f32 v87, v87
    v_mfma_f32_32x32x16_bf16 v[112:127], v[32:35], v[204:207], v[112:127]
    v_exp_f32 v88, v88
    v_exp_f32 v89, v89
    v_exp_f32 v90, v90
    v_smfmac_f32_32x32x32_bf16 v[128:143], v[52:55], v[72:79], v13
    s_waitcnt lgkmcnt(2)
    v_exp_f32 v91, v91
    v_exp_f32 v92, v92
    v_exp_f32 v93, v93
    v_exp_f32 v94, v94
    v_exp_f32 v95, v95
    v_mfma_f32_32x32x8_bf16 v[64:79], v[36:37], v[208:209], 0
    ds_read_b64_tr_b16 v[44:45], v10 offset:256
    v_exp_f32 v96, v96
    v_exp_f32 v97, v97
    v_exp_f32 v98, v98
    v_smfmac_f32_32x32x32_bf16 v[144:159], v[48:51], v[80:87], v13
    ds_read_b64_tr_b16 v[46:47], v10 offset:320
    v_exp_f32 v99, v99
    v_exp_f32 v100, v100
    v_exp_f32 v101, v101
    v_exp_f32 v102, v102
    v_exp_f32 v103, v103
    v_mfma_f32_32x32x16_bf16 v[64:79], v[28:31], v[192:195], v[64:79]
    v_exp_f32 v104, v104
    v_exp_f32 v105, v105
    v_exp_f32 v106, v106
    v_smfmac_f32_32x32x32_bf16 v[144:159], v[52:55], v[88:95], v13
    v_exp_f32 v107, v107
    v_exp_f32 v108, v108
    v_exp_f32 v109, v109
    v_exp_f32 v110, v110
    v_exp_f32 v111, v111
    v_mfma_f32_32x32x8_bf16 v[80:95], v[36:37], v[210:211], 0
    s_add_u32 s28, s28, s51
    v_add_u32 v10, v10, v11
    v_exp_f32 v112, v112
    v_exp_f32 v113, v113
    v_exp_f32 v114, v114
    v_smfmac_f32_32x32x32_bf16 v[160:175], v[48:51], v[96:103], v13
    s_add_u32 s29, s29, s57
    ds_read_b64 v[32:33], v8 offset:6144
    v_exp_f32 v115, v115
    v_exp_f32 v116, v116
    v_exp_f32 v117, v117
    v_exp_f32 v118, v118
    v_exp_f32 v119, v119
    v_mfma_f32_32x32x16_bf16 v[80:95], v[28:31], v[196:199], v[80:95]
    s_mov_b32 s57, s31
    v_exp_f32 v120, v120
    v_exp_f32 v121, v121
    v_exp_f32 v122, v122
    v_smfmac_f32_32x32x32_bf16 v[160:175], v[52:55], v[104:111], v13
    s_cmp_lt_u32 s30, 8
    v_exp_f32 v123, v123
    v_exp_f32 v124, v124
    v_exp_f32 v125, v125
    v_exp_f32 v126, v126
    v_exp_f32 v127, v127
    s_cbranch_scc1 K2_ALOOP
    s_nop 0
    v_smfmac_f32_32x32x32_bf16 v[176:191], v[48:51], v[112:119], v13
    v_smfmac_f32_32x32x32_bf16 v[176:191], v[52:55], v[120:127], v13
    v_cndmask_b32 v136, v138, v136, s[42:43]
    v_cndmask_b32 v137, v139, v137, s[42:43]
    v_mov_b32 v138, v140
    v_cndmask_b32 v152, v154, v152, s[42:43]
    v_cndmask_b32 v153, v155, v153, s[42:43]
    v_mov_b32 v154, v156
    v_cndmask_b32 v168, v170, v168, s[42:43]
    v_cndmask_b32 v169, v171, v169, s[42:43]
    v_mov_b32 v170, v172
    ds_write_b128 v24, v[160:163] offset:0
    ds_write_b128 v24, v[164:167] offset:1024
    ds_write_b128 v24, v[168:171] offset:2048
    v_cndmask_b32 v184, v186, v184, s[42:43]
    v_cndmask_b32 v185, v187, v185, s[42:43]
    v_mov_b32 v186, v188
    ds_write_b128 v24, v[176:179] offset:3072
    ds_write_b128 v24, v[180:183] offset:4096
    ds_write_b128 v24, v[184:187] offset:5120
    s_waitcnt lgkmcnt(0)
    s_barrier
    ds_read_b128 v[72:75], v25 offset:2048
    ds_read_b128 v[64:67], v25 offset:0
    ds_read_b128 v[68:71], v25 offset:1024
    ds_read_b128 v[88:91], v25 offset:5120
    ds_read_b128 v[80:83], v25 offset:3072
    ds_read_b128 v[84:87], v25 offset:4096
    s_waitcnt lgkmcnt(3)
    v_add_f32 v138, v138, v74
    v_add_f32 v128, v128, v64
    v_add_f32 v129, v129, v65
    v_add_f32 v130, v130, v66
    v_add_f32 v131, v131, v67
    v_add_f32 v132, v132, v68
    v_add_f32 v133, v133, v69
    v_add_f32 v134, v134, v70
    v_add_f32 v135, v135, v71
    v_add_f32 v136, v136, v72
    v_add_f32 v137, v137, v73
    v_maximum3_f32 v14, |v128|, |v129|, |v130|
    v_maximum3_f32 v56, |v131|, |v132|, |v133|
    v_maximum3_f32 v14, v14, |v134|, |v135|
    v_maximum3_f32 v56, v56, |v136|, |v137|
    v_mul_f32 v57, 0x1f800000, v138
    v_maximum3_f32 v14, v14, v56, v57
    v_cmp_nlt_f32 s[44:45], 0, v138
    s_waitcnt lgkmcnt(0)
    v_add_f32 v154, v154, v90
    v_add_f32 v144, v144, v80
    v_add_f32 v145, v145, v81
    v_add_f32 v146, v146, v82
    v_add_f32 v147, v147, v83
    v_add_f32 v148, v148, v84
    v_add_f32 v149, v149, v85
    v_add_f32 v150, v150, v86
    v_add_f32 v151, v151, v87
    v_add_f32 v152, v152, v88
    v_add_f32 v153, v153, v89
    v_maximum3_f32 v15, |v144|, |v145|, |v146|
    v_maximum3_f32 v56, |v147|, |v148|, |v149|
    v_maximum3_f32 v15, v15, |v150|, |v151|
    v_maximum3_f32 v56, v56, |v152|, |v153|
    v_mul_f32 v57, 0x1f800000, v154
    v_maximum3_f32 v15, v15, v56, v57
    v_cmp_nlt_f32 s[46:47], 0, v154
    v_maximum3_f32 v56, v14, v15, v15
    v_min_f32 v57, v14, v15
    s_or_b64 s[44:45], s[44:45], s[46:47]
    v_cmp_ngt_f32 vcc, 0x7f800000, v56
    s_nop 0
    s_or_b64 s[44:45], s[44:45], vcc
    v_cmp_gt_f32 vcc, 0xb800000, v57
    s_nop 0
    s_or_b64 vcc, vcc, s[44:45]
    s_cbranch_scc1 K2_AFALL
K2_AOUT:
    s_barrier
    v_rsq_f32 v138, v138
    v_rsq_f32 v154, v154
    s_nop 0
    v_mul_f32 v139, v138, v22
    v_mul_f32 v155, v154, v23
    v_mul_f32 v128, v128, v138
    v_mul_f32 v129, v129, v138
    v_mul_f32 v130, v130, v138
    v_mul_f32 v131, v131, v138
    v_mul_f32 v132, v132, v138
    v_mul_f32 v133, v133, v138
    v_mul_f32 v134, v134, v138
    v_mul_f32 v135, v135, v138
    v_mul_f32 v136, v136, v138
    v_mul_f32 v137, v137, v138
    v_mul_f32 v128, v128, v139
    v_mul_f32 v129, v129, v139
    v_mul_f32 v130, v130, v139
    v_mul_f32 v131, v131, v139
    v_mul_f32 v132, v132, v139
    v_mul_f32 v133, v133, v139
    v_mul_f32 v134, v134, v139
    v_mul_f32 v135, v135, v139
    v_mul_f32 v136, v136, v139
    v_mul_f32 v137, v137, v139
    v_cvt_pk_bf16_f32 v128, v128, v129
    v_cvt_pk_bf16_f32 v129, v130, v131
    v_cvt_pk_bf16_f32 v130, v132, v133
    v_cvt_pk_bf16_f32 v131, v134, v135
    v_cvt_pk_bf16_f32 v132, v136, v137
    buffer_store_dwordx4 v[128:131], v7, s[20:23], s36 offen sc1
    buffer_store_dword v132, v26, s[20:23], s38 offen sc1
    v_mul_f32 v144, v144, v154
    v_mul_f32 v145, v145, v154
    v_mul_f32 v146, v146, v154
    v_mul_f32 v147, v147, v154
    v_mul_f32 v148, v148, v154
    v_mul_f32 v149, v149, v154
    v_mul_f32 v150, v150, v154
    v_mul_f32 v151, v151, v154
    v_mul_f32 v152, v152, v154
    v_mul_f32 v153, v153, v154
    v_mul_f32 v144, v144, v155
    v_mul_f32 v145, v145, v155
    v_mul_f32 v146, v146, v155
    v_mul_f32 v147, v147, v155
    v_mul_f32 v148, v148, v155
    v_mul_f32 v149, v149, v155
    v_mul_f32 v150, v150, v155
    v_mul_f32 v151, v151, v155
    v_mul_f32 v152, v152, v155
    v_mul_f32 v153, v153, v155
    v_cvt_pk_bf16_f32 v144, v144, v145
    v_cvt_pk_bf16_f32 v145, v146, v147
    v_cvt_pk_bf16_f32 v146, v148, v149
    v_cvt_pk_bf16_f32 v147, v150, v151
    v_cvt_pk_bf16_f32 v148, v152, v153
    buffer_store_dwordx4 v[144:147], v7, s[20:23], s37 offen sc1
    buffer_store_dword v148, v26, s[20:23], s39 offen sc1
    s_barrier
    s_waitcnt vmcnt(0)
    buffer_store_dword v61, v27, s[20:23], s58 offen sc1
    s_or_b32 s33, s15, s24
    s_cmp_lg_u32 s33, 0
    s_cbranch_scc1 KA_NZ
    v_mov_b32 v14, 0
    s_mov_b64 exec, 1
    global_store_dword v14, v14, s[48:49] sc1
    s_mov_b64 exec, -1
KA_NZ:
    s_barrier
    s_barrier
    s_barrier
K_EXIT:
    s_endpgm
K1_X01:
    v_mfma_f32_16x16x32_bf16 v[176:179], v[224:227], v[0:3], 0
    ds_read_b64_tr_b16 v[240:241], v248 offset:4096
    ds_read_b64_tr_b16 v[242:243], v248 offset:4608
    v_mfma_f32_16x16x32_bf16 v[180:183], v[224:227], v[4:7], 0
    s_waitcnt lgkmcnt(6)
    v_mfma_f32_16x16x32_bf16 v[184:187], v[228:231], v[0:3], 0
    ds_read_b64_tr_b16 v[244:245], v249 offset:4096
    ds_read_b64_tr_b16 v[246:247], v249 offset:4608
    v_mfma_f32_16x16x32_bf16 v[188:191], v[228:231], v[4:7], 0
    s_waitcnt lgkmcnt(6)
    v_mfma_f32_16x16x32_bf16 v[192:195], v[232:235], v[0:3], 0
    ds_read_b64_tr_b16 v[224:225], v250 offset:4096
    ds_read_b64_tr_b16 v[226:227], v250 offset:4608
    v_mfma_f32_16x16x32_bf16 v[196:199], v[232:235], v[4:7], 0
    s_waitcnt lgkmcnt(6)
    v_mfma_f32_16x16x32_bf16 v[200:203], v[236:239], v[0:3], 0
    ds_read_b64_tr_b16 v[228:229], v251 offset:4096
    ds_read_b64_tr_b16 v[230:231], v251 offset:4608
    v_mfma_f32_16x16x32_bf16 v[204:207], v[236:239], v[4:7], 0
    s_waitcnt lgkmcnt(6)
    s_mov_b32 s34, 0xbf317218
    v_mfma_f32_16x16x32_bf16 v[176:179], v[240:243], v[8:11], v[176:179]
    ds_read_b64_tr_b16 v[232:233], v248 offset:8192
    ds_read_b64_tr_b16 v[234:235], v248 offset:8704
    v_mfma_f32_16x16x32_bf16 v[180:183], v[240:243], v[12:15], v[180:183]
    s_waitcnt lgkmcnt(6)
    s_cmp_lt_u32 s43, 9
    s_cselect_b32 s33, 0xbe715bef, s34
    v_mfma_f32_16x16x32_bf16 v[184:187], v[244:247], v[8:11], v[184:187]
    ds_read_b64_tr_b16 v[236:237], v249 offset:8192
    ds_read_b64_tr_b16 v[238:239], v249 offset:8704
    v_mfma_f32_16x16x32_bf16 v[188:191], v[244:247], v[12:15], v[188:191]
    s_waitcnt lgkmcnt(6)
    v_mfma_f32_16x16x32_bf16 v[192:195], v[224:227], v[8:11], v[192:195]
    ds_read_b64_tr_b16 v[240:241], v250 offset:8192
    v_mfma_f32_16x16x32_bf16 v[196:199], v[224:227], v[12:15], v[196:199]
    s_waitcnt lgkmcnt(5)
    ds_read_b64_tr_b16 v[242:243], v250 offset:8704
    v_mul_f32 v218, s33, v252
    v_mfma_f32_16x16x32_bf16 v[200:203], v[228:231], v[8:11], v[200:203]
    ds_read_b64_tr_b16 v[244:245], v251 offset:8192
    v_mfma_f32_16x16x32_bf16 v[204:207], v[228:231], v[12:15], v[204:207]
    s_waitcnt lgkmcnt(5)
    ds_read_b64_tr_b16 v[246:247], v251 offset:8704
    v_mul_f32 v219, s33, v253
    v_mfma_f32_16x16x32_bf16 v[176:179], v[232:235], v[16:19], v[176:179]
    ds_read_b64_tr_b16 v[224:225], v248 offset:12288
    v_mfma_f32_16x16x32_bf16 v[180:183], v[232:235], v[20:23], v[180:183]
    s_waitcnt lgkmcnt(5)
    ds_read_b64_tr_b16 v[226:227], v248 offset:12800
    v_mul_f32 v144, v144, v218
    v_mfma_f32_16x16x32_bf16 v[184:187], v[236:239], v[16:19], v[184:187]
    ds_read_b64_tr_b16 v[228:229], v249 offset:12288
    v_mfma_f32_16x16x32_bf16 v[188:191], v[236:239], v[20:23], v[188:191]
    s_waitcnt lgkmcnt(5)
    ds_read_b64_tr_b16 v[230:231], v249 offset:12800
    v_mul_f32 v145, v145, v218
    v_mfma_f32_16x16x32_bf16 v[192:195], v[240:243], v[16:19], v[192:195]
    ds_read_b64_tr_b16 v[232:233], v250 offset:12288
    v_mfma_f32_16x16x32_bf16 v[196:199], v[240:243], v[20:23], v[196:199]
    s_waitcnt lgkmcnt(5)
    ds_read_b64_tr_b16 v[234:235], v250 offset:12800
    v_mul_f32 v146, v146, v218
    v_mfma_f32_16x16x32_bf16 v[200:203], v[244:247], v[16:19], v[200:203]
    ds_read_b64_tr_b16 v[236:237], v251 offset:12288
    v_mfma_f32_16x16x32_bf16 v[204:207], v[244:247], v[20:23], v[204:207]
    s_waitcnt lgkmcnt(5)
    ds_read_b64_tr_b16 v[238:239], v251 offset:12800
    v_mul_f32 v147, v147, v218
    v_mfma_f32_16x16x32_bf16 v[176:179], v[224:227], v[24:27], v[176:179]
    ds_read_b64_tr_b16 v[240:241], v248 offset:16384
    v_mfma_f32_16x16x32_bf16 v[180:183], v[224:227], v[28:31], v[180:183]
    s_waitcnt lgkmcnt(5)
    ds_read_b64_tr_b16 v[242:243], v248 offset:16896
    v_mul_f32 v148, v148, v219
    v_mfma_f32_16x16x32_bf16 v[184:187], v[228:231], v[24:27], v[184:187]
    ds_read_b64_tr_b16 v[244:245], v249 offset:16384
    v_mfma_f32_16x16x32_bf16 v[188:191], v[228:231], v[28:31], v[188:191]
    s_waitcnt lgkmcnt(5)
    ds_read_b64_tr_b16 v[246:247], v249 offset:16896
    v_mul_f32 v149, v149, v219
    v_mfma_f32_16x16x32_bf16 v[192:195], v[232:235], v[24:27], v[192:195]
    ds_read_b64_tr_b16 v[224:225], v250 offset:16384
    v_mfma_f32_16x16x32_bf16 v[196:199], v[232:235], v[28:31], v[196:199]
    s_waitcnt lgkmcnt(5)
    ds_read_b64_tr_b16 v[226:227], v250 offset:16896
    v_mul_f32 v150, v150, v219
    v_mfma_f32_16x16x32_bf16 v[200:203], v[236:239], v[24:27], v[200:203]
    ds_read_b64_tr_b16 v[228:229], v251 offset:16384
    v_mfma_f32_16x16x32_bf16 v[204:207], v[236:239], v[28:31], v[204:207]
    s_waitcnt lgkmcnt(5)
    ds_read_b64_tr_b16 v[230:231], v251 offset:16896
    v_mul_f32 v151, v151, v219
    v_mfma_f32_16x16x32_bf16 v[176:179], v[240:243], v[32:35], v[176:179]
    ds_read_b64_tr_b16 v[232:233], v248 offset:20480
    v_mfma_f32_16x16x32_bf16 v[180:183], v[240:243], v[36:39], v[180:183]
    s_waitcnt lgkmcnt(5)
    ds_read_b64_tr_b16 v[234:235], v248 offset:20992
    v_cvt_pk_bf16_f32 v144, v144, v145
    v_mfma_f32_16x16x32_bf16 v[184:187], v[244:247], v[32:35], v[184:187]
    ds_read_b64_tr_b16 v[236:237], v249 offset:20480
    v_mfma_f32_16x16x32_bf16 v[188:191], v[244:247], v[36:39], v[188:191]
    s_waitcnt lgkmcnt(5)
    ds_read_b64_tr_b16 v[238:239], v249 offset:20992
    v_cvt_pk_bf16_f32 v145, v146, v147
    v_mfma_f32_16x16x32_bf16 v[192:195], v[224:227], v[32:35], v[192:195]
    ds_read_b64_tr_b16 v[240:241], v250 offset:20480
    v_mfma_f32_16x16x32_bf16 v[196:199], v[224:227], v[36:39], v[196:199]
    s_waitcnt lgkmcnt(5)
    ds_read_b64_tr_b16 v[242:243], v250 offset:20992
    v_cvt_pk_bf16_f32 v146, v148, v149
    v_mfma_f32_16x16x32_bf16 v[200:203], v[228:231], v[32:35], v[200:203]
    ds_read_b64_tr_b16 v[244:245], v251 offset:20480
    v_mfma_f32_16x16x32_bf16 v[204:207], v[228:231], v[36:39], v[204:207]
    s_waitcnt lgkmcnt(5)
    ds_read_b64_tr_b16 v[246:247], v251 offset:20992
    v_cvt_pk_bf16_f32 v147, v150, v151
    v_mfma_f32_16x16x32_bf16 v[176:179], v[232:235], v[40:43], v[176:179]
    s_barrier
    ds_read_b64_tr_b16 v[224:225], v248 offset:24576
    v_mfma_f32_16x16x32_bf16 v[180:183], v[232:235], v[44:47], v[180:183]
    s_waitcnt lgkmcnt(5)
    ds_read_b64_tr_b16 v[226:227], v248 offset:25088
    v_mul_f32 v152, v152, v218
    v_mfma_f32_16x16x32_bf16 v[184:187], v[236:239], v[40:43], v[184:187]
    ds_read_b64_tr_b16 v[228:229], v249 offset:24576
    v_mfma_f32_16x16x32_bf16 v[188:191], v[236:239], v[44:47], v[188:191]
    s_waitcnt lgkmcnt(5)
    ds_read_b64_tr_b16 v[230:231], v249 offset:25088
    v_mul_f32 v153, v153, v218
    v_mfma_f32_16x16x32_bf16 v[192:195], v[240:243], v[40:43], v[192:195]
    ds_read_b64_tr_b16 v[232:233], v250 offset:24576
    v_mfma_f32_16x16x32_bf16 v[196:199], v[240:243], v[44:47], v[196:199]
    s_waitcnt lgkmcnt(5)
    ds_read_b64_tr_b16 v[234:235], v250 offset:25088
    v_mul_f32 v154, v154, v218
    v_mfma_f32_16x16x32_bf16 v[200:203], v[244:247], v[40:43], v[200:203]
    ds_read_b64_tr_b16 v[236:237], v251 offset:24576
    v_mfma_f32_16x16x32_bf16 v[204:207], v[244:247], v[44:47], v[204:207]
    s_waitcnt lgkmcnt(5)
    ds_read_b64_tr_b16 v[238:239], v251 offset:25088
    v_mul_f32 v155, v155, v218
    v_mfma_f32_16x16x32_bf16 v[176:179], v[224:227], v[48:51], v[176:179]
    ds_read_b64_tr_b16 v[240:241], v248 offset:28672
    v_mfma_f32_16x16x32_bf16 v[180:183], v[224:227], v[52:55], v[180:183]
    s_waitcnt lgkmcnt(5)
    ds_read_b64_tr_b16 v[242:243], v248 offset:29184
    v_permlane16_swap_b32 v144, v146
    v_mfma_f32_16x16x32_bf16 v[184:187], v[228:231], v[48:51], v[184:187]
    ds_read_b64_tr_b16 v[244:245], v249 offset:28672
    v_mfma_f32_16x16x32_bf16 v[188:191], v[228:231], v[52:55], v[188:191]
    s_waitcnt lgkmcnt(5)
    ds_read_b64_tr_b16 v[246:247], v249 offset:29184
    v_permlane16_swap_b32 v145, v147
    v_mfma_f32_16x16x32_bf16 v[192:195], v[232:235], v[48:51], v[192:195]
    ds_read_b64_tr_b16 v[224:225], v250 offset:28672
    ds_read_b64_tr_b16 v[226:227], v250 offset:29184
    v_mfma_f32_16x16x32_bf16 v[196:199], v[232:235], v[52:55], v[196:199]
    s_waitcnt lgkmcnt(6)
    buffer_store_dwordx4 v[144:147], v254, s[20:23], s42 offen offset:0 sc1
    v_mfma_f32_16x16x32_bf16 v[200:203], v[236:239], v[48:51], v[200:203]
    ds_read_b64_tr_b16 v[228:229], v251 offset:28672
    v_mfma_f32_16x16x32_bf16 v[204:207], v[236:239], v[52:55], v[204:207]
    s_waitcnt lgkmcnt(5)
    ds_read_b64_tr_b16 v[230:231], v251 offset:29184
    v_mul_f32 v156, v156, v219
    v_mfma_f32_16x16x32_bf16 v[176:179], v[240:243], v[56:59], v[176:179]
    ds_read_b64_tr_b16 v[232:233], v248 offset:32768
    ds_read_b64_tr_b16 v[234:235], v248 offset:33280
    v_mfma_f32_16x16x32_bf16 v[180:183], v[240:243], v[60:63], v[180:183]
    s_waitcnt lgkmcnt(6)
    v_mul_f32 v157, v157, v219
    v_add_u32 v248, 36864, v248
    v_mfma_f32_16x16x32_bf16 v[184:187], v[244:247], v[56:59], v[184:187]
    ds_read_b64_tr_b16 v[236:237], v249 offset:32768
    ds_read_b64_tr_b16 v[238:239], v249 offset:33280
    v_mfma_f32_16x16x32_bf16 v[188:191], v[244:247], v[60:63], v[188:191]
    s_waitcnt lgkmcnt(6)
    v_mul_f32 v158, v158, v219
    v_add_u32 v249, 36864, v249
    v_mfma_f32_16x16x32_bf16 v[192:195], v[224:227], v[56:59], v[192:195]
    ds_read_b64_tr_b16 v[240:241], v250 offset:32768
    ds_read_b64_tr_b16 v[242:243], v250 offset:33280
    v_mfma_f32_16x16x32_bf16 v[196:199], v[224:227], v[60:63], v[196:199]
    s_waitcnt lgkmcnt(6)
    v_mul_f32 v159, v159, v219
    v_add_u32 v250, 36864, v250
    v_mfma_f32_16x16x32_bf16 v[200:203], v[228:231], v[56:59], v[200:203]
    ds_read_b64_tr_b16 v[244:245], v251 offset:32768
    ds_read_b64_tr_b16 v[246:247], v251 offset:33280
    v_mfma_f32_16x16x32_bf16 v[204:207], v[228:231], v[60:63], v[204:207]
    s_waitcnt lgkmcnt(6)
    v_cvt_pk_bf16_f32 v152, v152, v153
    v_add_u32 v251, 36864, v251
    v_mfma_f32_16x16x32_bf16 v[176:179], v[232:235], v[64:67], v[176:179]
    ds_read_b64_tr_b16 v[224:225], v248 offset:0
    v_mfma_f32_16x16x32_bf16 v[180:183], v[232:235], v[68:71], v[180:183]
    s_waitcnt lgkmcnt(5)
    ds_read_b64_tr_b16 v[226:227], v248 offset:512
    v_cvt_pk_bf16_f32 v153, v154, v155
    v_mfma_f32_16x16x32_bf16 v[184:187], v[236:239], v[64:67], v[184:187]
    ds_read_b64_tr_b16 v[228:229], v249 offset:0
    v_mfma_f32_16x16x32_bf16 v[188:191], v[236:239], v[68:71], v[188:191]
    s_waitcnt lgkmcnt(5)
    ds_read_b64_tr_b16 v[230:231], v249 offset:512
    v_cvt_pk_bf16_f32 v154, v156, v157
    v_mfma_f32_16x16x32_bf16 v[192:195], v[240:243], v[64:67], v[192:195]
    ds_read_b64_tr_b16 v[232:233], v250 offset:0
    v_mfma_f32_16x16x32_bf16 v[196:199], v[240:243], v[68:71], v[196:199]
    s_waitcnt lgkmcnt(5)
    ds_read_b64_tr_b16 v[234:235], v250 offset:512
    v_cvt_pk_bf16_f32 v155, v158, v159
    v_mfma_f32_16x16x32_bf16 v[200:203], v[244:247], v[64:67], v[200:203]
    ds_read_b64_tr_b16 v[236:237], v251 offset:0
    v_mfma_f32_16x16x32_bf16 v[204:207], v[244:247], v[68:71], v[204:207]
    s_waitcnt lgkmcnt(5)
    ds_read_b64_tr_b16 v[238:239], v251 offset:512
    v_mul_f32 v160, v160, v218
    v_mfma_f32_16x16x32_bf16 v[176:179], v[224:227], v[72:75], v[176:179]
    ds_read_b64_tr_b16 v[240:241], v248 offset:4096
    ds_read_b64_tr_b16 v[242:243], v248 offset:4608
    v_mfma_f32_16x16x32_bf16 v[180:183], v[224:227], v[76:79], v[180:183]
    s_waitcnt lgkmcnt(6)
    v_mul_f32 v161, v161, v218
    v_mul_f32 v162, v162, v218
    v_mfma_f32_16x16x32_bf16 v[184:187], v[228:231], v[72:75], v[184:187]
    ds_read_b64_tr_b16 v[244:245], v249 offset:4096
    v_mfma_f32_16x16x32_bf16 v[188:191], v[228:231], v[76:79], v[188:191]
    s_waitcnt lgkmcnt(5)
    ds_read_b64_tr_b16 v[246:247], v249 offset:4608
    v_mul_f32 v163, v163, v218
    v_mfma_f32_16x16x32_bf16 v[192:195], v[232:235], v[72:75], v[192:195]
    ds_read_b64_tr_b16 v[224:225], v250 offset:4096
    v_mfma_f32_16x16x32_bf16 v[196:199], v[232:235], v[76:79], v[196:199]
    s_waitcnt lgkmcnt(5)
    ds_read_b64_tr_b16 v[226:227], v250 offset:4608
    v_permlane16_swap_b32 v152, v154
    v_mfma_f32_16x16x32_bf16 v[200:203], v[236:239], v[72:75], v[200:203]
    ds_read_b64_tr_b16 v[228:229], v251 offset:4096
    v_mfma_f32_16x16x32_bf16 v[204:207], v[236:239], v[76:79], v[204:207]
    s_waitcnt lgkmcnt(5)
    ds_read_b64_tr_b16 v[230:231], v251 offset:4608
    v_permlane16_swap_b32 v153, v155
    v_mfma_f32_16x16x32_bf16 v[176:179], v[240:243], v[80:83], v[176:179]
    ds_read_b64_tr_b16 v[232:233], v248 offset:8192
    ds_read_b64_tr_b16 v[234:235], v248 offset:8704
    v_mfma_f32_16x16x32_bf16 v[180:183], v[240:243], v[84:87], v[180:183]
    s_waitcnt lgkmcnt(6)
    buffer_store_dwordx4 v[152:155], v254, s[20:23], s42 offen offset:1024 sc1
    v_mfma_f32_16x16x32_bf16 v[184:187], v[244:247], v[80:83], v[184:187]
    ds_read_b64_tr_b16 v[236:237], v249 offset:8192
    v_mfma_f32_16x16x32_bf16 v[188:191], v[244:247], v[84:87], v[188:191]
    s_waitcnt lgkmcnt(5)
    ds_read_b64_tr_b16 v[238:239], v249 offset:8704
    v_mul_f32 v164, v164, v219
    v_mfma_f32_16x16x32_bf16 v[192:195], v[224:227], v[80:83], v[192:195]
    ds_read_b64_tr_b16 v[240:241], v250 offset:8192
    v_mfma_f32_16x16x32_bf16 v[196:199], v[224:227], v[84:87], v[196:199]
    s_waitcnt lgkmcnt(5)
    ds_read_b64_tr_b16 v[242:243], v250 offset:8704
    v_mul_f32 v165, v165, v219
    v_mfma_f32_16x16x32_bf16 v[200:203], v[228:231], v[80:83], v[200:203]
    ds_read_b64_tr_b16 v[244:245], v251 offset:8192
    v_mfma_f32_16x16x32_bf16 v[204:207], v[228:231], v[84:87], v[204:207]
    s_waitcnt lgkmcnt(5)
    ds_read_b64_tr_b16 v[246:247], v251 offset:8704
    v_mul_f32 v166, v166, v219
    v_mfma_f32_16x16x32_bf16 v[176:179], v[232:235], v[88:91], v[176:179]
    s_barrier
    ds_read_b64_tr_b16 v[224:225], v248 offset:12288
    v_mfma_f32_16x16x32_bf16 v[180:183], v[232:235], v[92:95], v[180:183]
    s_waitcnt lgkmcnt(5)
    ds_read_b64_tr_b16 v[226:227], v248 offset:12800
    v_mul_f32 v167, v167, v219
    v_mfma_f32_16x16x32_bf16 v[184:187], v[236:239], v[88:91], v[184:187]
    ds_read_b64_tr_b16 v[228:229], v249 offset:12288
    v_mfma_f32_16x16x32_bf16 v[188:191], v[236:239], v[92:95], v[188:191]
    s_waitcnt lgkmcnt(5)
    ds_read_b64_tr_b16 v[230:231], v249 offset:12800
    v_cvt_pk_bf16_f32 v160, v160, v161
    v_mfma_f32_16x16x32_bf16 v[192:195], v[240:243], v[88:91], v[192:195]
    ds_read_b64_tr_b16 v[232:233], v250 offset:12288
    v_mfma_f32_16x16x32_bf16 v[196:199], v[240:243], v[92:95], v[196:199]
    s_waitcnt lgkmcnt(5)
    ds_read_b64_tr_b16 v[234:235], v250 offset:12800
    v_cvt_pk_bf16_f32 v161, v162, v163
    v_mfma_f32_16x16x32_bf16 v[200:203], v[244:247], v[88:91], v[200:203]
    ds_read_b64_tr_b16 v[236:237], v251 offset:12288
    v_mfma_f32_16x16x32_bf16 v[204:207], v[244:247], v[92:95], v[204:207]
    s_waitcnt lgkmcnt(5)
    ds_read_b64_tr_b16 v[238:239], v251 offset:12800
    v_cvt_pk_bf16_f32 v162, v164, v165
    v_mfma_f32_16x16x32_bf16 v[176:179], v[224:227], v[96:99], v[176:179]
    ds_read_b64_tr_b16 v[240:241], v248 offset:16384
    v_mfma_f32_16x16x32_bf16 v[180:183], v[224:227], v[100:103], v[180:183]
    s_waitcnt lgkmcnt(5)
    ds_read_b64_tr_b16 v[242:243], v248 offset:16896
    v_cvt_pk_bf16_f32 v163, v166, v167
    v_mfma_f32_16x16x32_bf16 v[184:187], v[228:231], v[96:99], v[184:187]
    ds_read_b64_tr_b16 v[244:245], v249 offset:16384
    v_mfma_f32_16x16x32_bf16 v[188:191], v[228:231], v[100:103], v[188:191]
    s_waitcnt lgkmcnt(5)
    ds_read_b64_tr_b16 v[246:247], v249 offset:16896
    v_mul_f32 v168, v168, v218
    v_mfma_f32_16x16x32_bf16 v[192:195], v[232:235], v[96:99], v[192:195]
    ds_read_b64_tr_b16 v[224:225], v250 offset:16384
    v_mfma_f32_16x16x32_bf16 v[196:199], v[232:235], v[100:103], v[196:199]
    s_waitcnt lgkmcnt(5)
    ds_read_b64_tr_b16 v[226:227], v250 offset:16896
    v_mul_f32 v169, v169, v218
    v_mfma_f32_16x16x32_bf16 v[200:203], v[236:239], v[96:99], v[200:203]
    ds_read_b64_tr_b16 v[228:229], v251 offset:16384
    v_mfma_f32_16x16x32_bf16 v[204:207], v[236:239], v[100:103], v[204:207]
    s_waitcnt lgkmcnt(5)
    ds_read_b64_tr_b16 v[230:231], v251 offset:16896
    v_mul_f32 v170, v170, v218
    v_mfma_f32_16x16x32_bf16 v[176:179], v[240:243], v[104:107], v[176:179]
    ds_read_b64_tr_b16 v[232:233], v248 offset:20480
    v_mfma_f32_16x16x32_bf16 v[180:183], v[240:243], v[108:111], v[180:183]
    s_waitcnt lgkmcnt(5)
    ds_read_b64_tr_b16 v[234:235], v248 offset:20992
    v_mul_f32 v171, v171, v218
    v_mfma_f32_16x16x32_bf16 v[184:187], v[244:247], v[104:107], v[184:187]
    ds_read_b64_tr_b16 v[236:237], v249 offset:20480
    v_mfma_f32_16x16x32_bf16 v[188:191], v[244:247], v[108:111], v[188:191]
    s_waitcnt lgkmcnt(5)
    ds_read_b64_tr_b16 v[238:239], v249 offset:20992
    v_permlane16_swap_b32 v160, v162
    v_mfma_f32_16x16x32_bf16 v[192:195], v[224:227], v[104:107], v[192:195]
    ds_read_b64_tr_b16 v[240:241], v250 offset:20480
    v_mfma_f32_16x16x32_bf16 v[196:199], v[224:227], v[108:111], v[196:199]
    s_waitcnt lgkmcnt(5)
    ds_read_b64_tr_b16 v[242:243], v250 offset:20992
    v_permlane16_swap_b32 v161, v163
    v_mfma_f32_16x16x32_bf16 v[200:203], v[228:231], v[104:107], v[200:203]
    ds_read_b64_tr_b16 v[244:245], v251 offset:20480
    ds_read_b64_tr_b16 v[246:247], v251 offset:20992
    v_mfma_f32_16x16x32_bf16 v[204:207], v[228:231], v[108:111], v[204:207]
    s_waitcnt lgkmcnt(6)
    buffer_store_dwordx4 v[160:163], v254, s[20:23], s42 offen offset:2048 sc1
    v_mfma_f32_16x16x32_bf16 v[176:179], v[232:235], v[112:115], v[176:179]
    ds_read_b64_tr_b16 v[224:225], v248 offset:24576
    v_mfma_f32_16x16x32_bf16 v[180:183], v[232:235], v[116:119], v[180:183]
    s_waitcnt lgkmcnt(5)
    ds_read_b64_tr_b16 v[226:227], v248 offset:25088
    v_mul_f32 v172, v172, v219
    v_mfma_f32_16x16x32_bf16 v[184:187], v[236:239], v[112:115], v[184:187]
    ds_read_b64_tr_b16 v[228:229], v249 offset:24576
    v_mfma_f32_16x16x32_bf16 v[188:191], v[236:239], v[116:119], v[188:191]
    s_waitcnt lgkmcnt(5)
    ds_read_b64_tr_b16 v[230:231], v249 offset:25088
    v_mul_f32 v173, v173, v219
    v_mfma_f32_16x16x32_bf16 v[192:195], v[240:243], v[112:115], v[192:195]
    ds_read_b64_tr_b16 v[232:233], v250 offset:24576
    v_mfma_f32_16x16x32_bf16 v[196:199], v[240:243], v[116:119], v[196:199]
    s_waitcnt lgkmcnt(5)
    ds_read_b64_tr_b16 v[234:235], v250 offset:25088
    v_mul_f32 v174, v174, v219
    v_mfma_f32_16x16x32_bf16 v[200:203], v[244:247], v[112:115], v[200:203]
    ds_read_b64_tr_b16 v[236:237], v251 offset:24576
    v_mfma_f32_16x16x32_bf16 v[204:207], v[244:247], v[116:119], v[204:207]
    s_waitcnt lgkmcnt(5)
    ds_read_b64_tr_b16 v[238:239], v251 offset:25088
    v_mul_f32 v175, v175, v219
    v_mfma_f32_16x16x32_bf16 v[176:179], v[224:227], v[120:123], v[176:179]
    ds_read_b64_tr_b16 v[240:241], v248 offset:28672
    v_mfma_f32_16x16x32_bf16 v[180:183], v[224:227], v[124:127], v[180:183]
    s_waitcnt lgkmcnt(5)
    ds_read_b64_tr_b16 v[242:243], v248 offset:29184
    v_cvt_pk_bf16_f32 v168, v168, v169
    v_mfma_f32_16x16x32_bf16 v[184:187], v[228:231], v[120:123], v[184:187]
    ds_read_b64_tr_b16 v[244:245], v249 offset:28672
    v_mfma_f32_16x16x32_bf16 v[188:191], v[228:231], v[124:127], v[188:191]
    s_waitcnt lgkmcnt(5)
    ds_read_b64_tr_b16 v[246:247], v249 offset:29184
    v_cvt_pk_bf16_f32 v169, v170, v171
    v_mfma_f32_16x16x32_bf16 v[192:195], v[232:235], v[120:123], v[192:195]
    ds_read_b64_tr_b16 v[224:225], v250 offset:28672
    v_mfma_f32_16x16x32_bf16 v[196:199], v[232:235], v[124:127], v[196:199]
    s_waitcnt lgkmcnt(5)
    ds_read_b64_tr_b16 v[226:227], v250 offset:29184
    v_cvt_pk_bf16_f32 v170, v172, v173
    v_mfma_f32_16x16x32_bf16 v[200:203], v[236:239], v[120:123], v[200:203]
    ds_read_b64_tr_b16 v[228:229], v251 offset:28672
    v_mfma_f32_16x16x32_bf16 v[204:207], v[236:239], v[124:127], v[204:207]
    s_waitcnt lgkmcnt(5)
    ds_read_b64_tr_b16 v[230:231], v251 offset:29184
    v_cvt_pk_bf16_f32 v171, v174, v175
    v_mfma_f32_16x16x32_bf16 v[176:179], v[240:243], v[128:131], v[176:179]
    ds_read_b64_tr_b16 v[232:233], v248 offset:32768
    ds_read_b64_tr_b16 v[234:235], v248 offset:33280
    v_mfma_f32_16x16x32_bf16 v[180:183], v[240:243], v[132:135], v[180:183]
    s_waitcnt lgkmcnt(6)
    s_add_u32 s43, s43, 1
    v_add_u32 v248, -110592, v248
    v_mfma_f32_16x16x32_bf16 v[184:187], v[244:247], v[128:131], v[184:187]
    ds_read_b64_tr_b16 v[236:237], v249 offset:32768
    ds_read_b64_tr_b16 v[238:239], v249 offset:33280
    v_mfma_f32_16x16x32_bf16 v[188:191], v[244:247], v[132:135], v[188:191]
    s_waitcnt lgkmcnt(6)
    s_sub_u32 s44, s44, 1
    v_add_u32 v249, -110592, v249
    v_mfma_f32_16x16x32_bf16 v[192:195], v[224:227], v[128:131], v[192:195]
    ds_read_b64_tr_b16 v[240:241], v250 offset:32768
    ds_read_b64_tr_b16 v[242:243], v250 offset:33280
    v_mfma_f32_16x16x32_bf16 v[196:199], v[224:227], v[132:135], v[196:199]
    s_waitcnt lgkmcnt(6)
    v_permlane16_swap_b32 v168, v170
    v_add_u32 v250, -110592, v250
    v_mfma_f32_16x16x32_bf16 v[200:203], v[228:231], v[128:131], v[200:203]
    ds_read_b64_tr_b16 v[244:245], v251 offset:32768
    ds_read_b64_tr_b16 v[246:247], v251 offset:33280
    v_mfma_f32_16x16x32_bf16 v[204:207], v[228:231], v[132:135], v[204:207]
    s_waitcnt lgkmcnt(6)
    v_permlane16_swap_b32 v169, v171
    v_add_u32 v251, -110592, v251
    v_mfma_f32_16x16x32_bf16 v[176:179], v[232:235], v[136:139], v[176:179]
    s_barrier
    ds_read_b64_tr_b16 v[224:225], v248 offset:0
    ds_read_b64_tr_b16 v[226:227], v248 offset:512
    v_mfma_f32_16x16x32_bf16 v[180:183], v[232:235], v[140:143], v[180:183]
    s_waitcnt lgkmcnt(6)
    buffer_store_dwordx4 v[168:171], v254, s[20:23], s42 offen offset:3072 sc1
    v_mfma_f32_16x16x32_bf16 v[184:187], v[236:239], v[136:139], v[184:187]
    ds_read_b64_tr_b16 v[228:229], v249 offset:0
    ds_read_b64_tr_b16 v[230:231], v249 offset:512
    v_mfma_f32_16x16x32_bf16 v[188:191], v[236:239], v[140:143], v[188:191]
    s_waitcnt lgkmcnt(6)
    s_add_u32 s42, s42, 4096
    v_mfma_f32_16x16x32_bf16 v[192:195], v[240:243], v[136:139], v[192:195]
    ds_read_b64_tr_b16 v[232:233], v250 offset:0
    ds_read_b64_tr_b16 v[234:235], v250 offset:512
    v_mfma_f32_16x16x32_bf16 v[196:199], v[240:243], v[140:143], v[196:199]
    s_waitcnt lgkmcnt(6)
    v_mfma_f32_16x16x32_bf16 v[200:203], v[244:247], v[136:139], v[200:203]
    ds_read_b64_tr_b16 v[236:237], v251 offset:0
    ds_read_b64_tr_b16 v[238:239], v251 offset:512
    v_mfma_f32_16x16x32_bf16 v[204:207], v[244:247], v[140:143], v[204:207]
    s_waitcnt lgkmcnt(6)
    s_branch K1_X10
K1_F0:
    v_mfma_f32_16x16x32_bf16 v[144:147], v[224:227], v[0:3], 0
    ds_read_b64_tr_b16 v[240:241], v248 offset:4096
    v_lshlrev_b32 v210, 16, v80
    v_mfma_f32_16x16x32_bf16 v[148:151], v[224:227], v[4:7], 0
    s_waitcnt lgkmcnt(5)
    ds_read_b64_tr_b16 v[242:243], v248 offset:4608
    v_and_b32 v211, 0xffff0000, v80
    v_add_f32 v210, v210, v208
    v_add_f32 v211, v211, v208
    v_cvt_pk_bf16_f32 v80, v210, v211
    v_mfma_f32_16x16x32_bf16 v[152:155], v[228:231], v[0:3], 0
    ds_read_b64_tr_b16 v[244:245], v249 offset:4096
    v_lshlrev_b32 v212, 16, v81
    v_mfma_f32_16x16x32_bf16 v[156:159], v[228:231], v[4:7], 0
    s_waitcnt lgkmcnt(5)
    ds_read_b64_tr_b16 v[246:247], v249 offset:4608
    v_and_b32 v213, 0xffff0000, v81
    v_add_f32 v212, v212, v208
    v_add_f32 v213, v213, v208
    v_cvt_pk_bf16_f32 v81, v212, v213
    v_mfma_f32_16x16x32_bf16 v[160:163], v[232:235], v[0:3], 0
    ds_read_b64_tr_b16 v[224:225], v250 offset:4096
    v_lshlrev_b32 v214, 16, v82
    v_mfma_f32_16x16x32_bf16 v[164:167], v[232:235], v[4:7], 0
    s_waitcnt lgkmcnt(5)
    ds_read_b64_tr_b16 v[226:227], v250 offset:4608
    v_and_b32 v215, 0xffff0000, v82
    v_add_f32 v214, v214, v208
    v_add_f32 v215, v215, v208
    v_mfma_f32_16x16x32_bf16 v[168:171], v[236:239], v[0:3], 0
    ds_read_b64_tr_b16 v[228:229], v251 offset:4096
    v_cvt_pk_bf16_f32 v82, v214, v215
    v_mfma_f32_16x16x32_bf16 v[172:175], v[236:239], v[4:7], 0
    s_waitcnt lgkmcnt(5)
    ds_read_b64_tr_b16 v[230:231], v251 offset:4608
    v_lshlrev_b32 v216, 16, v83
    v_and_b32 v217, 0xffff0000, v83
    v_add_f32 v216, v216, v208
    v_add_f32 v217, v217, v208
    v_mfma_f32_16x16x32_bf16 v[144:147], v[240:243], v[8:11], v[144:147]
    ds_read_b64_tr_b16 v[232:233], v248 offset:8192
    v_cvt_pk_bf16_f32 v83, v216, v217
    v_mfma_f32_16x16x32_bf16 v[148:151], v[240:243], v[12:15], v[148:151]
    s_waitcnt lgkmcnt(5)
    ds_read_b64_tr_b16 v[234:235], v248 offset:8704
    v_lshlrev_b32 v210, 16, v84
    v_and_b32 v211, 0xffff0000, v84
    v_add_f32 v210, v210, v209
    v_add_f32 v211, v211, v209
    v_mfma_f32_16x16x32_bf16 v[152:155], v[244:247], v[8:11], v[152:155]
    ds_read_b64_tr_b16 v[236:237], v249 offset:8192
    v_cvt_pk_bf16_f32 v84, v210, v211
    v_mfma_f32_16x16x32_bf16 v[156:159], v[244:247], v[12:15], v[156:159]
    s_waitcnt lgkmcnt(5)
    ds_read_b64_tr_b16 v[238:239], v249 offset:8704
    v_lshlrev_b32 v212, 16, v85
    v_and_b32 v213, 0xffff0000, v85
    v_add_f32 v212, v212, v209
    v_add_f32 v213, v213, v209
    v_mfma_f32_16x16x32_bf16 v[160:163], v[224:227], v[8:11], v[160:163]
    ds_read_b64_tr_b16 v[240:241], v250 offset:8192
    v_cvt_pk_bf16_f32 v85, v212, v213
    v_mfma_f32_16x16x32_bf16 v[164:167], v[224:227], v[12:15], v[164:167]
    s_waitcnt lgkmcnt(5)
    ds_read_b64_tr_b16 v[242:243], v250 offset:8704
    v_lshlrev_b32 v214, 16, v86
    v_and_b32 v215, 0xffff0000, v86
    v_add_f32 v214, v214, v209
    v_mfma_f32_16x16x32_bf16 v[168:171], v[228:231], v[8:11], v[168:171]
    ds_read_b64_tr_b16 v[244:245], v251 offset:8192
    v_add_f32 v215, v215, v209
    v_mfma_f32_16x16x32_bf16 v[172:175], v[228:231], v[12:15], v[172:175]
    s_waitcnt lgkmcnt(5)
    ds_read_b64_tr_b16 v[246:247], v251 offset:8704
    v_cvt_pk_bf16_f32 v86, v214, v215
    v_lshlrev_b32 v216, 16, v87
    v_and_b32 v217, 0xffff0000, v87
    v_add_f32 v216, v216, v209
    v_mfma_f32_16x16x32_bf16 v[144:147], v[232:235], v[16:19], v[144:147]
    ds_read_b64_tr_b16 v[224:225], v248 offset:12288
    v_add_f32 v217, v217, v209
    v_mfma_f32_16x16x32_bf16 v[148:151], v[232:235], v[20:23], v[148:151]
    s_waitcnt lgkmcnt(5)
    ds_read_b64_tr_b16 v[226:227], v248 offset:12800
    v_cvt_pk_bf16_f32 v87, v216, v217
    v_lshlrev_b32 v210, 16, v88
    v_and_b32 v211, 0xffff0000, v88
    v_add_f32 v210, v210, v208
    v_mfma_f32_16x16x32_bf16 v[152:155], v[236:239], v[16:19], v[152:155]
    ds_read_b64_tr_b16 v[228:229], v249 offset:12288
    v_add_f32 v211, v211, v208
    v_mfma_f32_16x16x32_bf16 v[156:159], v[236:239], v[20:23], v[156:159]
    s_waitcnt lgkmcnt(5)
    ds_read_b64_tr_b16 v[230:231], v249 offset:12800
    v_cvt_pk_bf16_f32 v88, v210, v211
    v_lshlrev_b32 v212, 16, v89
    v_and_b32 v213, 0xffff0000, v89
    v_add_f32 v212, v212, v208
    v_mfma_f32_16x16x32_bf16 v[160:163], v[240:243], v[16:19], v[160:163]
    ds_read_b64_tr_b16 v[232:233], v250 offset:12288
    v_add_f32 v213, v213, v208
    v_mfma_f32_16x16x32_bf16 v[164:167], v[240:243], v[20:23], v[164:167]
    s_waitcnt lgkmcnt(5)
    ds_read_b64_tr_b16 v[234:235], v250 offset:12800
    v_cvt_pk_bf16_f32 v89, v212, v213
    v_lshlrev_b32 v214, 16, v90
    v_and_b32 v215, 0xffff0000, v90
    v_add_f32 v214, v214, v208
    v_mfma_f32_16x16x32_bf16 v[168:171], v[244:247], v[16:19], v[168:171]
    ds_read_b64_tr_b16 v[236:237], v251 offset:12288
    v_add_f32 v215, v215, v208
    v_mfma_f32_16x16x32_bf16 v[172:175], v[244:247], v[20:23], v[172:175]
    s_waitcnt lgkmcnt(5)
    ds_read_b64_tr_b16 v[238:239], v251 offset:12800
    v_cvt_pk_bf16_f32 v90, v214, v215
    v_lshlrev_b32 v216, 16, v91
    v_and_b32 v217, 0xffff0000, v91
    v_mfma_f32_16x16x32_bf16 v[144:147], v[224:227], v[24:27], v[144:147]
    ds_read_b64_tr_b16 v[240:241], v248 offset:16384
    v_add_f32 v216, v216, v208
    v_mfma_f32_16x16x32_bf16 v[148:151], v[224:227], v[28:31], v[148:151]
    s_waitcnt lgkmcnt(5)
    ds_read_b64_tr_b16 v[242:243], v248 offset:16896
    v_add_f32 v217, v217, v208
    v_cvt_pk_bf16_f32 v91, v216, v217
    v_lshlrev_b32 v210, 16, v92
    v_and_b32 v211, 0xffff0000, v92
    v_mfma_f32_16x16x32_bf16 v[152:155], v[228:231], v[24:27], v[152:155]
    ds_read_b64_tr_b16 v[244:245], v249 offset:16384
    v_add_f32 v210, v210, v209
    v_mfma_f32_16x16x32_bf16 v[156:159], v[228:231], v[28:31], v[156:159]
    s_waitcnt lgkmcnt(5)
    ds_read_b64_tr_b16 v[246:247], v249 offset:16896
    v_add_f32 v211, v211, v209
    v_cvt_pk_bf16_f32 v92, v210, v211
    v_lshlrev_b32 v212, 16, v93
    v_and_b32 v213, 0xffff0000, v93
    v_mfma_f32_16x16x32_bf16 v[160:163], v[232:235], v[24:27], v[160:163]
    ds_read_b64_tr_b16 v[224:225], v250 offset:16384
    v_add_f32 v212, v212, v209
    v_mfma_f32_16x16x32_bf16 v[164:167], v[232:235], v[28:31], v[164:167]
    s_waitcnt lgkmcnt(5)
    ds_read_b64_tr_b16 v[226:227], v250 offset:16896
    v_add_f32 v213, v213, v209
    v_cvt_pk_bf16_f32 v93, v212, v213
    v_lshlrev_b32 v214, 16, v94
    v_and_b32 v215, 0xffff0000, v94
    v_mfma_f32_16x16x32_bf16 v[168:171], v[236:239], v[24:27], v[168:171]
    ds_read_b64_tr_b16 v[228:229], v251 offset:16384
    v_add_f32 v214, v214, v209
    v_mfma_f32_16x16x32_bf16 v[172:175], v[236:239], v[28:31], v[172:175]
    s_waitcnt lgkmcnt(5)
    ds_read_b64_tr_b16 v[230:231], v251 offset:16896
    v_add_f32 v215, v215, v209
    v_cvt_pk_bf16_f32 v94, v214, v215
    v_lshlrev_b32 v216, 16, v95
    v_mfma_f32_16x16x32_bf16 v[144:147], v[240:243], v[32:35], v[144:147]
    ds_read_b64_tr_b16 v[232:233], v248 offset:20480
    v_and_b32 v217, 0xffff0000, v95
    v_mfma_f32_16x16x32_bf16 v[148:151], v[240:243], v[36:39], v[148:151]
    s_waitcnt lgkmcnt(5)
    ds_read_b64_tr_b16 v[234:235], v248 offset:20992
    v_add_f32 v216, v216, v209
    v_add_f32 v217, v217, v209
    v_cvt_pk_bf16_f32 v95, v216, v217
    v_lshlrev_b32 v210, 16, v96
    v_mfma_f32_16x16x32_bf16 v[152:155], v[244:247], v[32:35], v[152:155]
    ds_read_b64_tr_b16 v[236:237], v249 offset:20480
    v_and_b32 v211, 0xffff0000, v96
    v_mfma_f32_16x16x32_bf16 v[156:159], v[244:247], v[36:39], v[156:159]
    s_waitcnt lgkmcnt(5)
    ds_read_b64_tr_b16 v[238:239], v249 offset:20992
    v_add_f32 v210, v210, v208
    v_add_f32 v211, v211, v208
    v_cvt_pk_bf16_f32 v96, v210, v211
    v_lshlrev_b32 v212, 16, v97
    v_mfma_f32_16x16x32_bf16 v[160:163], v[224:227], v[32:35], v[160:163]
    ds_read_b64_tr_b16 v[240:241], v250 offset:20480
    v_and_b32 v213, 0xffff0000, v97
    v_mfma_f32_16x16x32_bf16 v[164:167], v[224:227], v[36:39], v[164:167]
    s_waitcnt lgkmcnt(5)
    ds_read_b64_tr_b16 v[242:243], v250 offset:20992
    v_add_f32 v212, v212, v208
    v_add_f32 v213, v213, v208
    v_cvt_pk_bf16_f32 v97, v212, v213
    v_lshlrev_b32 v214, 16, v98
    v_mfma_f32_16x16x32_bf16 v[168:171], v[228:231], v[32:35], v[168:171]
    ds_read_b64_tr_b16 v[244:245], v251 offset:20480
    v_and_b32 v215, 0xffff0000, v98
    v_mfma_f32_16x16x32_bf16 v[172:175], v[228:231], v[36:39], v[172:175]
    s_waitcnt lgkmcnt(5)
    ds_read_b64_tr_b16 v[246:247], v251 offset:20992
    v_add_f32 v214, v214, v208
    v_add_f32 v215, v215, v208
    v_cvt_pk_bf16_f32 v98, v214, v215
    v_lshlrev_b32 v216, 16, v99
    v_mfma_f32_16x16x32_bf16 v[144:147], v[232:235], v[40:43], v[144:147]
    s_barrier
    ds_read_b64_tr_b16 v[224:225], v248 offset:24576
    v_and_b32 v217, 0xffff0000, v99
    v_mfma_f32_16x16x32_bf16 v[148:151], v[232:235], v[44:47], v[148:151]
    s_waitcnt lgkmcnt(5)
    ds_read_b64_tr_b16 v[226:227], v248 offset:25088
    v_add_f32 v216, v216, v208
    v_add_f32 v217, v217, v208
    v_cvt_pk_bf16_f32 v99, v216, v217
    v_mfma_f32_16x16x32_bf16 v[152:155], v[236:239], v[40:43], v[152:155]
    ds_read_b64_tr_b16 v[228:229], v249 offset:24576
    v_lshlrev_b32 v210, 16, v100
    v_mfma_f32_16x16x32_bf16 v[156:159], v[236:239], v[44:47], v[156:159]
    s_waitcnt lgkmcnt(5)
    ds_read_b64_tr_b16 v[230:231], v249 offset:25088
    v_and_b32 v211, 0xffff0000, v100
    v_add_f32 v210, v210, v209
    v_add_f32 v211, v211, v209
    v_cvt_pk_bf16_f32 v100, v210, v211
    v_mfma_f32_16x16x32_bf16 v[160:163], v[240:243], v[40:43], v[160:163]
    ds_read_b64_tr_b16 v[232:233], v250 offset:24576
    v_lshlrev_b32 v212, 16, v101
    v_mfma_f32_16x16x32_bf16 v[164:167], v[240:243], v[44:47], v[164:167]
    s_waitcnt lgkmcnt(5)
    ds_read_b64_tr_b16 v[234:235], v250 offset:25088
    v_and_b32 v213, 0xffff0000, v101
    v_add_f32 v212, v212, v209
    v_add_f32 v213, v213, v209
    v_cvt_pk_bf16_f32 v101, v212, v213
    v_mfma_f32_16x16x32_bf16 v[168:171], v[244:247], v[40:43], v[168:171]
    ds_read_b64_tr_b16 v[236:237], v251 offset:24576
    v_lshlrev_b32 v214, 16, v102
    v_mfma_f32_16x16x32_bf16 v[172:175], v[244:247], v[44:47], v[172:175]
    s_waitcnt lgkmcnt(5)
    ds_read_b64_tr_b16 v[238:239], v251 offset:25088
    v_and_b32 v215, 0xffff0000, v102
    v_add_f32 v214, v214, v209
    v_add_f32 v215, v215, v209
    v_cvt_pk_bf16_f32 v102, v214, v215
    v_mfma_f32_16x16x32_bf16 v[144:147], v[224:227], v[48:51], v[144:147]
    ds_read_b64_tr_b16 v[240:241], v248 offset:28672
    v_lshlrev_b32 v216, 16, v103
    v_mfma_f32_16x16x32_bf16 v[148:151], v[224:227], v[52:55], v[148:151]
    s_waitcnt lgkmcnt(5)
    ds_read_b64_tr_b16 v[242:243], v248 offset:29184
    v_and_b32 v217, 0xffff0000, v103
    v_add_f32 v216, v216, v209
    v_add_f32 v217, v217, v209
    v_cvt_pk_bf16_f32 v103, v216, v217
    v_mfma_f32_16x16x32_bf16 v[152:155], v[228:231], v[48:51], v[152:155]
    ds_read_b64_tr_b16 v[244:245], v249 offset:28672
    v_lshlrev_b32 v210, 16, v104
    v_mfma_f32_16x16x32_bf16 v[156:159], v[228:231], v[52:55], v[156:159]
    s_waitcnt lgkmcnt(5)
    ds_read_b64_tr_b16 v[246:247], v249 offset:29184
    v_and_b32 v211, 0xffff0000, v104
    v_add_f32 v210, v210, v208
    v_add_f32 v211, v211, v208
    v_cvt_pk_bf16_f32 v104, v210, v211
    v_mfma_f32_16x16x32_bf16 v[160:163], v[232:235], v[48:51], v[160:163]
    ds_read_b64_tr_b16 v[224:225], v250 offset:28672
    v_lshlrev_b32 v212, 16, v105
    v_mfma_f32_16x16x32_bf16 v[164:167], v[232:235], v[52:55], v[164:167]
    s_waitcnt lgkmcnt(5)
    ds_read_b64_tr_b16 v[226:227], v250 offset:29184
    v_and_b32 v213, 0xffff0000, v105
    v_add_f32 v212, v212, v208
    v_add_f32 v213, v213, v208
    v_cvt_pk_bf16_f32 v105, v212, v213
    v_mfma_f32_16x16x32_bf16 v[168:171], v[236:239], v[48:51], v[168:171]
    ds_read_b64_tr_b16 v[228:229], v251 offset:28672
    v_lshlrev_b32 v214, 16, v106
    v_mfma_f32_16x16x32_bf16 v[172:175], v[236:239], v[52:55], v[172:175]
    s_waitcnt lgkmcnt(5)
    ds_read_b64_tr_b16 v[230:231], v251 offset:29184
    v_and_b32 v215, 0xffff0000, v106
    v_add_f32 v214, v214, v208
    v_add_f32 v215, v215, v208
    v_cvt_pk_bf16_f32 v106, v214, v215
    v_mfma_f32_16x16x32_bf16 v[144:147], v[240:243], v[56:59], v[144:147]
    ds_read_b64_tr_b16 v[232:233], v248 offset:32768
    v_lshlrev_b32 v216, 16, v107
    v_mfma_f32_16x16x32_bf16 v[148:151], v[240:243], v[60:63], v[148:151]
    s_waitcnt lgkmcnt(5)
    ds_read_b64_tr_b16 v[234:235], v248 offset:33280
    v_and_b32 v217, 0xffff0000, v107
    v_add_f32 v216, v216, v208
    v_add_f32 v217, v217, v208
    v_add_u32 v248, 36864, v248
    v_mfma_f32_16x16x32_bf16 v[152:155], v[244:247], v[56:59], v[152:155]
    ds_read_b64_tr_b16 v[236:237], v249 offset:32768
    v_cvt_pk_bf16_f32 v107, v216, v217
    v_mfma_f32_16x16x32_bf16 v[156:159], v[244:247], v[60:63], v[156:159]
    s_waitcnt lgkmcnt(5)
    ds_read_b64_tr_b16 v[238:239], v249 offset:33280
    v_lshlrev_b32 v210, 16, v108
    v_and_b32 v211, 0xffff0000, v108
    v_add_f32 v210, v210, v209
    v_add_u32 v249, 36864, v249
    v_mfma_f32_16x16x32_bf16 v[160:163], v[224:227], v[56:59], v[160:163]
    ds_read_b64_tr_b16 v[240:241], v250 offset:32768
    v_add_f32 v211, v211, v209
    v_mfma_f32_16x16x32_bf16 v[164:167], v[224:227], v[60:63], v[164:167]
    s_waitcnt lgkmcnt(5)
    ds_read_b64_tr_b16 v[242:243], v250 offset:33280
    v_cvt_pk_bf16_f32 v108, v210, v211
    v_lshlrev_b32 v212, 16, v109
    v_and_b32 v213, 0xffff0000, v109
    v_add_u32 v250, 36864, v250
    v_mfma_f32_16x16x32_bf16 v[168:171], v[228:231], v[56:59], v[168:171]
    ds_read_b64_tr_b16 v[244:245], v251 offset:32768
    v_add_f32 v212, v212, v209
    v_mfma_f32_16x16x32_bf16 v[172:175], v[228:231], v[60:63], v[172:175]
    s_waitcnt lgkmcnt(5)
    ds_read_b64_tr_b16 v[246:247], v251 offset:33280
    v_add_f32 v213, v213, v209
    v_cvt_pk_bf16_f32 v109, v212, v213
    v_lshlrev_b32 v214, 16, v110
    v_add_u32 v251, 36864, v251
    v_mfma_f32_16x16x32_bf16 v[144:147], v[232:235], v[64:67], v[144:147]
    ds_read_b64_tr_b16 v[224:225], v248 offset:0
    v_and_b32 v215, 0xffff0000, v110
    v_mfma_f32_16x16x32_bf16 v[148:151], v[232:235], v[68:71], v[148:151]
    s_waitcnt lgkmcnt(5)
    ds_read_b64_tr_b16 v[226:227], v248 offset:512
    v_add_f32 v214, v214, v209
    v_add_f32 v215, v215, v209
    v_cvt_pk_bf16_f32 v110, v214, v215
    v_lshlrev_b32 v216, 16, v111
    v_mfma_f32_16x16x32_bf16 v[152:155], v[236:239], v[64:67], v[152:155]
    ds_read_b64_tr_b16 v[228:229], v249 offset:0
    v_and_b32 v217, 0xffff0000, v111
    v_mfma_f32_16x16x32_bf16 v[156:159], v[236:239], v[68:71], v[156:159]
    s_waitcnt lgkmcnt(5)
    ds_read_b64_tr_b16 v[230:231], v249 offset:512
    v_add_f32 v216, v216, v209
    v_add_f32 v217, v217, v209
    v_cvt_pk_bf16_f32 v111, v216, v217
    v_lshlrev_b32 v210, 16, v112
    v_mfma_f32_16x16x32_bf16 v[160:163], v[240:243], v[64:67], v[160:163]
    ds_read_b64_tr_b16 v[232:233], v250 offset:0
    v_and_b32 v211, 0xffff0000, v112
    v_mfma_f32_16x16x32_bf16 v[164:167], v[240:243], v[68:71], v[164:167]
    s_waitcnt lgkmcnt(5)
    ds_read_b64_tr_b16 v[234:235], v250 offset:512
    v_add_f32 v210, v210, v208
    v_add_f32 v211, v211, v208
    v_cvt_pk_bf16_f32 v112, v210, v211
    v_lshlrev_b32 v212, 16, v113
    v_mfma_f32_16x16x32_bf16 v[168:171], v[244:247], v[64:67], v[168:171]
    ds_read_b64_tr_b16 v[236:237], v251 offset:0
    v_and_b32 v213, 0xffff0000, v113
    v_mfma_f32_16x16x32_bf16 v[172:175], v[244:247], v[68:71], v[172:175]
    s_waitcnt lgkmcnt(5)
    ds_read_b64_tr_b16 v[238:239], v251 offset:512
    v_add_f32 v212, v212, v208
    v_add_f32 v213, v213, v208
    v_cvt_pk_bf16_f32 v113, v212, v213
    v_lshlrev_b32 v214, 16, v114
    v_mfma_f32_16x16x32_bf16 v[144:147], v[224:227], v[72:75], v[144:147]
    ds_read_b64_tr_b16 v[240:241], v248 offset:4096
    v_and_b32 v215, 0xffff0000, v114
    v_mfma_f32_16x16x32_bf16 v[148:151], v[224:227], v[76:79], v[148:151]
    s_waitcnt lgkmcnt(5)
    ds_read_b64_tr_b16 v[242:243], v248 offset:4608
    v_add_f32 v214, v214, v208
    v_add_f32 v215, v215, v208
    v_cvt_pk_bf16_f32 v114, v214, v215
    v_lshlrev_b32 v216, 16, v115
    v_mfma_f32_16x16x32_bf16 v[152:155], v[228:231], v[72:75], v[152:155]
    ds_read_b64_tr_b16 v[244:245], v249 offset:4096
    v_and_b32 v217, 0xffff0000, v115
    v_mfma_f32_16x16x32_bf16 v[156:159], v[228:231], v[76:79], v[156:159]
    s_waitcnt lgkmcnt(5)
    ds_read_b64_tr_b16 v[246:247], v249 offset:4608
    v_add_f32 v216, v216, v208
    v_add_f32 v217, v217, v208
    v_cvt_pk_bf16_f32 v115, v216, v217
    v_lshlrev_b32 v210, 16, v116
    v_mfma_f32_16x16x32_bf16 v[160:163], v[232:235], v[72:75], v[160:163]
    ds_read_b64_tr_b16 v[224:225], v250 offset:4096
    v_and_b32 v211, 0xffff0000, v116
    v_mfma_f32_16x16x32_bf16 v[164:167], v[232:235], v[76:79], v[164:167]
    s_waitcnt lgkmcnt(5)
    ds_read_b64_tr_b16 v[226:227], v250 offset:4608
    v_add_f32 v210, v210, v209
    v_add_f32 v211, v211, v209
    v_cvt_pk_bf16_f32 v116, v210, v211
    v_lshlrev_b32 v212, 16, v117
    v_mfma_f32_16x16x32_bf16 v[168:171], v[236:239], v[72:75], v[168:171]
    ds_read_b64_tr_b16 v[228:229], v251 offset:4096
    v_and_b32 v213, 0xffff0000, v117
    v_mfma_f32_16x16x32_bf16 v[172:175], v[236:239], v[76:79], v[172:175]
    s_waitcnt lgkmcnt(5)
    ds_read_b64_tr_b16 v[230:231], v251 offset:4608
    v_add_f32 v212, v212, v209
    v_add_f32 v213, v213, v209
    v_cvt_pk_bf16_f32 v117, v212, v213
    v_lshlrev_b32 v214, 16, v118
    v_mfma_f32_16x16x32_bf16 v[144:147], v[240:243], v[80:83], v[144:147]
    ds_read_b64_tr_b16 v[232:233], v248 offset:8192
    v_and_b32 v215, 0xffff0000, v118
    v_mfma_f32_16x16x32_bf16 v[148:151], v[240:243], v[84:87], v[148:151]
    s_waitcnt lgkmcnt(5)
    ds_read_b64_tr_b16 v[234:235], v248 offset:8704
    v_add_f32 v214, v214, v209
    v_add_f32 v215, v215, v209
    v_cvt_pk_bf16_f32 v118, v214, v215
    v_lshlrev_b32 v216, 16, v119
    v_mfma_f32_16x16x32_bf16 v[152:155], v[244:247], v[80:83], v[152:155]
    ds_read_b64_tr_b16 v[236:237], v249 offset:8192
    v_and_b32 v217, 0xffff0000, v119
    v_mfma_f32_16x16x32_bf16 v[156:159], v[244:247], v[84:87], v[156:159]
    s_waitcnt lgkmcnt(5)
    ds_read_b64_tr_b16 v[238:239], v249 offset:8704
    v_add_f32 v216, v216, v209
    v_add_f32 v217, v217, v209
    v_cvt_pk_bf16_f32 v119, v216, v217
    v_lshlrev_b32 v210, 16, v120
    v_mfma_f32_16x16x32_bf16 v[160:163], v[224:227], v[80:83], v[160:163]
    ds_read_b64_tr_b16 v[240:241], v250 offset:8192
    v_and_b32 v211, 0xffff0000, v120
    v_mfma_f32_16x16x32_bf16 v[164:167], v[224:227], v[84:87], v[164:167]
    s_waitcnt lgkmcnt(5)
    ds_read_b64_tr_b16 v[242:243], v250 offset:8704
    v_add_f32 v210, v210, v208
    v_add_f32 v211, v211, v208
    v_cvt_pk_bf16_f32 v120, v210, v211
    v_lshlrev_b32 v212, 16, v121
    v_mfma_f32_16x16x32_bf16 v[168:171], v[228:231], v[80:83], v[168:171]
    ds_read_b64_tr_b16 v[244:245], v251 offset:8192
    v_and_b32 v213, 0xffff0000, v121
    v_mfma_f32_16x16x32_bf16 v[172:175], v[228:231], v[84:87], v[172:175]
    s_waitcnt lgkmcnt(5)
    ds_read_b64_tr_b16 v[246:247], v251 offset:8704
    v_add_f32 v212, v212, v208
    v_add_f32 v213, v213, v208
    v_cvt_pk_bf16_f32 v121, v212, v213
    v_lshlrev_b32 v214, 16, v122
    v_mfma_f32_16x16x32_bf16 v[144:147], v[232:235], v[88:91], v[144:147]
    s_barrier
    ds_read_b64_tr_b16 v[224:225], v248 offset:12288
    v_and_b32 v215, 0xffff0000, v122
    v_mfma_f32_16x16x32_bf16 v[148:151], v[232:235], v[92:95], v[148:151]
    s_waitcnt lgkmcnt(5)
    ds_read_b64_tr_b16 v[226:227], v248 offset:12800
    v_add_f32 v214, v214, v208
    v_add_f32 v215, v215, v208
    v_cvt_pk_bf16_f32 v122, v214, v215
    v_mfma_f32_16x16x32_bf16 v[152:155], v[236:239], v[88:91], v[152:155]
    ds_read_b64_tr_b16 v[228:229], v249 offset:12288
    v_lshlrev_b32 v216, 16, v123
    v_mfma_f32_16x16x32_bf16 v[156:159], v[236:239], v[92:95], v[156:159]
    s_waitcnt lgkmcnt(5)
    ds_read_b64_tr_b16 v[230:231], v249 offset:12800
    v_and_b32 v217, 0xffff0000, v123
    v_add_f32 v216, v216, v208
    v_add_f32 v217, v217, v208
    v_cvt_pk_bf16_f32 v123, v216, v217
    v_mfma_f32_16x16x32_bf16 v[160:163], v[240:243], v[88:91], v[160:163]
    ds_read_b64_tr_b16 v[232:233], v250 offset:12288
    v_lshlrev_b32 v210, 16, v124
    v_mfma_f32_16x16x32_bf16 v[164:167], v[240:243], v[92:95], v[164:167]
    s_waitcnt lgkmcnt(5)
    ds_read_b64_tr_b16 v[234:235], v250 offset:12800
    v_and_b32 v211, 0xffff0000, v124
    v_add_f32 v210, v210, v209
    v_add_f32 v211, v211, v209
    v_mfma_f32_16x16x32_bf16 v[168:171], v[244:247], v[88:91], v[168:171]
    ds_read_b64_tr_b16 v[236:237], v251 offset:12288
    v_cvt_pk_bf16_f32 v124, v210, v211
    v_mfma_f32_16x16x32_bf16 v[172:175], v[244:247], v[92:95], v[172:175]
    s_waitcnt lgkmcnt(5)
    ds_read_b64_tr_b16 v[238:239], v251 offset:12800
    v_lshlrev_b32 v212, 16, v125
    v_and_b32 v213, 0xffff0000, v125
    v_add_f32 v212, v212, v209
    v_add_f32 v213, v213, v209
    v_mfma_f32_16x16x32_bf16 v[144:147], v[224:227], v[96:99], v[144:147]
    ds_read_b64_tr_b16 v[240:241], v248 offset:16384
    v_cvt_pk_bf16_f32 v125, v212, v213
    v_mfma_f32_16x16x32_bf16 v[148:151], v[224:227], v[100:103], v[148:151]
    s_waitcnt lgkmcnt(5)
    ds_read_b64_tr_b16 v[242:243], v248 offset:16896
    v_lshlrev_b32 v214, 16, v126
    v_and_b32 v215, 0xffff0000, v126
    v_add_f32 v214, v214, v209
    v_add_f32 v215, v215, v209
    v_mfma_f32_16x16x32_bf16 v[152:155], v[228:231], v[96:99], v[152:155]
    ds_read_b64_tr_b16 v[244:245], v249 offset:16384
    v_cvt_pk_bf16_f32 v126, v214, v215
    v_mfma_f32_16x16x32_bf16 v[156:159], v[228:231], v[100:103], v[156:159]
    s_waitcnt lgkmcnt(5)
    ds_read_b64_tr_b16 v[246:247], v249 offset:16896
    v_lshlrev_b32 v216, 16, v127
    v_and_b32 v217, 0xffff0000, v127
    v_add_f32 v216, v216, v209
    v_add_f32 v217, v217, v209
    v_mfma_f32_16x16x32_bf16 v[160:163], v[232:235], v[96:99], v[160:163]
    ds_read_b64_tr_b16 v[224:225], v250 offset:16384
    v_cvt_pk_bf16_f32 v127, v216, v217
    v_mfma_f32_16x16x32_bf16 v[164:167], v[232:235], v[100:103], v[164:167]
    s_waitcnt lgkmcnt(5)
    ds_read_b64_tr_b16 v[226:227], v250 offset:16896
    v_lshlrev_b32 v210, 16, v128
    v_and_b32 v211, 0xffff0000, v128
    v_add_f32 v210, v210, v208
    v_add_f32 v211, v211, v208
    v_mfma_f32_16x16x32_bf16 v[168:171], v[236:239], v[96:99], v[168:171]
    ds_read_b64_tr_b16 v[228:229], v251 offset:16384
    v_cvt_pk_bf16_f32 v128, v210, v211
    v_mfma_f32_16x16x32_bf16 v[172:175], v[236:239], v[100:103], v[172:175]
    s_waitcnt lgkmcnt(5)
    ds_read_b64_tr_b16 v[230:231], v251 offset:16896
    v_lshlrev_b32 v212, 16, v129
    v_and_b32 v213, 0xffff0000, v129
    v_add_f32 v212, v212, v208
    v_mfma_f32_16x16x32_bf16 v[144:147], v[240:243], v[104:107], v[144:147]
    ds_read_b64_tr_b16 v[232:233], v248 offset:20480
    v_add_f32 v213, v213, v208
    v_mfma_f32_16x16x32_bf16 v[148:151], v[240:243], v[108:111], v[148:151]
    s_waitcnt lgkmcnt(5)
    ds_read_b64_tr_b16 v[234:235], v248 offset:20992
    v_cvt_pk_bf16_f32 v129, v212, v213
    v_lshlrev_b32 v214, 16, v130
    v_and_b32 v215, 0xffff0000, v130
    v_add_f32 v214, v214, v208
    v_mfma_f32_16x16x32_bf16 v[152:155], v[244:247], v[104:107], v[152:155]
    ds_read_b64_tr_b16 v[236:237], v249 offset:20480
    v_add_f32 v215, v215, v208
    v_mfma_f32_16x16x32_bf16 v[156:159], v[244:247], v[108:111], v[156:159]
    s_waitcnt lgkmcnt(5)
    ds_read_b64_tr_b16 v[238:239], v249 offset:20992
    v_cvt_pk_bf16_f32 v130, v214, v215
    v_lshlrev_b32 v216, 16, v131
    v_and_b32 v217, 0xffff0000, v131
    v_add_f32 v216, v216, v208
    v_mfma_f32_16x16x32_bf16 v[160:163], v[224:227], v[104:107], v[160:163]
    ds_read_b64_tr_b16 v[240:241], v250 offset:20480
    v_add_f32 v217, v217, v208
    v_mfma_f32_16x16x32_bf16 v[164:167], v[224:227], v[108:111], v[164:167]
    s_waitcnt lgkmcnt(5)
    ds_read_b64_tr_b16 v[242:243], v250 offset:20992
    v_cvt_pk_bf16_f32 v131, v216, v217
    v_lshlrev_b32 v210, 16, v132
    v_and_b32 v211, 0xffff0000, v132
    v_add_f32 v210, v210, v209
    v_mfma_f32_16x16x32_bf16 v[168:171], v[228:231], v[104:107], v[168:171]
    ds_read_b64_tr_b16 v[244:245], v251 offset:20480
    v_add_f32 v211, v211, v209
    v_mfma_f32_16x16x32_bf16 v[172:175], v[228:231], v[108:111], v[172:175]
    s_waitcnt lgkmcnt(5)
    ds_read_b64_tr_b16 v[246:247], v251 offset:20992
    v_cvt_pk_bf16_f32 v132, v210, v211
    v_lshlrev_b32 v212, 16, v133
    v_and_b32 v213, 0xffff0000, v133
    v_add_f32 v212, v212, v209
    v_mfma_f32_16x16x32_bf16 v[144:147], v[232:235], v[112:115], v[144:147]
    ds_read_b64_tr_b16 v[224:225], v248 offset:24576
    v_add_f32 v213, v213, v209
    v_mfma_f32_16x16x32_bf16 v[148:151], v[232:235], v[116:119], v[148:151]
    s_waitcnt lgkmcnt(5)
    ds_read_b64_tr_b16 v[226:227], v248 offset:25088
    v_cvt_pk_bf16_f32 v133, v212, v213
    v_lshlrev_b32 v214, 16, v134
    v_and_b32 v215, 0xffff0000, v134
    v_add_f32 v214, v214, v209
    v_mfma_f32_16x16x32_bf16 v[152:155], v[236:239], v[112:115], v[152:155]
    ds_read_b64_tr_b16 v[228:229], v249 offset:24576
    v_add_f32 v215, v215, v209
    v_mfma_f32_16x16x32_bf16 v[156:159], v[236:239], v[116:119], v[156:159]
    s_waitcnt lgkmcnt(5)
    ds_read_b64_tr_b16 v[230:231], v249 offset:25088
    v_cvt_pk_bf16_f32 v134, v214, v215
    v_lshlrev_b32 v216, 16, v135
    v_and_b32 v217, 0xffff0000, v135
    v_add_f32 v216, v216, v209
    v_mfma_f32_16x16x32_bf16 v[160:163], v[240:243], v[112:115], v[160:163]
    ds_read_b64_tr_b16 v[232:233], v250 offset:24576
    v_add_f32 v217, v217, v209
    v_mfma_f32_16x16x32_bf16 v[164:167], v[240:243], v[116:119], v[164:167]
    s_waitcnt lgkmcnt(5)
    ds_read_b64_tr_b16 v[234:235], v250 offset:25088
    v_cvt_pk_bf16_f32 v135, v216, v217
    v_lshlrev_b32 v210, 16, v136
    v_and_b32 v211, 0xffff0000, v136
    v_add_f32 v210, v210, v208
    v_mfma_f32_16x16x32_bf16 v[168:171], v[244:247], v[112:115], v[168:171]
    ds_read_b64_tr_b16 v[236:237], v251 offset:24576
    v_add_f32 v211, v211, v208
    v_mfma_f32_16x16x32_bf16 v[172:175], v[244:247], v[116:119], v[172:175]
    s_waitcnt lgkmcnt(5)
    ds_read_b64_tr_b16 v[238:239], v251 offset:25088
    v_cvt_pk_bf16_f32 v136, v210, v211
    v_lshlrev_b32 v212, 16, v137
    v_and_b32 v213, 0xffff0000, v137
    v_add_f32 v212, v212, v208
    v_mfma_f32_16x16x32_bf16 v[144:147], v[224:227], v[120:123], v[144:147]
    ds_read_b64_tr_b16 v[240:241], v248 offset:28672
    v_add_f32 v213, v213, v208
    v_mfma_f32_16x16x32_bf16 v[148:151], v[224:227], v[124:127], v[148:151]
    s_waitcnt lgkmcnt(5)
    ds_read_b64_tr_b16 v[242:243], v248 offset:29184
    v_cvt_pk_bf16_f32 v137, v212, v213
    v_lshlrev_b32 v214, 16, v138
    v_and_b32 v215, 0xffff0000, v138
    v_add_f32 v214, v214, v208
    v_mfma_f32_16x16x32_bf16 v[152:155], v[228:231], v[120:123], v[152:155]
    ds_read_b64_tr_b16 v[244:245], v249 offset:28672
    v_add_f32 v215, v215, v208
    v_mfma_f32_16x16x32_bf16 v[156:159], v[228:231], v[124:127], v[156:159]
    s_waitcnt lgkmcnt(5)
    ds_read_b64_tr_b16 v[246:247], v249 offset:29184
    v_cvt_pk_bf16_f32 v138, v214, v215
    v_lshlrev_b32 v216, 16, v139
    v_and_b32 v217, 0xffff0000, v139
    v_add_f32 v216, v216, v208
    v_mfma_f32_16x16x32_bf16 v[160:163], v[232:235], v[120:123], v[160:163]
    ds_read_b64_tr_b16 v[224:225], v250 offset:28672
    v_add_f32 v217, v217, v208
    v_mfma_f32_16x16x32_bf16 v[164:167], v[232:235], v[124:127], v[164:167]
    s_waitcnt lgkmcnt(5)
    ds_read_b64_tr_b16 v[226:227], v250 offset:29184
    v_cvt_pk_bf16_f32 v139, v216, v217
    v_lshlrev_b32 v210, 16, v140
    v_and_b32 v211, 0xffff0000, v140
    v_add_f32 v210, v210, v209
    v_mfma_f32_16x16x32_bf16 v[168:171], v[236:239], v[120:123], v[168:171]
    ds_read_b64_tr_b16 v[228:229], v251 offset:28672
    v_add_f32 v211, v211, v209
    v_mfma_f32_16x16x32_bf16 v[172:175], v[236:239], v[124:127], v[172:175]
    s_waitcnt lgkmcnt(5)
    ds_read_b64_tr_b16 v[230:231], v251 offset:29184
    v_cvt_pk_bf16_f32 v140, v210, v211
    v_lshlrev_b32 v212, 16, v141
    v_and_b32 v213, 0xffff0000, v141
    v_add_f32 v212, v212, v209
    v_mfma_f32_16x16x32_bf16 v[144:147], v[240:243], v[128:131], v[144:147]
    ds_read_b64_tr_b16 v[232:233], v248 offset:32768
    v_add_f32 v213, v213, v209
    v_mfma_f32_16x16x32_bf16 v[148:151], v[240:243], v[132:135], v[148:151]
    s_waitcnt lgkmcnt(5)
    ds_read_b64_tr_b16 v[234:235], v248 offset:33280
    v_cvt_pk_bf16_f32 v141, v212, v213
    v_lshlrev_b32 v214, 16, v142
    v_and_b32 v215, 0xffff0000, v142
    v_add_u32 v248, 36864, v248
    v_mfma_f32_16x16x32_bf16 v[152:155], v[244:247], v[128:131], v[152:155]
    ds_read_b64_tr_b16 v[236:237], v249 offset:32768
    v_add_f32 v214, v214, v209
    v_mfma_f32_16x16x32_bf16 v[156:159], v[244:247], v[132:135], v[156:159]
    s_waitcnt lgkmcnt(5)
    ds_read_b64_tr_b16 v[238:239], v249 offset:33280
    v_add_f32 v215, v215, v209
    v_cvt_pk_bf16_f32 v142, v214, v215
    v_lshlrev_b32 v216, 16, v143
    v_add_u32 v249, 36864, v249
    v_mfma_f32_16x16x32_bf16 v[160:163], v[224:227], v[128:131], v[160:163]
    ds_read_b64_tr_b16 v[240:241], v250 offset:32768
    v_and_b32 v217, 0xffff0000, v143
    v_mfma_f32_16x16x32_bf16 v[164:167], v[224:227], v[132:135], v[164:167]
    s_waitcnt lgkmcnt(5)
    ds_read_b64_tr_b16 v[242:243], v250 offset:33280
    v_add_f32 v216, v216, v209
    v_add_f32 v217, v217, v209
    v_cvt_pk_bf16_f32 v143, v216, v217
    v_add_u32 v250, 36864, v250
    v_mfma_f32_16x16x32_bf16 v[168:171], v[228:231], v[128:131], v[168:171]
    ds_read_b64_tr_b16 v[244:245], v251 offset:32768
    ds_read_b64_tr_b16 v[246:247], v251 offset:33280
    v_mfma_f32_16x16x32_bf16 v[172:175], v[228:231], v[132:135], v[172:175]
    s_waitcnt lgkmcnt(6)
    v_add_u32 v251, 36864, v251
    v_mfma_f32_16x16x32_bf16 v[144:147], v[232:235], v[136:139], v[144:147]
    s_barrier
    ds_read_b64_tr_b16 v[224:225], v248 offset:0
    ds_read_b64_tr_b16 v[226:227], v248 offset:512
    v_mfma_f32_16x16x32_bf16 v[148:151], v[232:235], v[140:143], v[148:151]
    s_waitcnt lgkmcnt(6)
    v_mfma_f32_16x16x32_bf16 v[152:155], v[236:239], v[136:139], v[152:155]
    ds_read_b64_tr_b16 v[228:229], v249 offset:0
    ds_read_b64_tr_b16 v[230:231], v249 offset:512
    v_mfma_f32_16x16x32_bf16 v[156:159], v[236:239], v[140:143], v[156:159]
    s_waitcnt lgkmcnt(6)
    v_mfma_f32_16x16x32_bf16 v[160:163], v[240:243], v[136:139], v[160:163]
    ds_read_b64_tr_b16 v[232:233], v250 offset:0
    ds_read_b64_tr_b16 v[234:235], v250 offset:512
    v_mfma_f32_16x16x32_bf16 v[164:167], v[240:243], v[140:143], v[164:167]
    s_waitcnt lgkmcnt(6)
    v_mfma_f32_16x16x32_bf16 v[168:171], v[244:247], v[136:139], v[168:171]
    ds_read_b64_tr_b16 v[236:237], v251 offset:0
    ds_read_b64_tr_b16 v[238:239], v251 offset:512
    v_mfma_f32_16x16x32_bf16 v[172:175], v[244:247], v[140:143], v[172:175]
    s_waitcnt lgkmcnt(6)
    s_branch K1_X01
K2_AFALL:
    v_add_u32 v14, s59, v3
    v_and_b32 v15, 1, v14
    v_lshrrev_b32 v14, 1, v14
    v_lshlrev_b32 v14, 9, v14
    v_lshl_add_u32 v14, v15, 3, v14
    v_lshl_add_u32 v8, v2, 4, v14
    s_lshl_b32 s33, s25, 2
    s_add_u32 s33, s33, s34
    v_lshl_add_u32 v9, v2, 4, s33
    v_lshrrev_b32 v14, 2, v2
    v_add_u32 v14, s59, v14
    v_and_b32 v15, 1, v14
    v_lshrrev_b32 v14, 1, v14
    v_lshlrev_b32 v14, 9, v14
    v_lshl_add_u32 v14, v15, 3, v14
    v_mov_b32 v15, s34
    v_cmp_gt_u32 vcc, 16, v2
    s_nop 1
    v_cndmask_b32 v14, v15, v14, vcc
    v_lshl_add_u32 v14, v5, 1, v14
    v_lshl_add_u32 v59, v3, 7, v14
    v_cmp_gt_u32 s[44:45], 20, v2
    v_mov_b32 v60, 0x3f803f80
    s_add_u32 s28, s27, 36864
    v_mov_b32 v209, 0
    v_mov_b32 v58, 0xff7fffff
    v_mov_b32 v128, 0
    v_mov_b32 v129, 0
    v_mov_b32 v130, 0
    v_mov_b32 v131, 0
    v_mov_b32 v132, 0
    v_mov_b32 v133, 0
    v_mov_b32 v134, 0
    v_mov_b32 v135, 0
    v_mov_b32 v136, 0
    v_mov_b32 v137, 0
    v_mov_b32 v138, 0
    v_mov_b32 v139, 0
    v_mov_b32 v140, 0
    v_mov_b32 v141, 0
    v_mov_b32 v142, 0
    v_mov_b32 v143, 0
    s_mov_b32 s30, 0
K2_AFB0:
    s_nop 0
    s_add_u32 s33, s28, 36864
    buffer_load_dwordx2 v[28:29], v8, s[20:23], s28 offen sc1
    buffer_load_dwordx2 v[30:31], v8, s[20:23], s28 offen offset:512 sc1
    buffer_load_dword v36, v9, s[20:23], s28 offen sc1
    buffer_load_ushort v80, v59, s[20:23], s33 offen offset:0 sc1
    buffer_load_ushort v81, v59, s[20:23], s33 offen offset:16 sc1
    buffer_load_ushort v82, v59, s[20:23], s33 offen offset:32 sc1
    buffer_load_ushort v83, v59, s[20:23], s33 offen offset:48 sc1
    buffer_load_ushort v84, v59, s[20:23], s33 offen offset:64 sc1
    buffer_load_ushort v85, v59, s[20:23], s33 offen offset:80 sc1
    buffer_load_ushort v86, v59, s[20:23], s33 offen offset:96 sc1
    buffer_load_ushort v87, v59, s[20:23], s33 offen offset:112 sc1
    buffer_load_ushort v88, v59, s[20:23], s33 offen offset:256 sc1
    buffer_load_ushort v89, v59, s[20:23], s33 offen offset:272 sc1
    buffer_load_ushort v90, v59, s[20:23], s33 offen offset:288 sc1
    buffer_load_ushort v91, v59, s[20:23], s33 offen offset:304 sc1
    buffer_load_ushort v92, v59, s[20:23], s33 offen offset:320 sc1
    buffer_load_ushort v93, v59, s[20:23], s33 offen offset:336 sc1
    buffer_load_ushort v94, v59, s[20:23], s33 offen offset:352 sc1
    buffer_load_ushort v95, v59, s[20:23], s33 offen offset:368 sc1
    s_waitcnt vmcnt(0)
    s_nop 0
    v_mfma_f32_32x32x8_bf16 v[64:79], v[36:37], v[208:209], 0
    v_mfma_f32_32x32x16_bf16 v[64:79], v[28:31], v[192:195], v[64:79]
    v_lshl_or_b32 v14, v81, 16, v80
    v_cndmask_b32 v40, v60, v14, s[44:45]
    v_lshl_or_b32 v14, v83, 16, v82
    v_cndmask_b32 v41, v60, v14, s[44:45]
    v_lshl_or_b32 v14, v85, 16, v84
    v_cndmask_b32 v42, v60, v14, s[44:45]
    v_lshl_or_b32 v14, v87, 16, v86
    v_cndmask_b32 v43, v60, v14, s[44:45]
    v_lshl_or_b32 v14, v89, 16, v88
    v_cndmask_b32 v44, v60, v14, s[44:45]
    v_lshl_or_b32 v14, v91, 16, v90
    v_cndmask_b32 v45, v60, v14, s[44:45]
    v_lshl_or_b32 v14, v93, 16, v92
    v_cndmask_b32 v46, v60, v14, s[44:45]
    v_lshl_or_b32 v14, v95, 16, v94
    v_cndmask_b32 v47, v60, v14, s[44:45]
    v_max3_f32 v57, v64, v65, v66
    v_max3_f32 v57, v57, v67, v68
    v_max3_f32 v57, v57, v69, v70
    v_max3_f32 v57, v57, v71, v72
    v_max3_f32 v57, v57, v73, v74
    v_max3_f32 v57, v57, v75, v76
    v_max3_f32 v57, v57, v77, v78
    v_max_f32 v57, v57, v79
    v_mov_b32 v14, v57
    s_nop 1
    v_permlane32_swap_b32 v57, v14
    s_nop 1
    v_max_f32 v57, v57, v14
    v_max_f32 v57, v57, v58
    v_sub_f32 v14, v58, v57
    v_exp_f32 v14, v14
    v_mov_b32 v58, v57
    v_sub_f32 v64, v64, v58
    v_sub_f32 v65, v65, v58
    v_sub_f32 v66, v66, v58
    v_sub_f32 v67, v67, v58
    v_sub_f32 v68, v68, v58
    v_sub_f32 v69, v69, v58
    v_sub_f32 v70, v70, v58
    v_sub_f32 v71, v71, v58
    v_sub_f32 v72, v72, v58
    v_sub_f32 v73, v73, v58
    v_sub_f32 v74, v74, v58
    v_sub_f32 v75, v75, v58
    v_sub_f32 v76, v76, v58
    v_sub_f32 v77, v77, v58
    v_sub_f32 v78, v78, v58
    v_sub_f32 v79, v79, v58
    v_exp_f32 v64, v64
    v_exp_f32 v65, v65
    v_exp_f32 v66, v66
    v_exp_f32 v67, v67
    v_exp_f32 v68, v68
    v_exp_f32 v69, v69
    v_exp_f32 v70, v70
    v_exp_f32 v71, v71
    v_exp_f32 v72, v72
    v_exp_f32 v73, v73
    v_exp_f32 v74, v74
    v_exp_f32 v75, v75
    v_exp_f32 v76, v76
    v_exp_f32 v77, v77
    v_exp_f32 v78, v78
    v_exp_f32 v79, v79
    v_mul_f32 v128, v128, v14
    v_mul_f32 v129, v129, v14
    v_mul_f32 v130, v130, v14
    v_mul_f32 v131, v131, v14
    v_mul_f32 v132, v132, v14
    v_mul_f32 v133, v133, v14
    v_mul_f32 v134, v134, v14
    v_mul_f32 v135, v135, v14
    v_mul_f32 v136, v136, v14
    v_mul_f32 v137, v137, v14
    v_mul_f32 v138, v138, v14
    v_mul_f32 v139, v139, v14
    v_mul_f32 v140, v140, v14
    v_mul_f32 v141, v141, v14
    v_mul_f32 v142, v142, v14
    v_mul_f32 v143, v143, v14
    s_nop 1
    v_smfmac_f32_32x32x32_bf16 v[128:143], v[40:43], v[64:71], v13
    v_smfmac_f32_32x32x32_bf16 v[128:143], v[44:47], v[72:79], v13
    s_add_u32 s28, s28, 110592
    s_nop 7
    s_nop 3
    s_add_u32 s30, s30, 1
    s_cmp_lt_u32 s30, 64
    s_cbranch_scc1 K2_AFB0
    s_add_u32 s28, s27, 36864
    v_mov_b32 v211, 0
    v_mov_b32 v58, 0xff7fffff
    v_mov_b32 v144, 0
    v_mov_b32 v145, 0
    v_mov_b32 v146, 0
    v_mov_b32 v147, 0
    v_mov_b32 v148, 0
    v_mov_b32 v149, 0
    v_mov_b32 v150, 0
    v_mov_b32 v151, 0
    v_mov_b32 v152, 0
    v_mov_b32 v153, 0
    v_mov_b32 v154, 0
    v_mov_b32 v155, 0
    v_mov_b32 v156, 0
    v_mov_b32 v157, 0
    v_mov_b32 v158, 0
    v_mov_b32 v159, 0
    s_mov_b32 s30, 0
K2_AFB1:
    s_add_u32 s33, s28, 36864
    buffer_load_dwordx2 v[28:29], v8, s[20:23], s28 offen sc1
    buffer_load_dwordx2 v[30:31], v8, s[20:23], s28 offen offset:512 sc1
    buffer_load_dword v36, v9, s[20:23], s28 offen sc1
    buffer_load_ushort v80, v59, s[20:23], s33 offen offset:0 sc1
    buffer_load_ushort v81, v59, s[20:23], s33 offen offset:16 sc1
    buffer_load_ushort v82, v59, s[20:23], s33 offen offset:32 sc1
    buffer_load_ushort v83, v59, s[20:23], s33 offen offset:48 sc1
    buffer_load_ushort v84, v59, s[20:23], s33 offen offset:64 sc1
    buffer_load_ushort v85, v59, s[20:23], s33 offen offset:80 sc1
    buffer_load_ushort v86, v59, s[20:23], s33 offen offset:96 sc1
    buffer_load_ushort v87, v59, s[20:23], s33 offen offset:112 sc1
    buffer_load_ushort v88, v59, s[20:23], s33 offen offset:256 sc1
    buffer_load_ushort v89, v59, s[20:23], s33 offen offset:272 sc1
    buffer_load_ushort v90, v59, s[20:23], s33 offen offset:288 sc1
    buffer_load_ushort v91, v59, s[20:23], s33 offen offset:304 sc1
    buffer_load_ushort v92, v59, s[20:23], s33 offen offset:320 sc1
    buffer_load_ushort v93, v59, s[20:23], s33 offen offset:336 sc1
    buffer_load_ushort v94, v59, s[20:23], s33 offen offset:352 sc1
    buffer_load_ushort v95, v59, s[20:23], s33 offen offset:368 sc1
    s_waitcnt vmcnt(0)
    s_nop 0
    v_mfma_f32_32x32x8_bf16 v[64:79], v[36:37], v[210:211], 0
    v_mfma_f32_32x32x16_bf16 v[64:79], v[28:31], v[196:199], v[64:79]
    v_lshl_or_b32 v14, v81, 16, v80
    v_cndmask_b32 v40, v60, v14, s[44:45]
    v_lshl_or_b32 v14, v83, 16, v82
    v_cndmask_b32 v41, v60, v14, s[44:45]
    v_lshl_or_b32 v14, v85, 16, v84
    v_cndmask_b32 v42, v60, v14, s[44:45]
    v_lshl_or_b32 v14, v87, 16, v86
    v_cndmask_b32 v43, v60, v14, s[44:45]
    v_lshl_or_b32 v14, v89, 16, v88
    v_cndmask_b32 v44, v60, v14, s[44:45]
    v_lshl_or_b32 v14, v91, 16, v90
    v_cndmask_b32 v45, v60, v14, s[44:45]
    v_lshl_or_b32 v14, v93, 16, v92
    v_cndmask_b32 v46, v60, v14, s[44:45]
    v_lshl_or_b32 v14, v95, 16, v94
    v_cndmask_b32 v47, v60, v14, s[44:45]
    v_max3_f32 v57, v64, v65, v66
    v_max3_f32 v57, v57, v67, v68
    v_max3_f32 v57, v57, v69, v70
    v_max3_f32 v57, v57, v71, v72
    v_max3_f32 v57, v57, v73, v74
    v_max3_f32 v57, v57, v75, v76
    v_max3_f32 v57, v57, v77, v78
    v_max_f32 v57, v57, v79
    v_mov_b32 v14, v57
    s_nop 1
    v_permlane32_swap_b32 v57, v14
    s_nop 1
    v_max_f32 v57, v57, v14
    v_max_f32 v57, v57, v58
    v_sub_f32 v14, v58, v57
    v_exp_f32 v14, v14
    v_mov_b32 v58, v57
    v_sub_f32 v64, v64, v58
    v_sub_f32 v65, v65, v58
    v_sub_f32 v66, v66, v58
    v_sub_f32 v67, v67, v58
    v_sub_f32 v68, v68, v58
    v_sub_f32 v69, v69, v58
    v_sub_f32 v70, v70, v58
    v_sub_f32 v71, v71, v58
    v_sub_f32 v72, v72, v58
    v_sub_f32 v73, v73, v58
    v_sub_f32 v74, v74, v58
    v_sub_f32 v75, v75, v58
    v_sub_f32 v76, v76, v58
    v_sub_f32 v77, v77, v58
    v_sub_f32 v78, v78, v58
    v_sub_f32 v79, v79, v58
    v_exp_f32 v64, v64
    v_exp_f32 v65, v65
    v_exp_f32 v66, v66
    v_exp_f32 v67, v67
    v_exp_f32 v68, v68
    v_exp_f32 v69, v69
    v_exp_f32 v70, v70
    v_exp_f32 v71, v71
    v_exp_f32 v72, v72
    v_exp_f32 v73, v73
    v_exp_f32 v74, v74
    v_exp_f32 v75, v75
    v_exp_f32 v76, v76
    v_exp_f32 v77, v77
    v_exp_f32 v78, v78
    v_exp_f32 v79, v79
    v_mul_f32 v144, v144, v14
    v_mul_f32 v145, v145, v14
    v_mul_f32 v146, v146, v14
    v_mul_f32 v147, v147, v14
    v_mul_f32 v148, v148, v14
    v_mul_f32 v149, v149, v14
    v_mul_f32 v150, v150, v14
    v_mul_f32 v151, v151, v14
    v_mul_f32 v152, v152, v14
    v_mul_f32 v153, v153, v14
    v_mul_f32 v154, v154, v14
    v_mul_f32 v155, v155, v14
    v_mul_f32 v156, v156, v14
    v_mul_f32 v157, v157, v14
    v_mul_f32 v158, v158, v14
    v_mul_f32 v159, v159, v14
    s_nop 1
    v_smfmac_f32_32x32x32_bf16 v[144:159], v[40:43], v[64:71], v13
    v_smfmac_f32_32x32x32_bf16 v[144:159], v[44:47], v[72:79], v13
    s_add_u32 s28, s28, 110592
    s_nop 7
    s_nop 3
    s_add_u32 s30, s30, 1
    s_cmp_lt_u32 s30, 64
    s_cbranch_scc1 K2_AFB1
    v_cndmask_b32 v136, v138, v136, s[42:43]
    v_cndmask_b32 v137, v139, v137, s[42:43]
    v_mov_b32 v138, v140
    v_cndmask_b32 v152, v154, v152, s[42:43]
    v_cndmask_b32 v153, v155, v153, s[42:43]
    v_mov_b32 v154, v156
    s_branch K2_AOUT
CODE_END:
.section .rodata,"a"
.p2align 6
.amdhsa_kernel parallel_sum__softmax_full_mha__glu_gated_glu__prompt_kernel
  .amdhsa_next_free_vgpr 256
  .amdhsa_next_free_sgpr 102
  .amdhsa_accum_offset 256
  .amdhsa_group_segment_fixed_size 0
  .amdhsa_kernarg_size 80
  .amdhsa_user_sgpr_count 2
  .amdhsa_user_sgpr_kernarg_segment_ptr 1
  .amdhsa_system_sgpr_workgroup_id_x 1
.end_amdhsa_kernel
```
